```python
import torch

def _softmax(x, axis=-1):
    return torch.softmax(x, dim=axis)

def _gelu(x):
    return torch.nn.functional.gelu(x, approximate='tanh')

def _silu(x):
    return torch.nn.functional.silu(x)

def _sigmoid(x):
    return torch.sigmoid(x)

def _layernorm(x, axis=-1, eps=1e-05):
    m = x.mean(dim=axis, keepdim=True)
    v = x.var(dim=axis, keepdim=True, unbiased=False)
    return (x - m) / torch.sqrt(v + eps)

def _scatter_add(tgt, idx, src, axis=0):
    return tgt.clone().index_add_(axis, idx, src)

def _segment_sum(src, seg, n):
    out = torch.zeros((n,) + src.shape[1:], dtype=src.dtype)
    return out.index_add_(0, seg, src)

def _pad(x, pw):
    flat = tuple((v for pair in reversed(pw) for v in pair))
    return torch.nn.functional.pad(x, flat)
kernel_name = 'adaLN_cond__grouped_kv_mqa__glu_gated_reglu__prompt'

def setup_inputs():

    _w = lambda a: (lambda t: t.to(torch.bfloat16) if t.is_floating_point() else t)(torch.as_tensor(a))

    def _A_setup():
        B, S, D, H = (1, 2048, 576, 32)
        Dh = D // H
        return {'x': _w((lambda *s: torch.randn(*s, dtype=torch.bfloat16) * 0.05)(B, S, D)), 'wq': _w((lambda *s: torch.randn(*s, dtype=torch.bfloat16) * 0.05)(D, H * Dh)), 'wk': _w((lambda *s: torch.randn(*s, dtype=torch.bfloat16) * 0.05)(D, Dh)), 'wv': _w((lambda *s: torch.randn(*s, dtype=torch.bfloat16) * 0.05)(D, Dh)), 'wo': _w((lambda *s: torch.randn(*s, dtype=torch.bfloat16) * 0.05)(H * Dh, D))}
    _A_in = _A_setup()

    def _B_setup():
        B, S, D, F = (1, 2048, 576, 4608)
        return {'x': _w((lambda *s: torch.randn(*s, dtype=torch.bfloat16) * 0.05)(B, S, D)), 'W_gate': _w((lambda *s: torch.randn(*s, dtype=torch.bfloat16) * 0.8)(D, F) * (2.0 / D) ** 0.5), 'W_up': _w((lambda *s: torch.randn(*s, dtype=torch.bfloat16) * 0.8)(D, F) * (2.0 / D) ** 0.5), 'W_down': _w((lambda *s: torch.randn(*s, dtype=torch.bfloat16) * 0.8)(F, D) * (1.0 / F) ** 0.5)}
    _B_in = _B_setup()
    return {'A_x': _A_in['x'], 'A_wq': _A_in['wq'], 'A_wk': _A_in['wk'], 'A_wv': _A_in['wv'], 'A_wo': _A_in['wo'], 'B_x': _B_in['x'], 'B_W_gate': _B_in['W_gate'], 'B_W_up': _B_in['W_up'], 'B_W_down': _B_in['W_down'], 'c': _w((lambda *s: torch.randn(*s, dtype=torch.bfloat16) * 0.2)(1, 576) * 8.0), 'w_mod': _w((lambda *s: torch.randn(*s, dtype=torch.bfloat16) * 0.2)(576, 6 * 576) * 576 ** (-0.5) * 8.0)}

def reference(A_x, A_wq, A_wk, A_wv, A_wo, B_x, B_W_gate, B_W_up, B_W_down, c, w_mod):

    def _A_ref(x, wq, wk, wv, wo):
        B, S, D = x.shape
        H = 32
        Dh = D // H
        q = (lambda x, *d: x.permute(*d))((x @ wq).reshape(B, S, H, Dh), 0, 2, 1, 3)
        k = x @ wk
        v = x @ wv
        scores = torch.einsum('bhqd,bkd->bhqk', q, k) * Dh ** (-0.5)
        p = _softmax(scores, axis=-1)
        o = torch.einsum('bhqk,bkd->bhqd', p, v)
        return (lambda x, *d: x.permute(*d))(o, 0, 2, 1, 3).reshape(B, S, H * Dh) @ wo

    def _B_ref(x, W_gate, W_up, W_down):
        gate = torch.einsum('bsd,df->bsf', x, W_gate)
        up = torch.einsum('bsd,df->bsf', x, W_up)
        gate = gate * (lambda x, dt: x.to(dt))(gate > 0, gate.dtype)
        h = gate * up
        return torch.einsum('bsf,fd->bsd', h, W_down)
    x = A_x
    mod = (_silu(c) @ w_mod).reshape(c.shape[0], 6, 1, -1)
    sa, ca, ga, sb, cb, gb = (mod[:, 0].clone(), mod[:, 1].clone(), mod[:, 2].clone(), mod[:, 3].clone(), mod[:, 4].clone(), mod[:, 5].clone())
    h = _layernorm(x, axis=-1) * (1 + ca) + sa
    x = x + ga * _A_ref(h, A_wq, A_wk, A_wv, A_wo)
    h = _layernorm(x, axis=-1) * (1 + cb) + sb
    x = x + gb * _B_ref(h, B_W_gate, B_W_up, B_W_down)
    return x
```

```asm
; @launch kernel=k1_prep_kernel grid=(446,1,1) block=(256,1,1) lds=2048
; @launch kernel=k2_qkv_kernel grid=(256,1,1) block=(256,1,1) lds=106496
; @launch kernel=k3_attn_kernel grid=(256,1,1) block=(768,1,1) lds=163840
; @launch kernel=k4_tail_kernel grid=(256,1,1) block=(512,1,1) lds=163840
.amdgcn_target "amdgcn-amd-amdhsa--gfx950"
.text
.globl k1_prep_kernel
.p2align 8
.type k1_prep_kernel,@function
k1_prep_kernel:
    s_cmp_ge_u32 s2, 446
    s_cbranch_scc1 K1_END
    s_cmp_ge_u32 s2, 438
    s_cbranch_scc1 K1_PF
    s_load_dwordx8 s[4:11], s[0:1], 0
    s_load_dwordx4 s[12:15], s[0:1], 72
    s_load_dwordx2 s[16:17], s[0:1], 104
    v_and_b32 v1, 63, v0
    v_lshrrev_b32 v2, 6, v0
    s_nop 0
    v_readfirstlane_b32 s48, v2
    s_cmp_ge_u32 s2, 240
    s_cbranch_scc1 K1_PACK
    s_cmp_ge_u32 s2, 112
    s_cbranch_scc1 K1_LN
    s_and_b32 s49, s2, 7
    s_lshr_b32 s50, s2, 3
    s_and_b32 s51, s50, 1
    s_lshr_b32 s50, s50, 1
    s_lshl_b32 s50, s50, 3
    s_add_u32 s50, s50, s49
    s_cmp_ge_u32 s50, 54
    s_cbranch_scc1 K1_END
    s_lshl_b32 s50, s50, 1
    s_add_u32 s50, s50, s51
    v_and_b32 v3, 3, v0
    v_lshrrev_b32 v4, 2, v0
    v_mul_u32_u24 v5, 6912, v4
    v_lshl_add_u32 v5, v3, 4, v5
    s_lshl_b32 s52, s50, 6
    v_lshlrev_b32 v6, 1, v4
    s_waitcnt lgkmcnt(0)
    s_mov_b32 s20, s14
    s_mov_b32 s21, s15
    s_mov_b32 s22, 3981312
    s_mov_b32 s23, 0x00020000
    s_mov_b32 s24, s12
    s_mov_b32 s25, s13
    s_mov_b32 s26, 1152
    s_mov_b32 s27, 0x00020000
    buffer_load_ushort v48, v6, s[24:27], 0 offen offset:0
    buffer_load_ushort v49, v6, s[24:27], 0 offen offset:128
    buffer_load_ushort v50, v6, s[24:27], 0 offen offset:256
    buffer_load_ushort v51, v6, s[24:27], 0 offen offset:384
    buffer_load_ushort v52, v6, s[24:27], 0 offen offset:512
    buffer_load_ushort v53, v6, s[24:27], 0 offen offset:640
    buffer_load_ushort v54, v6, s[24:27], 0 offen offset:768
    buffer_load_ushort v55, v6, s[24:27], 0 offen offset:896
    buffer_load_ushort v56, v6, s[24:27], 0 offen offset:1024
    buffer_load_dwordx4 v[12:15], v5, s[20:23], s52 offen
    s_add_u32 s52, s52, 442368
    buffer_load_dwordx4 v[16:19], v5, s[20:23], s52 offen
    s_add_u32 s52, s52, 442368
    buffer_load_dwordx4 v[20:23], v5, s[20:23], s52 offen
    s_add_u32 s52, s52, 442368
    buffer_load_dwordx4 v[24:27], v5, s[20:23], s52 offen
    s_add_u32 s52, s52, 442368
    buffer_load_dwordx4 v[28:31], v5, s[20:23], s52 offen
    s_add_u32 s52, s52, 442368
    buffer_load_dwordx4 v[32:35], v5, s[20:23], s52 offen
    s_add_u32 s52, s52, 442368
    buffer_load_dwordx4 v[36:39], v5, s[20:23], s52 offen
    s_add_u32 s52, s52, 442368
    buffer_load_dwordx4 v[40:43], v5, s[20:23], s52 offen
    s_add_u32 s52, s52, 442368
    buffer_load_dwordx4 v[44:47], v5, s[20:23], s52 offen
    s_mov_b32 s44, s16
    s_mov_b32 s45, s17
    s_mov_b32 s46, 268435456
    s_mov_b32 s47, 0x00020000
    v_mov_b32 v60, 0
    v_mov_b32 v61, 0
    v_mov_b32 v62, 0
    v_mov_b32 v63, 0
    v_mov_b32 v64, 0
    v_mov_b32 v65, 0
    v_mov_b32 v66, 0
    v_mov_b32 v67, 0
    s_waitcnt vmcnt(9)
    v_lshlrev_b32 v48, 16, v48
    v_mul_f32 v8, 0xbfb8aa3b, v48
    v_exp_f32 v8, v8
    s_nop 0
    v_add_f32 v8, 1.0, v8
    v_rcp_f32 v8, v8
    s_nop 0
    v_mul_f32 v8, v8, v48
    v_cvt_pk_bf16_f32 v8, v8, v8
    v_lshlrev_b32 v48, 16, v8
    v_lshlrev_b32 v49, 16, v49
    v_mul_f32 v8, 0xbfb8aa3b, v49
    v_exp_f32 v8, v8
    s_nop 0
    v_add_f32 v8, 1.0, v8
    v_rcp_f32 v8, v8
    s_nop 0
    v_mul_f32 v8, v8, v49
    v_cvt_pk_bf16_f32 v8, v8, v8
    v_lshlrev_b32 v49, 16, v8
    v_lshlrev_b32 v50, 16, v50
    v_mul_f32 v8, 0xbfb8aa3b, v50
    v_exp_f32 v8, v8
    s_nop 0
    v_add_f32 v8, 1.0, v8
    v_rcp_f32 v8, v8
    s_nop 0
    v_mul_f32 v8, v8, v50
    v_cvt_pk_bf16_f32 v8, v8, v8
    v_lshlrev_b32 v50, 16, v8
    v_lshlrev_b32 v51, 16, v51
    v_mul_f32 v8, 0xbfb8aa3b, v51
    v_exp_f32 v8, v8
    s_nop 0
    v_add_f32 v8, 1.0, v8
    v_rcp_f32 v8, v8
    s_nop 0
    v_mul_f32 v8, v8, v51
    v_cvt_pk_bf16_f32 v8, v8, v8
    v_lshlrev_b32 v51, 16, v8
    v_lshlrev_b32 v52, 16, v52
    v_mul_f32 v8, 0xbfb8aa3b, v52
    v_exp_f32 v8, v8
    s_nop 0
    v_add_f32 v8, 1.0, v8
    v_rcp_f32 v8, v8
    s_nop 0
    v_mul_f32 v8, v8, v52
    v_cvt_pk_bf16_f32 v8, v8, v8
    v_lshlrev_b32 v52, 16, v8
    v_lshlrev_b32 v53, 16, v53
    v_mul_f32 v8, 0xbfb8aa3b, v53
    v_exp_f32 v8, v8
    s_nop 0
    v_add_f32 v8, 1.0, v8
    v_rcp_f32 v8, v8
    s_nop 0
    v_mul_f32 v8, v8, v53
    v_cvt_pk_bf16_f32 v8, v8, v8
    v_lshlrev_b32 v53, 16, v8
    v_lshlrev_b32 v54, 16, v54
    v_mul_f32 v8, 0xbfb8aa3b, v54
    v_exp_f32 v8, v8
    s_nop 0
    v_add_f32 v8, 1.0, v8
    v_rcp_f32 v8, v8
    s_nop 0
    v_mul_f32 v8, v8, v54
    v_cvt_pk_bf16_f32 v8, v8, v8
    v_lshlrev_b32 v54, 16, v8
    v_lshlrev_b32 v55, 16, v55
    v_mul_f32 v8, 0xbfb8aa3b, v55
    v_exp_f32 v8, v8
    s_nop 0
    v_add_f32 v8, 1.0, v8
    v_rcp_f32 v8, v8
    s_nop 0
    v_mul_f32 v8, v8, v55
    v_cvt_pk_bf16_f32 v8, v8, v8
    v_lshlrev_b32 v55, 16, v8
    v_lshlrev_b32 v56, 16, v56
    v_mul_f32 v8, 0xbfb8aa3b, v56
    v_exp_f32 v8, v8
    s_nop 0
    v_add_f32 v8, 1.0, v8
    v_rcp_f32 v8, v8
    s_nop 0
    v_mul_f32 v8, v8, v56
    v_cvt_pk_bf16_f32 v8, v8, v8
    v_lshlrev_b32 v56, 16, v8
    s_waitcnt vmcnt(8)
    v_lshlrev_b32 v8, 16, v12
    v_and_b32 v9, 0xffff0000, v12
    v_pk_fma_f32 v[60:61], v[8:9], v[48:49], v[60:61] op_sel_hi:[1,0,1]
    v_lshlrev_b32 v8, 16, v13
    v_and_b32 v9, 0xffff0000, v13
    v_pk_fma_f32 v[62:63], v[8:9], v[48:49], v[62:63] op_sel_hi:[1,0,1]
    v_lshlrev_b32 v8, 16, v14
    v_and_b32 v9, 0xffff0000, v14
    v_pk_fma_f32 v[64:65], v[8:9], v[48:49], v[64:65] op_sel_hi:[1,0,1]
    v_lshlrev_b32 v8, 16, v15
    v_and_b32 v9, 0xffff0000, v15
    v_pk_fma_f32 v[66:67], v[8:9], v[48:49], v[66:67] op_sel_hi:[1,0,1]
    s_waitcnt vmcnt(7)
    v_lshlrev_b32 v8, 16, v16
    v_and_b32 v9, 0xffff0000, v16
    v_fmac_f32 v60, v8, v49
    v_fmac_f32 v61, v9, v49
    v_lshlrev_b32 v8, 16, v17
    v_and_b32 v9, 0xffff0000, v17
    v_fmac_f32 v62, v8, v49
    v_fmac_f32 v63, v9, v49
    v_lshlrev_b32 v8, 16, v18
    v_and_b32 v9, 0xffff0000, v18
    v_fmac_f32 v64, v8, v49
    v_fmac_f32 v65, v9, v49
    v_lshlrev_b32 v8, 16, v19
    v_and_b32 v9, 0xffff0000, v19
    v_fmac_f32 v66, v8, v49
    v_fmac_f32 v67, v9, v49
    s_waitcnt vmcnt(6)
    v_lshlrev_b32 v8, 16, v20
    v_and_b32 v9, 0xffff0000, v20
    v_pk_fma_f32 v[60:61], v[8:9], v[50:51], v[60:61] op_sel_hi:[1,0,1]
    v_lshlrev_b32 v8, 16, v21
    v_and_b32 v9, 0xffff0000, v21
    v_pk_fma_f32 v[62:63], v[8:9], v[50:51], v[62:63] op_sel_hi:[1,0,1]
    v_lshlrev_b32 v8, 16, v22
    v_and_b32 v9, 0xffff0000, v22
    v_pk_fma_f32 v[64:65], v[8:9], v[50:51], v[64:65] op_sel_hi:[1,0,1]
    v_lshlrev_b32 v8, 16, v23
    v_and_b32 v9, 0xffff0000, v23
    v_pk_fma_f32 v[66:67], v[8:9], v[50:51], v[66:67] op_sel_hi:[1,0,1]
    s_waitcnt vmcnt(5)
    v_lshlrev_b32 v8, 16, v24
    v_and_b32 v9, 0xffff0000, v24
    v_fmac_f32 v60, v8, v51
    v_fmac_f32 v61, v9, v51
    v_lshlrev_b32 v8, 16, v25
    v_and_b32 v9, 0xffff0000, v25
    v_fmac_f32 v62, v8, v51
    v_fmac_f32 v63, v9, v51
    v_lshlrev_b32 v8, 16, v26
    v_and_b32 v9, 0xffff0000, v26
    v_fmac_f32 v64, v8, v51
    v_fmac_f32 v65, v9, v51
    v_lshlrev_b32 v8, 16, v27
    v_and_b32 v9, 0xffff0000, v27
    v_fmac_f32 v66, v8, v51
    v_fmac_f32 v67, v9, v51
    s_waitcnt vmcnt(4)
    v_lshlrev_b32 v8, 16, v28
    v_and_b32 v9, 0xffff0000, v28
    v_pk_fma_f32 v[60:61], v[8:9], v[52:53], v[60:61] op_sel_hi:[1,0,1]
    v_lshlrev_b32 v8, 16, v29
    v_and_b32 v9, 0xffff0000, v29
    v_pk_fma_f32 v[62:63], v[8:9], v[52:53], v[62:63] op_sel_hi:[1,0,1]
    v_lshlrev_b32 v8, 16, v30
    v_and_b32 v9, 0xffff0000, v30
    v_pk_fma_f32 v[64:65], v[8:9], v[52:53], v[64:65] op_sel_hi:[1,0,1]
    v_lshlrev_b32 v8, 16, v31
    v_and_b32 v9, 0xffff0000, v31
    v_pk_fma_f32 v[66:67], v[8:9], v[52:53], v[66:67] op_sel_hi:[1,0,1]
    s_waitcnt vmcnt(3)
    v_lshlrev_b32 v8, 16, v32
    v_and_b32 v9, 0xffff0000, v32
    v_fmac_f32 v60, v8, v53
    v_fmac_f32 v61, v9, v53
    v_lshlrev_b32 v8, 16, v33
    v_and_b32 v9, 0xffff0000, v33
    v_fmac_f32 v62, v8, v53
    v_fmac_f32 v63, v9, v53
    v_lshlrev_b32 v8, 16, v34
    v_and_b32 v9, 0xffff0000, v34
    v_fmac_f32 v64, v8, v53
    v_fmac_f32 v65, v9, v53
    v_lshlrev_b32 v8, 16, v35
    v_and_b32 v9, 0xffff0000, v35
    v_fmac_f32 v66, v8, v53
    v_fmac_f32 v67, v9, v53
    s_waitcnt vmcnt(2)
    v_lshlrev_b32 v8, 16, v36
    v_and_b32 v9, 0xffff0000, v36
    v_pk_fma_f32 v[60:61], v[8:9], v[54:55], v[60:61] op_sel_hi:[1,0,1]
    v_lshlrev_b32 v8, 16, v37
    v_and_b32 v9, 0xffff0000, v37
    v_pk_fma_f32 v[62:63], v[8:9], v[54:55], v[62:63] op_sel_hi:[1,0,1]
    v_lshlrev_b32 v8, 16, v38
    v_and_b32 v9, 0xffff0000, v38
    v_pk_fma_f32 v[64:65], v[8:9], v[54:55], v[64:65] op_sel_hi:[1,0,1]
    v_lshlrev_b32 v8, 16, v39
    v_and_b32 v9, 0xffff0000, v39
    v_pk_fma_f32 v[66:67], v[8:9], v[54:55], v[66:67] op_sel_hi:[1,0,1]
    s_waitcnt vmcnt(1)
    v_lshlrev_b32 v8, 16, v40
    v_and_b32 v9, 0xffff0000, v40
    v_fmac_f32 v60, v8, v55
    v_fmac_f32 v61, v9, v55
    v_lshlrev_b32 v8, 16, v41
    v_and_b32 v9, 0xffff0000, v41
    v_fmac_f32 v62, v8, v55
    v_fmac_f32 v63, v9, v55
    v_lshlrev_b32 v8, 16, v42
    v_and_b32 v9, 0xffff0000, v42
    v_fmac_f32 v64, v8, v55
    v_fmac_f32 v65, v9, v55
    v_lshlrev_b32 v8, 16, v43
    v_and_b32 v9, 0xffff0000, v43
    v_fmac_f32 v66, v8, v55
    v_fmac_f32 v67, v9, v55
    s_waitcnt vmcnt(0)
    v_lshlrev_b32 v8, 16, v44
    v_and_b32 v9, 0xffff0000, v44
    v_pk_fma_f32 v[60:61], v[8:9], v[56:57], v[60:61] op_sel_hi:[1,0,1]
    v_lshlrev_b32 v8, 16, v45
    v_and_b32 v9, 0xffff0000, v45
    v_pk_fma_f32 v[62:63], v[8:9], v[56:57], v[62:63] op_sel_hi:[1,0,1]
    v_lshlrev_b32 v8, 16, v46
    v_and_b32 v9, 0xffff0000, v46
    v_pk_fma_f32 v[64:65], v[8:9], v[56:57], v[64:65] op_sel_hi:[1,0,1]
    v_lshlrev_b32 v8, 16, v47
    v_and_b32 v9, 0xffff0000, v47
    v_pk_fma_f32 v[66:67], v[8:9], v[56:57], v[66:67] op_sel_hi:[1,0,1]
    v_add_f32_dpp v60, v60, v60 row_ror:4 row_mask:0xf bank_mask:0xf
    v_add_f32_dpp v61, v61, v61 row_ror:4 row_mask:0xf bank_mask:0xf
    v_add_f32_dpp v62, v62, v62 row_ror:4 row_mask:0xf bank_mask:0xf
    v_add_f32_dpp v63, v63, v63 row_ror:4 row_mask:0xf bank_mask:0xf
    v_add_f32_dpp v64, v64, v64 row_ror:4 row_mask:0xf bank_mask:0xf
    v_add_f32_dpp v65, v65, v65 row_ror:4 row_mask:0xf bank_mask:0xf
    v_add_f32_dpp v66, v66, v66 row_ror:4 row_mask:0xf bank_mask:0xf
    v_add_f32_dpp v67, v67, v67 row_ror:4 row_mask:0xf bank_mask:0xf
    v_add_f32_dpp v60, v60, v60 row_ror:8 row_mask:0xf bank_mask:0xf
    v_add_f32_dpp v61, v61, v61 row_ror:8 row_mask:0xf bank_mask:0xf
    v_add_f32_dpp v62, v62, v62 row_ror:8 row_mask:0xf bank_mask:0xf
    v_add_f32_dpp v63, v63, v63 row_ror:8 row_mask:0xf bank_mask:0xf
    v_add_f32_dpp v64, v64, v64 row_ror:8 row_mask:0xf bank_mask:0xf
    v_add_f32_dpp v65, v65, v65 row_ror:8 row_mask:0xf bank_mask:0xf
    v_add_f32_dpp v66, v66, v66 row_ror:8 row_mask:0xf bank_mask:0xf
    v_add_f32_dpp v67, v67, v67 row_ror:8 row_mask:0xf bank_mask:0xf
    v_lshrrev_b32 v8, 4, v0
    v_lshlrev_b32 v8, 7, v8
    v_lshl_add_u32 v8, v3, 5, v8
    ds_write_b128 v8, v[60:63]
    ds_write_b128 v8, v[64:67] offset:16
    s_waitcnt lgkmcnt(0)
    s_barrier
    s_cmp_lg_u32 s48, 0
    s_cbranch_scc1 K1_END
    v_and_b32 v9, 31, v1
    v_lshlrev_b32 v8, 2, v9
    v_lshrrev_b32 v4, 5, v1
    v_lshl_add_u32 v4, v4, 10, v8
    ds_read_b32 v12, v4 offset:0
    ds_read_b32 v13, v4 offset:128
    ds_read_b32 v14, v4 offset:256
    ds_read_b32 v15, v4 offset:384
    ds_read_b32 v16, v4 offset:512
    ds_read_b32 v17, v4 offset:640
    ds_read_b32 v18, v4 offset:768
    ds_read_b32 v19, v4 offset:896
    s_mul_i32 s53, s50, 57
    s_lshr_b32 s53, s53, 10
    s_mov_b32 s54, 0
    s_cmp_eq_u32 s53, 1
    s_cselect_b32 s54, 1.0, s54
    s_cmp_eq_u32 s53, 4
    s_cselect_b32 s54, 1.0, s54
    s_lshl_b32 s55, s50, 7
    s_lshl_b32 s56, s50, 6
    s_add_u32 s56, s56, 32768
    v_lshlrev_b32 v9, 1, v9
    s_waitcnt lgkmcnt(0)
    v_add_f32 v12, v12, v13
    v_add_f32 v12, v12, v14
    v_add_f32 v12, v12, v15
    v_add_f32 v12, v12, v16
    v_add_f32 v12, v12, v17
    v_add_f32 v12, v12, v18
    v_add_f32 v12, v12, v19
    v_mov_b32 v13, v12
    s_nop 1
    v_permlane32_swap_b32 v12, v13
    v_add_f32 v12, v12, v13
    v_cvt_pk_bf16_f32 v12, v12, v12
    v_lshlrev_b32 v12, 16, v12
    v_add_f32 v12, s54, v12
    v_cvt_pk_bf16_f32 v13, v12, v12
    v_lshlrev_b32 v12, 16, v13
    buffer_store_dword v12, v8, s[44:47], s55 offen
    buffer_store_short v13, v9, s[44:47], s56 offen
    s_endpgm
K1_LN:
    s_sub_u32 s49, s2, 112
    s_and_b32 s50, s49, 7
    s_lshl_b32 s50, s50, 4
    s_lshr_b32 s49, s49, 3
    s_add_u32 s49, s49, s50
    s_lshl_b32 s49, s49, 2
    s_add_u32 s49, s49, s48
    s_lshl_b32 s49, s49, 2
    v_lshrrev_b32 v3, 4, v1
    v_and_b32 v4, 15, v1
    v_add_u32 v3, s49, v3
    v_mul_u32_u24 v5, 1152, v3
    v_lshl_add_u32 v5, v4, 3, v5
    s_waitcnt lgkmcnt(0)
    s_mov_b32 s20, s4
    s_mov_b32 s21, s5
    s_mov_b32 s22, 2359296
    s_mov_b32 s23, 0x00020000
    buffer_load_dwordx2 v[10:11], v5, s[20:23], 0 offen offset:0
    buffer_load_dwordx2 v[12:13], v5, s[20:23], 0 offen offset:128
    buffer_load_dwordx2 v[14:15], v5, s[20:23], 0 offen offset:256
    buffer_load_dwordx2 v[16:17], v5, s[20:23], 0 offen offset:384
    buffer_load_dwordx2 v[18:19], v5, s[20:23], 0 offen offset:512
    buffer_load_dwordx2 v[20:21], v5, s[20:23], 0 offen offset:640
    buffer_load_dwordx2 v[22:23], v5, s[20:23], 0 offen offset:768
    buffer_load_dwordx2 v[24:25], v5, s[20:23], 0 offen offset:896
    buffer_load_dwordx2 v[26:27], v5, s[20:23], 0 offen offset:1024
    s_mov_b32 s44, s16
    s_mov_b32 s45, s17
    s_mov_b32 s46, 268435456
    s_mov_b32 s47, 0x00020000
    v_lshrrev_b32 v8, 5, v3
    v_mul_u32_u24 v6, 36864, v8
    v_and_b32 v8, 31, v3
    v_lshl_add_u32 v6, v8, 4, v6
    v_lshrrev_b32 v8, 1, v4
    v_lshl_add_u32 v6, v8, 9, v6
    v_and_b32 v8, 1, v4
    v_lshl_add_u32 v6, v8, 3, v6
    s_mov_b32 s50, 1048576
    s_waitcnt vmcnt(8)
    v_lshlrev_b32 v28, 16, v10
    v_and_b32 v29, 0xffff0000, v10
    v_lshlrev_b32 v30, 16, v11
    v_and_b32 v31, 0xffff0000, v11
    v_pk_add_f32 v[64:65], v[28:29], v[30:31]
    s_waitcnt vmcnt(7)
    v_lshlrev_b32 v32, 16, v12
    v_and_b32 v33, 0xffff0000, v12
    v_lshlrev_b32 v34, 16, v13
    v_and_b32 v35, 0xffff0000, v13
    v_pk_add_f32 v[64:65], v[64:65], v[32:33]
    v_pk_add_f32 v[64:65], v[64:65], v[34:35]
    s_waitcnt vmcnt(6)
    v_lshlrev_b32 v36, 16, v14
    v_and_b32 v37, 0xffff0000, v14
    v_lshlrev_b32 v38, 16, v15
    v_and_b32 v39, 0xffff0000, v15
    v_pk_add_f32 v[64:65], v[64:65], v[36:37]
    v_pk_add_f32 v[64:65], v[64:65], v[38:39]
    s_waitcnt vmcnt(5)
    v_lshlrev_b32 v40, 16, v16
    v_and_b32 v41, 0xffff0000, v16
    v_lshlrev_b32 v42, 16, v17
    v_and_b32 v43, 0xffff0000, v17
    v_pk_add_f32 v[64:65], v[64:65], v[40:41]
    v_pk_add_f32 v[64:65], v[64:65], v[42:43]
    s_waitcnt vmcnt(4)
    v_lshlrev_b32 v44, 16, v18
    v_and_b32 v45, 0xffff0000, v18
    v_lshlrev_b32 v46, 16, v19
    v_and_b32 v47, 0xffff0000, v19
    v_pk_add_f32 v[64:65], v[64:65], v[44:45]
    v_pk_add_f32 v[64:65], v[64:65], v[46:47]
    s_waitcnt vmcnt(3)
    v_lshlrev_b32 v48, 16, v20
    v_and_b32 v49, 0xffff0000, v20
    v_lshlrev_b32 v50, 16, v21
    v_and_b32 v51, 0xffff0000, v21
    v_pk_add_f32 v[64:65], v[64:65], v[48:49]
    v_pk_add_f32 v[64:65], v[64:65], v[50:51]
    s_waitcnt vmcnt(2)
    v_lshlrev_b32 v52, 16, v22
    v_and_b32 v53, 0xffff0000, v22
    v_lshlrev_b32 v54, 16, v23
    v_and_b32 v55, 0xffff0000, v23
    v_pk_add_f32 v[64:65], v[64:65], v[52:53]
    v_pk_add_f32 v[64:65], v[64:65], v[54:55]
    s_waitcnt vmcnt(1)
    v_lshlrev_b32 v56, 16, v24
    v_and_b32 v57, 0xffff0000, v24
    v_lshlrev_b32 v58, 16, v25
    v_and_b32 v59, 0xffff0000, v25
    v_pk_add_f32 v[64:65], v[64:65], v[56:57]
    v_pk_add_f32 v[64:65], v[64:65], v[58:59]
    s_waitcnt vmcnt(0)
    v_lshlrev_b32 v60, 16, v26
    v_and_b32 v61, 0xffff0000, v26
    v_lshlrev_b32 v62, 16, v27
    v_and_b32 v63, 0xffff0000, v27
    v_pk_add_f32 v[64:65], v[64:65], v[60:61]
    v_pk_add_f32 v[64:65], v[64:65], v[62:63]
    v_add_f32 v64, v64, v65
    s_nop 1
    v_add_f32_dpp v64, v64, v64 quad_perm:[1,0,3,2] row_mask:0xf bank_mask:0xf
    s_nop 1
    v_add_f32_dpp v64, v64, v64 quad_perm:[2,3,0,1] row_mask:0xf bank_mask:0xf
    s_nop 1
    v_add_f32_dpp v64, v64, v64 row_half_mirror row_mask:0xf bank_mask:0xf
    s_nop 1
    v_add_f32_dpp v64, v64, v64 row_mirror row_mask:0xf bank_mask:0xf
    v_mul_f32 v64, 0x3ae38e39, v64
    v_pk_add_f32 v[8:9], v[28:29], v[64:65] op_sel_hi:[1,0] neg_lo:[0,1] neg_hi:[0,1]
    v_pk_mul_f32 v[66:67], v[8:9], v[8:9]
    v_pk_add_f32 v[8:9], v[30:31], v[64:65] op_sel_hi:[1,0] neg_lo:[0,1] neg_hi:[0,1]
    v_pk_fma_f32 v[66:67], v[8:9], v[8:9], v[66:67]
    v_pk_add_f32 v[8:9], v[32:33], v[64:65] op_sel_hi:[1,0] neg_lo:[0,1] neg_hi:[0,1]
    v_pk_fma_f32 v[66:67], v[8:9], v[8:9], v[66:67]
    v_pk_add_f32 v[8:9], v[34:35], v[64:65] op_sel_hi:[1,0] neg_lo:[0,1] neg_hi:[0,1]
    v_pk_fma_f32 v[66:67], v[8:9], v[8:9], v[66:67]
    v_pk_add_f32 v[8:9], v[36:37], v[64:65] op_sel_hi:[1,0] neg_lo:[0,1] neg_hi:[0,1]
    v_pk_fma_f32 v[66:67], v[8:9], v[8:9], v[66:67]
    v_pk_add_f32 v[8:9], v[38:39], v[64:65] op_sel_hi:[1,0] neg_lo:[0,1] neg_hi:[0,1]
    v_pk_fma_f32 v[66:67], v[8:9], v[8:9], v[66:67]
    v_pk_add_f32 v[8:9], v[40:41], v[64:65] op_sel_hi:[1,0] neg_lo:[0,1] neg_hi:[0,1]
    v_pk_fma_f32 v[66:67], v[8:9], v[8:9], v[66:67]
    v_pk_add_f32 v[8:9], v[42:43], v[64:65] op_sel_hi:[1,0] neg_lo:[0,1] neg_hi:[0,1]
    v_pk_fma_f32 v[66:67], v[8:9], v[8:9], v[66:67]
    v_pk_add_f32 v[8:9], v[44:45], v[64:65] op_sel_hi:[1,0] neg_lo:[0,1] neg_hi:[0,1]
    v_pk_fma_f32 v[66:67], v[8:9], v[8:9], v[66:67]
    v_pk_add_f32 v[8:9], v[46:47], v[64:65] op_sel_hi:[1,0] neg_lo:[0,1] neg_hi:[0,1]
    v_pk_fma_f32 v[66:67], v[8:9], v[8:9], v[66:67]
    v_pk_add_f32 v[8:9], v[48:49], v[64:65] op_sel_hi:[1,0] neg_lo:[0,1] neg_hi:[0,1]
    v_pk_fma_f32 v[66:67], v[8:9], v[8:9], v[66:67]
    v_pk_add_f32 v[8:9], v[50:51], v[64:65] op_sel_hi:[1,0] neg_lo:[0,1] neg_hi:[0,1]
    v_pk_fma_f32 v[66:67], v[8:9], v[8:9], v[66:67]
    v_pk_add_f32 v[8:9], v[52:53], v[64:65] op_sel_hi:[1,0] neg_lo:[0,1] neg_hi:[0,1]
    v_pk_fma_f32 v[66:67], v[8:9], v[8:9], v[66:67]
    v_pk_add_f32 v[8:9], v[54:55], v[64:65] op_sel_hi:[1,0] neg_lo:[0,1] neg_hi:[0,1]
    v_pk_fma_f32 v[66:67], v[8:9], v[8:9], v[66:67]
    v_pk_add_f32 v[8:9], v[56:57], v[64:65] op_sel_hi:[1,0] neg_lo:[0,1] neg_hi:[0,1]
    v_pk_fma_f32 v[66:67], v[8:9], v[8:9], v[66:67]
    v_pk_add_f32 v[8:9], v[58:59], v[64:65] op_sel_hi:[1,0] neg_lo:[0,1] neg_hi:[0,1]
    v_pk_fma_f32 v[66:67], v[8:9], v[8:9], v[66:67]
    v_pk_add_f32 v[8:9], v[60:61], v[64:65] op_sel_hi:[1,0] neg_lo:[0,1] neg_hi:[0,1]
    v_pk_fma_f32 v[66:67], v[8:9], v[8:9], v[66:67]
    v_pk_add_f32 v[8:9], v[62:63], v[64:65] op_sel_hi:[1,0] neg_lo:[0,1] neg_hi:[0,1]
    v_pk_fma_f32 v[66:67], v[8:9], v[8:9], v[66:67]
    v_add_f32 v66, v66, v67
    s_nop 1
    v_add_f32_dpp v66, v66, v66 quad_perm:[1,0,3,2] row_mask:0xf bank_mask:0xf
    s_nop 1
    v_add_f32_dpp v66, v66, v66 quad_perm:[2,3,0,1] row_mask:0xf bank_mask:0xf
    s_nop 1
    v_add_f32_dpp v66, v66, v66 row_half_mirror row_mask:0xf bank_mask:0xf
    s_nop 1
    v_add_f32_dpp v66, v66, v66 row_mirror row_mask:0xf bank_mask:0xf
    v_mul_f32 v66, 0x3ae38e39, v66
    v_cvt_pk_bf16_f32 v8, v64, v66
    v_lshlrev_b32 v64, 16, v8
    v_and_b32 v66, 0xffff0000, v8
    v_add_f32 v66, 0x3727c5ac, v66
    v_cvt_pk_bf16_f32 v8, v66, v66
    v_lshlrev_b32 v66, 16, v8
    v_sqrt_f32 v66, v66
    s_nop 0
    v_cvt_pk_bf16_f32 v8, v66, v66
    v_lshlrev_b32 v66, 16, v8
    v_rcp_f32 v66, v66
    v_pk_add_f32 v[28:29], v[28:29], v[64:65] op_sel_hi:[1,0] neg_lo:[0,1] neg_hi:[0,1]
    v_cvt_pk_bf16_f32 v8, v28, v29
    v_lshlrev_b32 v28, 16, v8
    v_and_b32 v29, 0xffff0000, v8
    v_pk_mul_f32 v[28:29], v[28:29], v[66:67] op_sel_hi:[1,0]
    v_cvt_pk_bf16_f32 v10, v28, v29
    v_pk_add_f32 v[30:31], v[30:31], v[64:65] op_sel_hi:[1,0] neg_lo:[0,1] neg_hi:[0,1]
    v_cvt_pk_bf16_f32 v8, v30, v31
    v_lshlrev_b32 v30, 16, v8
    v_and_b32 v31, 0xffff0000, v8
    v_pk_mul_f32 v[30:31], v[30:31], v[66:67] op_sel_hi:[1,0]
    v_cvt_pk_bf16_f32 v11, v30, v31
    buffer_store_dwordx2 v[10:11], v6, s[44:47], s50 offen
    s_add_u32 s50, s50, 4096
    v_pk_add_f32 v[32:33], v[32:33], v[64:65] op_sel_hi:[1,0] neg_lo:[0,1] neg_hi:[0,1]
    v_cvt_pk_bf16_f32 v8, v32, v33
    v_lshlrev_b32 v32, 16, v8
    v_and_b32 v33, 0xffff0000, v8
    v_pk_mul_f32 v[32:33], v[32:33], v[66:67] op_sel_hi:[1,0]
    v_cvt_pk_bf16_f32 v12, v32, v33
    v_pk_add_f32 v[34:35], v[34:35], v[64:65] op_sel_hi:[1,0] neg_lo:[0,1] neg_hi:[0,1]
    v_cvt_pk_bf16_f32 v8, v34, v35
    v_lshlrev_b32 v34, 16, v8
    v_and_b32 v35, 0xffff0000, v8
    v_pk_mul_f32 v[34:35], v[34:35], v[66:67] op_sel_hi:[1,0]
    v_cvt_pk_bf16_f32 v13, v34, v35
    buffer_store_dwordx2 v[12:13], v6, s[44:47], s50 offen
    s_add_u32 s50, s50, 4096
    v_pk_add_f32 v[36:37], v[36:37], v[64:65] op_sel_hi:[1,0] neg_lo:[0,1] neg_hi:[0,1]
    v_cvt_pk_bf16_f32 v8, v36, v37
    v_lshlrev_b32 v36, 16, v8
    v_and_b32 v37, 0xffff0000, v8
    v_pk_mul_f32 v[36:37], v[36:37], v[66:67] op_sel_hi:[1,0]
    v_cvt_pk_bf16_f32 v14, v36, v37
    v_pk_add_f32 v[38:39], v[38:39], v[64:65] op_sel_hi:[1,0] neg_lo:[0,1] neg_hi:[0,1]
    v_cvt_pk_bf16_f32 v8, v38, v39
    v_lshlrev_b32 v38, 16, v8
    v_and_b32 v39, 0xffff0000, v8
    v_pk_mul_f32 v[38:39], v[38:39], v[66:67] op_sel_hi:[1,0]
    v_cvt_pk_bf16_f32 v15, v38, v39
    buffer_store_dwordx2 v[14:15], v6, s[44:47], s50 offen
    s_add_u32 s50, s50, 4096
    v_pk_add_f32 v[40:41], v[40:41], v[64:65] op_sel_hi:[1,0] neg_lo:[0,1] neg_hi:[0,1]
    v_cvt_pk_bf16_f32 v8, v40, v41
    v_lshlrev_b32 v40, 16, v8
    v_and_b32 v41, 0xffff0000, v8
    v_pk_mul_f32 v[40:41], v[40:41], v[66:67] op_sel_hi:[1,0]
    v_cvt_pk_bf16_f32 v16, v40, v41
    v_pk_add_f32 v[42:43], v[42:43], v[64:65] op_sel_hi:[1,0] neg_lo:[0,1] neg_hi:[0,1]
    v_cvt_pk_bf16_f32 v8, v42, v43
    v_lshlrev_b32 v42, 16, v8
    v_and_b32 v43, 0xffff0000, v8
    v_pk_mul_f32 v[42:43], v[42:43], v[66:67] op_sel_hi:[1,0]
    v_cvt_pk_bf16_f32 v17, v42, v43
    buffer_store_dwordx2 v[16:17], v6, s[44:47], s50 offen
    s_add_u32 s50, s50, 4096
    v_pk_add_f32 v[44:45], v[44:45], v[64:65] op_sel_hi:[1,0] neg_lo:[0,1] neg_hi:[0,1]
    v_cvt_pk_bf16_f32 v8, v44, v45
    v_lshlrev_b32 v44, 16, v8
    v_and_b32 v45, 0xffff0000, v8
    v_pk_mul_f32 v[44:45], v[44:45], v[66:67] op_sel_hi:[1,0]
    v_cvt_pk_bf16_f32 v18, v44, v45
    v_pk_add_f32 v[46:47], v[46:47], v[64:65] op_sel_hi:[1,0] neg_lo:[0,1] neg_hi:[0,1]
    v_cvt_pk_bf16_f32 v8, v46, v47
    v_lshlrev_b32 v46, 16, v8
    v_and_b32 v47, 0xffff0000, v8
    v_pk_mul_f32 v[46:47], v[46:47], v[66:67] op_sel_hi:[1,0]
    v_cvt_pk_bf16_f32 v19, v46, v47
    buffer_store_dwordx2 v[18:19], v6, s[44:47], s50 offen
    s_add_u32 s50, s50, 4096
    v_pk_add_f32 v[48:49], v[48:49], v[64:65] op_sel_hi:[1,0] neg_lo:[0,1] neg_hi:[0,1]
    v_cvt_pk_bf16_f32 v8, v48, v49
    v_lshlrev_b32 v48, 16, v8
    v_and_b32 v49, 0xffff0000, v8
    v_pk_mul_f32 v[48:49], v[48:49], v[66:67] op_sel_hi:[1,0]
    v_cvt_pk_bf16_f32 v20, v48, v49
    v_pk_add_f32 v[50:51], v[50:51], v[64:65] op_sel_hi:[1,0] neg_lo:[0,1] neg_hi:[0,1]
    v_cvt_pk_bf16_f32 v8, v50, v51
    v_lshlrev_b32 v50, 16, v8
    v_and_b32 v51, 0xffff0000, v8
    v_pk_mul_f32 v[50:51], v[50:51], v[66:67] op_sel_hi:[1,0]
    v_cvt_pk_bf16_f32 v21, v50, v51
    buffer_store_dwordx2 v[20:21], v6, s[44:47], s50 offen
    s_add_u32 s50, s50, 4096
    v_pk_add_f32 v[52:53], v[52:53], v[64:65] op_sel_hi:[1,0] neg_lo:[0,1] neg_hi:[0,1]
    v_cvt_pk_bf16_f32 v8, v52, v53
    v_lshlrev_b32 v52, 16, v8
    v_and_b32 v53, 0xffff0000, v8
    v_pk_mul_f32 v[52:53], v[52:53], v[66:67] op_sel_hi:[1,0]
    v_cvt_pk_bf16_f32 v22, v52, v53
    v_pk_add_f32 v[54:55], v[54:55], v[64:65] op_sel_hi:[1,0] neg_lo:[0,1] neg_hi:[0,1]
    v_cvt_pk_bf16_f32 v8, v54, v55
    v_lshlrev_b32 v54, 16, v8
    v_and_b32 v55, 0xffff0000, v8
    v_pk_mul_f32 v[54:55], v[54:55], v[66:67] op_sel_hi:[1,0]
    v_cvt_pk_bf16_f32 v23, v54, v55
    buffer_store_dwordx2 v[22:23], v6, s[44:47], s50 offen
    s_add_u32 s50, s50, 4096
    v_pk_add_f32 v[56:57], v[56:57], v[64:65] op_sel_hi:[1,0] neg_lo:[0,1] neg_hi:[0,1]
    v_cvt_pk_bf16_f32 v8, v56, v57
    v_lshlrev_b32 v56, 16, v8
    v_and_b32 v57, 0xffff0000, v8
    v_pk_mul_f32 v[56:57], v[56:57], v[66:67] op_sel_hi:[1,0]
    v_cvt_pk_bf16_f32 v24, v56, v57
    v_pk_add_f32 v[58:59], v[58:59], v[64:65] op_sel_hi:[1,0] neg_lo:[0,1] neg_hi:[0,1]
    v_cvt_pk_bf16_f32 v8, v58, v59
    v_lshlrev_b32 v58, 16, v8
    v_and_b32 v59, 0xffff0000, v8
    v_pk_mul_f32 v[58:59], v[58:59], v[66:67] op_sel_hi:[1,0]
    v_cvt_pk_bf16_f32 v25, v58, v59
    buffer_store_dwordx2 v[24:25], v6, s[44:47], s50 offen
    s_add_u32 s50, s50, 4096
    v_pk_add_f32 v[60:61], v[60:61], v[64:65] op_sel_hi:[1,0] neg_lo:[0,1] neg_hi:[0,1]
    v_cvt_pk_bf16_f32 v8, v60, v61
    v_lshlrev_b32 v60, 16, v8
    v_and_b32 v61, 0xffff0000, v8
    v_pk_mul_f32 v[60:61], v[60:61], v[66:67] op_sel_hi:[1,0]
    v_cvt_pk_bf16_f32 v26, v60, v61
    v_pk_add_f32 v[62:63], v[62:63], v[64:65] op_sel_hi:[1,0] neg_lo:[0,1] neg_hi:[0,1]
    v_cvt_pk_bf16_f32 v8, v62, v63
    v_lshlrev_b32 v62, 16, v8
    v_and_b32 v63, 0xffff0000, v8
    v_pk_mul_f32 v[62:63], v[62:63], v[66:67] op_sel_hi:[1,0]
    v_cvt_pk_bf16_f32 v27, v62, v63
    buffer_store_dwordx2 v[26:27], v6, s[44:47], s50 offen
    s_add_u32 s48, s48, 4
    s_endpgm
K1_PACK:
    s_sub_u32 s49, s2, 240
    s_lshl_b32 s49, s49, 2
    s_add_u32 s49, s49, s48
    s_mul_i32 s50, s49, 911
    s_lshr_b32 s50, s50, 15
    s_mul_i32 s51, s50, 36
    s_sub_u32 s51, s49, s51
    v_and_b32 v3, 31, v1
    v_lshrrev_b32 v4, 5, v1
    s_lshl_b32 s52, s49, 10
    s_add_u32 s52, s52, 4194304
    v_lshlrev_b32 v8, 4, v1
    s_lshl_b32 s53, s50, 5
    v_add_u32 v6, s53, v3
    v_mul_u32_u24 v7, 3277, v6
    v_lshrrev_b32 v7, 16, v7
    v_mul_u32_u24 v5, 20, v7
    v_sub_u32 v6, v6, v5
    v_mul_u32_u24 v5, 18, v7
    v_add_u32 v5, v5, v6
    s_cmp_ge_u32 s50, 20
    s_cselect_b64 s[54:55], -1, 0
    s_movk_i32 s56, 1152
    s_cselect_b32 s56, 36, s56
    s_mov_b32 s57, 663552
    s_cselect_b32 s57, 20736, s57
    v_cndmask_b32 v5, v5, v3, s[54:55]
    v_cndmask_b32 v6, v6, v3, s[54:55]
    v_lshlrev_b32 v5, 1, v5
    s_lshl_b32 s58, s56, 3
    v_mul_lo_u32 v7, v4, s58
    v_add_u32 v5, v5, v7
    v_mov_b32 v7, 1073741824
    v_cmp_gt_u32 vcc, 18, v6
    s_nop 1
    v_cndmask_b32 v5, v7, v5, vcc
    s_mul_i32 s59, s51, s56
    s_lshl_b32 s59, s59, 4
    s_mul_i32 s60, s56, 9
    s_waitcnt lgkmcnt(0)
    s_mov_b32 s20, s6
    s_mov_b32 s21, s7
    s_cmp_eq_u32 s50, 20
    s_cselect_b32 s20, s8, s20
    s_cselect_b32 s21, s9, s21
    s_cmp_eq_u32 s50, 21
    s_cselect_b32 s20, s10, s20
    s_cselect_b32 s21, s11, s21
    s_mov_b32 s22, s57
    s_mov_b32 s23, 0x00020000
    buffer_load_ushort v12, v5, s[20:23], s59 offen
    s_add_u32 s59, s59, s56
    buffer_load_ushort v13, v5, s[20:23], s59 offen
    s_add_u32 s59, s59, s56
    buffer_load_ushort v14, v5, s[20:23], s59 offen
    s_add_u32 s59, s59, s56
    buffer_load_ushort v15, v5, s[20:23], s59 offen
    s_add_u32 s59, s59, s56
    buffer_load_ushort v16, v5, s[20:23], s59 offen
    s_add_u32 s59, s59, s56
    buffer_load_ushort v17, v5, s[20:23], s59 offen
    s_add_u32 s59, s59, s56
    buffer_load_ushort v18, v5, s[20:23], s59 offen
    s_add_u32 s59, s59, s56
    buffer_load_ushort v19, v5, s[20:23], s59 offen
    s_add_u32 s59, s59, s60
    s_mov_b32 s44, s16
    s_mov_b32 s45, s17
    s_mov_b32 s46, 268435456
    s_mov_b32 s47, 0x00020000
    s_waitcnt vmcnt(0)
    v_lshl_or_b32 v36, v13, 16, v12
    v_lshl_or_b32 v37, v15, 16, v14
    v_lshl_or_b32 v38, v17, 16, v16
    v_lshl_or_b32 v39, v19, 16, v18
    buffer_store_dwordx4 v[36:39], v8, s[44:47], s52 offen offset:0
    s_add_u32 s48, s48, 8
    s_endpgm
K1_PF:
    s_load_dwordx2 s[16:17], s[0:1], 104
    v_mov_b32 v12, 0
    v_mov_b32 v13, 0
    v_mov_b32 v14, 0
    v_mov_b32 v15, 0
    v_lshlrev_b32 v10, 4, v0
    s_sub_u32 s18, s2, 438
    s_lshl_b32 s18, s18, 12
    s_add_u32 s18, s18, 20709376
    s_waitcnt lgkmcnt(0)
    s_mov_b32 s44, s16
    s_mov_b32 s45, s17
    s_mov_b32 s46, 268435456
    s_mov_b32 s47, 0x00020000
    buffer_store_dwordx4 v[12:15], v10, s[44:47], s18 offen sc1
    s_getpc_b64 s[4:5]
K1_PF2:
    s_mov_b32 s6, TEXT_END-K1_PF2
    s_mov_b32 s7, 0x00020000
    v_lshlrev_b32 v2, 4, v0
    buffer_load_dwordx4 v[4:7], v2, s[4:7], 0 offen
    v_add_u32 v2, 4096, v2
    buffer_load_dwordx4 v[4:7], v2, s[4:7], 0 offen
    v_add_u32 v2, 4096, v2
    buffer_load_dwordx4 v[4:7], v2, s[4:7], 0 offen
    v_add_u32 v2, 4096, v2
    buffer_load_dwordx4 v[4:7], v2, s[4:7], 0 offen
    v_add_u32 v2, 4096, v2
    buffer_load_dwordx4 v[4:7], v2, s[4:7], 0 offen
    v_add_u32 v2, 4096, v2
    buffer_load_dwordx4 v[4:7], v2, s[4:7], 0 offen
    v_add_u32 v2, 4096, v2
    buffer_load_dwordx4 v[4:7], v2, s[4:7], 0 offen
    v_add_u32 v2, 4096, v2
    buffer_load_dwordx4 v[4:7], v2, s[4:7], 0 offen
    v_add_u32 v2, 4096, v2
    buffer_load_dwordx4 v[4:7], v2, s[4:7], 0 offen
    v_add_u32 v2, 4096, v2
    buffer_load_dwordx4 v[4:7], v2, s[4:7], 0 offen
    v_add_u32 v2, 4096, v2
    buffer_load_dwordx4 v[4:7], v2, s[4:7], 0 offen
    v_add_u32 v2, 4096, v2
    buffer_load_dwordx4 v[4:7], v2, s[4:7], 0 offen
    v_add_u32 v2, 4096, v2
    buffer_load_dwordx4 v[4:7], v2, s[4:7], 0 offen
    v_add_u32 v2, 4096, v2
    buffer_load_dwordx4 v[4:7], v2, s[4:7], 0 offen
    v_add_u32 v2, 4096, v2
    buffer_load_dwordx4 v[4:7], v2, s[4:7], 0 offen
    v_add_u32 v2, 4096, v2
    buffer_load_dwordx4 v[4:7], v2, s[4:7], 0 offen
    s_waitcnt vmcnt(0)
K1_END:
    s_endpgm
.globl k2_qkv_kernel
.p2align 8
.type k2_qkv_kernel,@function
k2_qkv_kernel:
    s_cmp_ge_u32 s2, 256
    s_cbranch_scc1 K2_END
    s_cmp_ge_u32 s2, 16
    s_cbranch_scc1 K2_NOPF
    s_getpc_b64 s[32:33]
K2_PF:
    s_mov_b32 s34, TEXT_END-K2_PF
    s_mov_b32 s35, 0x00020000
    v_lshlrev_b32 v200, 4, v0
    buffer_load_dwordx4 v[202:205], v200, s[32:35], 0 offen
    v_add_u32 v200, 4096, v200
    buffer_load_dwordx4 v[202:205], v200, s[32:35], 0 offen
    v_add_u32 v200, 4096, v200
    buffer_load_dwordx4 v[202:205], v200, s[32:35], 0 offen
K2_NOPF:
    s_load_dwordx2 s[4:5], s[0:1], 104
    v_lshrrev_b32 v4, 6, v0
    s_nop 0
    v_readfirstlane_b32 s12, v4
    v_and_b32 v0, 63, v0
    v_lshlrev_b32 v1, 4, v0
    s_and_b32 s13, s2, 7
    s_lshr_b32 s14, s2, 3
    s_lshr_b32 s15, s14, 3
    s_lshl_b32 s13, s13, 2
    s_add_u32 s13, s13, s15
    s_and_b32 s14, s14, 7
    s_mul_i32 s15, s14, 3
    s_mul_i32 s17, s12, 9216
    s_mul_i32 s16, s13, 73728
    s_add_u32 s16, s16, s17
    s_add_u32 s16, s16, 1048576
    s_add_u32 s18, s16, 36864
    s_mul_i32 s21, s15, 36864
    s_add_u32 s21, s21, s17
    s_add_u32 s21, s21, 4194304
    s_add_u32 s22, s21, 36864
    s_add_u32 s23, s21, 73728
    s_lshl_b32 s19, s12, 11
    s_add_u32 s19, s19, 98304
    s_mul_i32 s20, s12, 576
    s_add_u32 s20, s20, 0
    s_waitcnt lgkmcnt(0)
    s_mov_b32 s8, s4
    s_mov_b32 s9, s5
    s_mov_b32 s10, 268435456
    s_mov_b32 s11, 0x00020000
    s_cmp_eq_u32 s14, 7
    s_cbranch_scc1 K2_V
    s_mov_b32 m0, s19
    s_add_u32 s24, s20, 1280
    buffer_load_dwordx4 v1, s[8:11], s20 offen lds
    buffer_load_dwordx4 v1, s[8:11], s24 offen offset:1024 lds
    buffer_load_dwordx4 v[12:15], v1, s[8:11], s16 offen offset:0
    buffer_load_dwordx4 v[16:19], v1, s[8:11], s18 offen offset:0
    buffer_load_dwordx4 a[0:3], v1, s[8:11], s21 offen offset:0
    buffer_load_dwordx4 a[4:7], v1, s[8:11], s22 offen offset:0
    buffer_load_dwordx4 a[8:11], v1, s[8:11], s23 offen offset:0
    buffer_load_dwordx4 v[20:23], v1, s[8:11], s16 offen offset:1024
    buffer_load_dwordx4 v[24:27], v1, s[8:11], s18 offen offset:1024
    buffer_load_dwordx4 a[12:15], v1, s[8:11], s21 offen offset:1024
    buffer_load_dwordx4 a[16:19], v1, s[8:11], s22 offen offset:1024
    buffer_load_dwordx4 a[20:23], v1, s[8:11], s23 offen offset:1024
    buffer_load_dwordx4 v[28:31], v1, s[8:11], s16 offen offset:2048
    buffer_load_dwordx4 v[32:35], v1, s[8:11], s18 offen offset:2048
    buffer_load_dwordx4 a[24:27], v1, s[8:11], s21 offen offset:2048
    buffer_load_dwordx4 a[28:31], v1, s[8:11], s22 offen offset:2048
    buffer_load_dwordx4 a[32:35], v1, s[8:11], s23 offen offset:2048
    buffer_load_dwordx4 v[36:39], v1, s[8:11], s16 offen offset:3072
    buffer_load_dwordx4 v[40:43], v1, s[8:11], s18 offen offset:3072
    buffer_load_dwordx4 a[36:39], v1, s[8:11], s21 offen offset:3072
    buffer_load_dwordx4 a[40:43], v1, s[8:11], s22 offen offset:3072
    buffer_load_dwordx4 a[44:47], v1, s[8:11], s23 offen offset:3072
    s_add_u32 s16, s16, 4096
    s_add_u32 s18, s18, 4096
    s_add_u32 s21, s21, 4096
    s_add_u32 s22, s22, 4096
    s_add_u32 s23, s23, 4096
    v_lshrrev_b32 v2, 5, v0
    v_and_b32 v3, 31, v0
    v_lshlrev_b32 v7, 5, v2
    v_add_u32 v7, s19, v7
    s_mul_i32 s25, s12, 6144
    v_add_u32 v8, s25, v1
    s_mul_i32 s25, s12, 24576
    v_add_u32 v9, s25, v1
    s_mov_b32 s26, 0x3eae1a93
    s_mov_b32 s27, 0x3eae1a93
    s_lshl_b32 s28, s15, 3
    s_lshl_b32 s29, s12, 1
    s_add_u32 s28, s28, s29
    s_mul_i32 s29, s13, 2560
    s_add_u32 s29, s29, 5242880
    v_add_u32 v4, s28, v2
    v_mul_u32_u24 v5, 205, v4
    v_lshrrev_b32 v5, 10, v5
    v_mul_u32_u24 v6, 5, v5
    v_sub_u32 v4, v4, v6
    v_mul_u32_u24 v220, 81920, v5
    v_lshrrev_b32 v6, 1, v4
    v_lshl_add_u32 v220, v6, 9, v220
    v_and_b32 v6, 1, v4
    v_lshl_add_u32 v220, v6, 3, v220
    v_lshlrev_b32 v5, 4, v3
    v_lshlrev_b32 v6, 3, v3
    v_cmp_eq_u32 vcc, 4, v4
    s_nop 1
    v_cndmask_b32 v5, v5, v6, vcc
    v_add_u32 v220, v220, v5
    v_add_u32 v4, s28, v2
    v_add_u32 v4, 8, v4
    v_mul_u32_u24 v5, 205, v4
    v_lshrrev_b32 v5, 10, v5
    v_mul_u32_u24 v6, 5, v5
    v_sub_u32 v4, v4, v6
    v_mul_u32_u24 v221, 81920, v5
    v_lshrrev_b32 v6, 1, v4
    v_lshl_add_u32 v221, v6, 9, v221
    v_and_b32 v6, 1, v4
    v_lshl_add_u32 v221, v6, 3, v221
    v_lshlrev_b32 v5, 4, v3
    v_lshlrev_b32 v6, 3, v3
    v_cmp_eq_u32 vcc, 4, v4
    s_nop 1
    v_cndmask_b32 v5, v5, v6, vcc
    v_add_u32 v221, v221, v5
    v_add_u32 v4, s28, v2
    v_add_u32 v4, 16, v4
    v_mul_u32_u24 v5, 205, v4
    v_lshrrev_b32 v5, 10, v5
    v_mul_u32_u24 v6, 5, v5
    v_sub_u32 v4, v4, v6
    v_mul_u32_u24 v222, 81920, v5
    v_lshrrev_b32 v6, 1, v4
    v_lshl_add_u32 v222, v6, 9, v222
    v_and_b32 v6, 1, v4
    v_lshl_add_u32 v222, v6, 3, v222
    v_lshlrev_b32 v5, 4, v3
    v_lshlrev_b32 v6, 3, v3
    v_cmp_eq_u32 vcc, 4, v4
    s_nop 1
    v_cndmask_b32 v5, v5, v6, vcc
    v_add_u32 v222, v222, v5
    s_waitcnt vmcnt(20)
    ds_read_b128 v[180:183], v7 offset:0
    ds_read_b128 v[188:191], v7 offset:1024
    ds_read_b128 v[184:187], v7 offset:16
    ds_read_b128 v[192:195], v7 offset:1040
    ds_read_b128 v[196:199], v7 offset:64
    ds_read_b128 v[204:207], v7 offset:1088
    ds_read_b128 v[200:203], v7 offset:80
    ds_read_b128 v[208:211], v7 offset:1104
    s_waitcnt vmcnt(18) lgkmcnt(4)
    buffer_load_dwordx4 v[44:47], v1, s[8:11], s16 offen offset:0
    buffer_load_dwordx4 v[48:51], v1, s[8:11], s18 offen offset:0
    buffer_load_dwordx4 a[48:51], v1, s[8:11], s21 offen offset:0
    buffer_load_dwordx4 a[52:55], v1, s[8:11], s22 offen offset:0
    buffer_load_dwordx4 a[56:59], v1, s[8:11], s23 offen offset:0
    v_lshlrev_b32 v212, 16, v12
    v_and_b32 v213, 0xffff0000, v12
    v_lshlrev_b32 v214, 16, v13
    v_and_b32 v215, 0xffff0000, v13
    v_lshlrev_b32 v216, 16, v14
    v_and_b32 v217, 0xffff0000, v14
    v_lshlrev_b32 v218, 16, v15
    v_and_b32 v219, 0xffff0000, v15
    v_fma_f32 v212, v212, v188, v180
    v_fma_f32 v213, v213, v189, v181
    v_fma_f32 v214, v214, v190, v182
    v_fma_f32 v215, v215, v191, v183
    v_fma_f32 v216, v216, v192, v184
    v_fma_f32 v217, v217, v193, v185
    v_fma_f32 v218, v218, v194, v186
    v_fma_f32 v219, v219, v195, v187
    v_cvt_pk_bf16_f32 v12, v212, v213
    v_cvt_pk_bf16_f32 v13, v214, v215
    v_cvt_pk_bf16_f32 v14, v216, v217
    v_cvt_pk_bf16_f32 v15, v218, v219
    v_lshlrev_b32 v212, 16, v16
    v_and_b32 v213, 0xffff0000, v16
    v_lshlrev_b32 v214, 16, v17
    s_waitcnt vmcnt(20)
    v_mfma_f32_32x32x16_bf16 v[84:99], a[0:3], v[12:15], 0
    v_and_b32 v215, 0xffff0000, v17
    v_lshlrev_b32 v216, 16, v18
    v_and_b32 v217, 0xffff0000, v18
    v_lshlrev_b32 v218, 16, v19
    v_and_b32 v219, 0xffff0000, v19
    v_fma_f32 v212, v212, v188, v180
    v_mfma_f32_32x32x16_bf16 v[116:131], a[4:7], v[12:15], 0
    v_fma_f32 v213, v213, v189, v181
    v_fma_f32 v214, v214, v190, v182
    v_fma_f32 v215, v215, v191, v183
    v_fma_f32 v216, v216, v192, v184
    v_fma_f32 v217, v217, v193, v185
    v_fma_f32 v218, v218, v194, v186
    v_mfma_f32_32x32x16_bf16 v[148:163], a[8:11], v[12:15], 0
    v_fma_f32 v219, v219, v195, v187
    v_cvt_pk_bf16_f32 v16, v212, v213
    v_cvt_pk_bf16_f32 v17, v214, v215
    v_cvt_pk_bf16_f32 v18, v216, v217
    v_cvt_pk_bf16_f32 v19, v218, v219
    ds_read_b128 v[180:183], v7 offset:128
    ds_read_b128 v[188:191], v7 offset:1152
    ds_read_b128 v[184:187], v7 offset:144
    ds_read_b128 v[192:195], v7 offset:1168
    s_waitcnt vmcnt(18) lgkmcnt(4)
    buffer_load_dwordx4 v[52:55], v1, s[8:11], s16 offen offset:1024
    buffer_load_dwordx4 v[56:59], v1, s[8:11], s18 offen offset:1024
    buffer_load_dwordx4 a[60:63], v1, s[8:11], s21 offen offset:1024
    buffer_load_dwordx4 a[64:67], v1, s[8:11], s22 offen offset:1024
    buffer_load_dwordx4 a[68:71], v1, s[8:11], s23 offen offset:1024
    v_lshlrev_b32 v212, 16, v20
    v_and_b32 v213, 0xffff0000, v20
    v_lshlrev_b32 v214, 16, v21
    v_mfma_f32_32x32x16_bf16 v[100:115], a[0:3], v[16:19], 0
    v_and_b32 v215, 0xffff0000, v21
    v_lshlrev_b32 v216, 16, v22
    v_and_b32 v217, 0xffff0000, v22
    v_lshlrev_b32 v218, 16, v23
    v_and_b32 v219, 0xffff0000, v23
    v_fma_f32 v212, v212, v204, v196
    v_mfma_f32_32x32x16_bf16 v[132:147], a[4:7], v[16:19], 0
    v_fma_f32 v213, v213, v205, v197
    v_fma_f32 v214, v214, v206, v198
    v_fma_f32 v215, v215, v207, v199
    v_fma_f32 v216, v216, v208, v200
    v_fma_f32 v217, v217, v209, v201
    v_fma_f32 v218, v218, v210, v202
    v_mfma_f32_32x32x16_bf16 v[164:179], a[8:11], v[16:19], 0
    v_fma_f32 v219, v219, v211, v203
    v_cvt_pk_bf16_f32 v20, v212, v213
    v_cvt_pk_bf16_f32 v21, v214, v215
    v_cvt_pk_bf16_f32 v22, v216, v217
    v_cvt_pk_bf16_f32 v23, v218, v219
    v_lshlrev_b32 v212, 16, v24
    v_and_b32 v213, 0xffff0000, v24
    v_lshlrev_b32 v214, 16, v25
    s_waitcnt vmcnt(20)
    v_mfma_f32_32x32x16_bf16 v[84:99], a[12:15], v[20:23], v[84:99]
    v_and_b32 v215, 0xffff0000, v25
    v_lshlrev_b32 v216, 16, v26
    v_and_b32 v217, 0xffff0000, v26
    v_lshlrev_b32 v218, 16, v27
    v_and_b32 v219, 0xffff0000, v27
    v_fma_f32 v212, v212, v204, v196
    v_mfma_f32_32x32x16_bf16 v[116:131], a[16:19], v[20:23], v[116:131]
    v_fma_f32 v213, v213, v205, v197
    v_fma_f32 v214, v214, v206, v198
    v_fma_f32 v215, v215, v207, v199
    v_fma_f32 v216, v216, v208, v200
    v_fma_f32 v217, v217, v209, v201
    v_fma_f32 v218, v218, v210, v202
    v_mfma_f32_32x32x16_bf16 v[148:163], a[20:23], v[20:23], v[148:163]
    v_fma_f32 v219, v219, v211, v203
    v_cvt_pk_bf16_f32 v24, v212, v213
    v_cvt_pk_bf16_f32 v25, v214, v215
    v_cvt_pk_bf16_f32 v26, v216, v217
    v_cvt_pk_bf16_f32 v27, v218, v219
    ds_read_b128 v[196:199], v7 offset:192
    ds_read_b128 v[204:207], v7 offset:1216
    ds_read_b128 v[200:203], v7 offset:208
    ds_read_b128 v[208:211], v7 offset:1232
    s_waitcnt vmcnt(18) lgkmcnt(4)
    buffer_load_dwordx4 v[60:63], v1, s[8:11], s16 offen offset:2048
    buffer_load_dwordx4 v[64:67], v1, s[8:11], s18 offen offset:2048
    buffer_load_dwordx4 a[72:75], v1, s[8:11], s21 offen offset:2048
    buffer_load_dwordx4 a[76:79], v1, s[8:11], s22 offen offset:2048
    buffer_load_dwordx4 a[80:83], v1, s[8:11], s23 offen offset:2048
    v_lshlrev_b32 v212, 16, v28
    v_and_b32 v213, 0xffff0000, v28
    v_lshlrev_b32 v214, 16, v29
    v_mfma_f32_32x32x16_bf16 v[100:115], a[12:15], v[24:27], v[100:115]
    v_and_b32 v215, 0xffff0000, v29
    v_lshlrev_b32 v216, 16, v30
    v_and_b32 v217, 0xffff0000, v30
    v_lshlrev_b32 v218, 16, v31
    v_and_b32 v219, 0xffff0000, v31
    v_fma_f32 v212, v212, v188, v180
    v_mfma_f32_32x32x16_bf16 v[132:147], a[16:19], v[24:27], v[132:147]
    v_fma_f32 v213, v213, v189, v181
    v_fma_f32 v214, v214, v190, v182
    v_fma_f32 v215, v215, v191, v183
    v_fma_f32 v216, v216, v192, v184
    v_fma_f32 v217, v217, v193, v185
    v_fma_f32 v218, v218, v194, v186
    v_mfma_f32_32x32x16_bf16 v[164:179], a[20:23], v[24:27], v[164:179]
    v_fma_f32 v219, v219, v195, v187
    v_cvt_pk_bf16_f32 v28, v212, v213
    v_cvt_pk_bf16_f32 v29, v214, v215
    v_cvt_pk_bf16_f32 v30, v216, v217
    v_cvt_pk_bf16_f32 v31, v218, v219
    v_lshlrev_b32 v212, 16, v32
    v_and_b32 v213, 0xffff0000, v32
    v_lshlrev_b32 v214, 16, v33
    s_waitcnt vmcnt(20)
    v_mfma_f32_32x32x16_bf16 v[84:99], a[24:27], v[28:31], v[84:99]
    v_and_b32 v215, 0xffff0000, v33
    v_lshlrev_b32 v216, 16, v34
    v_and_b32 v217, 0xffff0000, v34
    v_lshlrev_b32 v218, 16, v35
    v_and_b32 v219, 0xffff0000, v35
    v_fma_f32 v212, v212, v188, v180
    v_mfma_f32_32x32x16_bf16 v[116:131], a[28:31], v[28:31], v[116:131]
    v_fma_f32 v213, v213, v189, v181
    v_fma_f32 v214, v214, v190, v182
    v_fma_f32 v215, v215, v191, v183
    v_fma_f32 v216, v216, v192, v184
    v_fma_f32 v217, v217, v193, v185
    v_fma_f32 v218, v218, v194, v186
    v_mfma_f32_32x32x16_bf16 v[148:163], a[32:35], v[28:31], v[148:163]
    v_fma_f32 v219, v219, v195, v187
    v_cvt_pk_bf16_f32 v32, v212, v213
    v_cvt_pk_bf16_f32 v33, v214, v215
    v_cvt_pk_bf16_f32 v34, v216, v217
    v_cvt_pk_bf16_f32 v35, v218, v219
    ds_read_b128 v[180:183], v7 offset:256
    ds_read_b128 v[188:191], v7 offset:1280
    ds_read_b128 v[184:187], v7 offset:272
    ds_read_b128 v[192:195], v7 offset:1296
    s_waitcnt vmcnt(18) lgkmcnt(4)
    buffer_load_dwordx4 v[68:71], v1, s[8:11], s16 offen offset:3072
    buffer_load_dwordx4 v[72:75], v1, s[8:11], s18 offen offset:3072
    buffer_load_dwordx4 a[84:87], v1, s[8:11], s21 offen offset:3072
    buffer_load_dwordx4 a[88:91], v1, s[8:11], s22 offen offset:3072
    buffer_load_dwordx4 a[92:95], v1, s[8:11], s23 offen offset:3072
    s_add_u32 s16, s16, 4096
    s_add_u32 s18, s18, 4096
    s_add_u32 s21, s21, 4096
    s_add_u32 s22, s22, 4096
    s_add_u32 s23, s23, 4096
    v_lshlrev_b32 v212, 16, v36
    v_and_b32 v213, 0xffff0000, v36
    v_lshlrev_b32 v214, 16, v37
    v_mfma_f32_32x32x16_bf16 v[100:115], a[24:27], v[32:35], v[100:115]
    v_and_b32 v215, 0xffff0000, v37
    v_lshlrev_b32 v216, 16, v38
    v_and_b32 v217, 0xffff0000, v38
    v_lshlrev_b32 v218, 16, v39
    v_and_b32 v219, 0xffff0000, v39
    v_fma_f32 v212, v212, v204, v196
    v_mfma_f32_32x32x16_bf16 v[132:147], a[28:31], v[32:35], v[132:147]
    v_fma_f32 v213, v213, v205, v197
    v_fma_f32 v214, v214, v206, v198
    v_fma_f32 v215, v215, v207, v199
    v_fma_f32 v216, v216, v208, v200
    v_fma_f32 v217, v217, v209, v201
    v_fma_f32 v218, v218, v210, v202
    v_mfma_f32_32x32x16_bf16 v[164:179], a[32:35], v[32:35], v[164:179]
    v_fma_f32 v219, v219, v211, v203
    v_cvt_pk_bf16_f32 v36, v212, v213
    v_cvt_pk_bf16_f32 v37, v214, v215
    v_cvt_pk_bf16_f32 v38, v216, v217
    v_cvt_pk_bf16_f32 v39, v218, v219
    v_lshlrev_b32 v212, 16, v40
    v_and_b32 v213, 0xffff0000, v40
    v_lshlrev_b32 v214, 16, v41
    s_waitcnt vmcnt(20)
    v_mfma_f32_32x32x16_bf16 v[84:99], a[36:39], v[36:39], v[84:99]
    v_and_b32 v215, 0xffff0000, v41
    v_lshlrev_b32 v216, 16, v42
    v_and_b32 v217, 0xffff0000, v42
    v_lshlrev_b32 v218, 16, v43
    v_and_b32 v219, 0xffff0000, v43
    v_fma_f32 v212, v212, v204, v196
    v_mfma_f32_32x32x16_bf16 v[116:131], a[40:43], v[36:39], v[116:131]
    v_fma_f32 v213, v213, v205, v197
    v_fma_f32 v214, v214, v206, v198
    v_fma_f32 v215, v215, v207, v199
    v_fma_f32 v216, v216, v208, v200
    v_fma_f32 v217, v217, v209, v201
    v_fma_f32 v218, v218, v210, v202
    v_mfma_f32_32x32x16_bf16 v[148:163], a[44:47], v[36:39], v[148:163]
    v_fma_f32 v219, v219, v211, v203
    v_cvt_pk_bf16_f32 v40, v212, v213
    v_cvt_pk_bf16_f32 v41, v214, v215
    v_cvt_pk_bf16_f32 v42, v216, v217
    v_cvt_pk_bf16_f32 v43, v218, v219
    ds_read_b128 v[196:199], v7 offset:320
    ds_read_b128 v[204:207], v7 offset:1344
    ds_read_b128 v[200:203], v7 offset:336
    ds_read_b128 v[208:211], v7 offset:1360
    s_waitcnt vmcnt(18) lgkmcnt(4)
    buffer_load_dwordx4 v[76:79], v1, s[8:11], s16 offen offset:0
    buffer_load_dwordx4 v[80:83], v1, s[8:11], s18 offen offset:0
    buffer_load_dwordx4 a[96:99], v1, s[8:11], s21 offen offset:0
    buffer_load_dwordx4 a[100:103], v1, s[8:11], s22 offen offset:0
    buffer_load_dwordx4 a[104:107], v1, s[8:11], s23 offen offset:0
    v_lshlrev_b32 v212, 16, v44
    v_and_b32 v213, 0xffff0000, v44
    v_lshlrev_b32 v214, 16, v45
    v_mfma_f32_32x32x16_bf16 v[100:115], a[36:39], v[40:43], v[100:115]
    v_and_b32 v215, 0xffff0000, v45
    v_lshlrev_b32 v216, 16, v46
    v_and_b32 v217, 0xffff0000, v46
    v_lshlrev_b32 v218, 16, v47
    v_and_b32 v219, 0xffff0000, v47
    v_fma_f32 v212, v212, v188, v180
    v_mfma_f32_32x32x16_bf16 v[132:147], a[40:43], v[40:43], v[132:147]
    v_fma_f32 v213, v213, v189, v181
    v_fma_f32 v214, v214, v190, v182
    v_fma_f32 v215, v215, v191, v183
    v_fma_f32 v216, v216, v192, v184
    v_fma_f32 v217, v217, v193, v185
    v_fma_f32 v218, v218, v194, v186
    v_mfma_f32_32x32x16_bf16 v[164:179], a[44:47], v[40:43], v[164:179]
    v_fma_f32 v219, v219, v195, v187
    v_cvt_pk_bf16_f32 v44, v212, v213
    v_cvt_pk_bf16_f32 v45, v214, v215
    v_cvt_pk_bf16_f32 v46, v216, v217
    v_cvt_pk_bf16_f32 v47, v218, v219
    v_lshlrev_b32 v212, 16, v48
    v_and_b32 v213, 0xffff0000, v48
    v_lshlrev_b32 v214, 16, v49
    s_waitcnt vmcnt(20)
    v_mfma_f32_32x32x16_bf16 v[84:99], a[48:51], v[44:47], v[84:99]
    v_and_b32 v215, 0xffff0000, v49
    v_lshlrev_b32 v216, 16, v50
    v_and_b32 v217, 0xffff0000, v50
    v_lshlrev_b32 v218, 16, v51
    v_and_b32 v219, 0xffff0000, v51
    v_fma_f32 v212, v212, v188, v180
    v_mfma_f32_32x32x16_bf16 v[116:131], a[52:55], v[44:47], v[116:131]
    v_fma_f32 v213, v213, v189, v181
    v_fma_f32 v214, v214, v190, v182
    v_fma_f32 v215, v215, v191, v183
    v_fma_f32 v216, v216, v192, v184
    v_fma_f32 v217, v217, v193, v185
    v_fma_f32 v218, v218, v194, v186
    v_mfma_f32_32x32x16_bf16 v[148:163], a[56:59], v[44:47], v[148:163]
    v_fma_f32 v219, v219, v195, v187
    v_cvt_pk_bf16_f32 v48, v212, v213
    v_cvt_pk_bf16_f32 v49, v214, v215
    v_cvt_pk_bf16_f32 v50, v216, v217
    v_cvt_pk_bf16_f32 v51, v218, v219
    ds_read_b128 v[180:183], v7 offset:384
    ds_read_b128 v[188:191], v7 offset:1408
    ds_read_b128 v[184:187], v7 offset:400
    ds_read_b128 v[192:195], v7 offset:1424
    s_waitcnt vmcnt(18) lgkmcnt(4)
    v_lshlrev_b32 v212, 16, v52
    v_and_b32 v213, 0xffff0000, v52
    v_lshlrev_b32 v214, 16, v53
    v_mfma_f32_32x32x16_bf16 v[100:115], a[48:51], v[48:51], v[100:115]
    v_and_b32 v215, 0xffff0000, v53
    v_lshlrev_b32 v216, 16, v54
    v_and_b32 v217, 0xffff0000, v54
    v_lshlrev_b32 v218, 16, v55
    v_and_b32 v219, 0xffff0000, v55
    v_fma_f32 v212, v212, v204, v196
    v_mfma_f32_32x32x16_bf16 v[132:147], a[52:55], v[48:51], v[132:147]
    v_fma_f32 v213, v213, v205, v197
    v_fma_f32 v214, v214, v206, v198
    v_fma_f32 v215, v215, v207, v199
    v_fma_f32 v216, v216, v208, v200
    v_fma_f32 v217, v217, v209, v201
    v_fma_f32 v218, v218, v210, v202
    v_mfma_f32_32x32x16_bf16 v[164:179], a[56:59], v[48:51], v[164:179]
    v_fma_f32 v219, v219, v211, v203
    v_cvt_pk_bf16_f32 v52, v212, v213
    v_cvt_pk_bf16_f32 v53, v214, v215
    v_cvt_pk_bf16_f32 v54, v216, v217
    v_cvt_pk_bf16_f32 v55, v218, v219
    v_lshlrev_b32 v212, 16, v56
    v_and_b32 v213, 0xffff0000, v56
    v_lshlrev_b32 v214, 16, v57
    s_waitcnt vmcnt(15)
    v_mfma_f32_32x32x16_bf16 v[84:99], a[60:63], v[52:55], v[84:99]
    v_and_b32 v215, 0xffff0000, v57
    v_lshlrev_b32 v216, 16, v58
    v_and_b32 v217, 0xffff0000, v58
    v_lshlrev_b32 v218, 16, v59
    v_and_b32 v219, 0xffff0000, v59
    v_fma_f32 v212, v212, v204, v196
    v_mfma_f32_32x32x16_bf16 v[116:131], a[64:67], v[52:55], v[116:131]
    v_fma_f32 v213, v213, v205, v197
    v_fma_f32 v214, v214, v206, v198
    v_fma_f32 v215, v215, v207, v199
    v_fma_f32 v216, v216, v208, v200
    v_fma_f32 v217, v217, v209, v201
    v_fma_f32 v218, v218, v210, v202
    v_mfma_f32_32x32x16_bf16 v[148:163], a[68:71], v[52:55], v[148:163]
    v_fma_f32 v219, v219, v211, v203
    v_cvt_pk_bf16_f32 v56, v212, v213
    v_cvt_pk_bf16_f32 v57, v214, v215
    v_cvt_pk_bf16_f32 v58, v216, v217
    v_cvt_pk_bf16_f32 v59, v218, v219
    ds_read_b128 v[196:199], v7 offset:448
    ds_read_b128 v[204:207], v7 offset:1472
    ds_read_b128 v[200:203], v7 offset:464
    ds_read_b128 v[208:211], v7 offset:1488
    s_waitcnt vmcnt(13) lgkmcnt(4)
    v_lshlrev_b32 v212, 16, v60
    v_and_b32 v213, 0xffff0000, v60
    v_lshlrev_b32 v214, 16, v61
    v_mfma_f32_32x32x16_bf16 v[100:115], a[60:63], v[56:59], v[100:115]
    v_and_b32 v215, 0xffff0000, v61
    v_lshlrev_b32 v216, 16, v62
    v_and_b32 v217, 0xffff0000, v62
    v_lshlrev_b32 v218, 16, v63
    v_and_b32 v219, 0xffff0000, v63
    v_fma_f32 v212, v212, v188, v180
    v_mfma_f32_32x32x16_bf16 v[132:147], a[64:67], v[56:59], v[132:147]
    v_fma_f32 v213, v213, v189, v181
    v_fma_f32 v214, v214, v190, v182
    v_fma_f32 v215, v215, v191, v183
    v_fma_f32 v216, v216, v192, v184
    v_fma_f32 v217, v217, v193, v185
    v_fma_f32 v218, v218, v194, v186
    v_mfma_f32_32x32x16_bf16 v[164:179], a[68:71], v[56:59], v[164:179]
    v_fma_f32 v219, v219, v195, v187
    v_cvt_pk_bf16_f32 v60, v212, v213
    v_cvt_pk_bf16_f32 v61, v214, v215
    v_cvt_pk_bf16_f32 v62, v216, v217
    v_cvt_pk_bf16_f32 v63, v218, v219
    v_lshlrev_b32 v212, 16, v64
    v_and_b32 v213, 0xffff0000, v64
    v_lshlrev_b32 v214, 16, v65
    s_waitcnt vmcnt(10)
    v_mfma_f32_32x32x16_bf16 v[84:99], a[72:75], v[60:63], v[84:99]
    v_and_b32 v215, 0xffff0000, v65
    v_lshlrev_b32 v216, 16, v66
    v_and_b32 v217, 0xffff0000, v66
    v_lshlrev_b32 v218, 16, v67
    v_and_b32 v219, 0xffff0000, v67
    v_fma_f32 v212, v212, v188, v180
    v_mfma_f32_32x32x16_bf16 v[116:131], a[76:79], v[60:63], v[116:131]
    v_fma_f32 v213, v213, v189, v181
    v_fma_f32 v214, v214, v190, v182
    v_fma_f32 v215, v215, v191, v183
    v_fma_f32 v216, v216, v192, v184
    v_fma_f32 v217, v217, v193, v185
    v_fma_f32 v218, v218, v194, v186
    v_mfma_f32_32x32x16_bf16 v[148:163], a[80:83], v[60:63], v[148:163]
    v_fma_f32 v219, v219, v195, v187
    v_cvt_pk_bf16_f32 v64, v212, v213
    v_cvt_pk_bf16_f32 v65, v214, v215
    v_cvt_pk_bf16_f32 v66, v216, v217
    v_cvt_pk_bf16_f32 v67, v218, v219
    ds_read_b128 v[180:183], v7 offset:512
    ds_read_b128 v[188:191], v7 offset:1536
    ds_read_b128 v[184:187], v7 offset:528
    ds_read_b128 v[192:195], v7 offset:1552
    s_waitcnt vmcnt(8) lgkmcnt(4)
    v_lshlrev_b32 v212, 16, v68
    v_and_b32 v213, 0xffff0000, v68
    v_lshlrev_b32 v214, 16, v69
    v_mfma_f32_32x32x16_bf16 v[100:115], a[72:75], v[64:67], v[100:115]
    v_and_b32 v215, 0xffff0000, v69
    v_lshlrev_b32 v216, 16, v70
    v_and_b32 v217, 0xffff0000, v70
    v_lshlrev_b32 v218, 16, v71
    v_and_b32 v219, 0xffff0000, v71
    v_fma_f32 v212, v212, v204, v196
    v_mfma_f32_32x32x16_bf16 v[132:147], a[76:79], v[64:67], v[132:147]
    v_fma_f32 v213, v213, v205, v197
    v_fma_f32 v214, v214, v206, v198
    v_fma_f32 v215, v215, v207, v199
    v_fma_f32 v216, v216, v208, v200
    v_fma_f32 v217, v217, v209, v201
    v_fma_f32 v218, v218, v210, v202
    v_mfma_f32_32x32x16_bf16 v[164:179], a[80:83], v[64:67], v[164:179]
    v_fma_f32 v219, v219, v211, v203
    v_cvt_pk_bf16_f32 v68, v212, v213
    v_cvt_pk_bf16_f32 v69, v214, v215
    v_cvt_pk_bf16_f32 v70, v216, v217
    v_cvt_pk_bf16_f32 v71, v218, v219
    v_lshlrev_b32 v212, 16, v72
    v_and_b32 v213, 0xffff0000, v72
    v_lshlrev_b32 v214, 16, v73
    s_waitcnt vmcnt(5)
    v_mfma_f32_32x32x16_bf16 v[84:99], a[84:87], v[68:71], v[84:99]
    v_and_b32 v215, 0xffff0000, v73
    v_lshlrev_b32 v216, 16, v74
    v_and_b32 v217, 0xffff0000, v74
    v_lshlrev_b32 v218, 16, v75
    v_and_b32 v219, 0xffff0000, v75
    v_fma_f32 v212, v212, v204, v196
    v_mfma_f32_32x32x16_bf16 v[116:131], a[88:91], v[68:71], v[116:131]
    v_fma_f32 v213, v213, v205, v197
    v_fma_f32 v214, v214, v206, v198
    v_fma_f32 v215, v215, v207, v199
    v_fma_f32 v216, v216, v208, v200
    v_fma_f32 v217, v217, v209, v201
    v_fma_f32 v218, v218, v210, v202
    v_mfma_f32_32x32x16_bf16 v[148:163], a[92:95], v[68:71], v[148:163]
    v_fma_f32 v219, v219, v211, v203
    v_cvt_pk_bf16_f32 v72, v212, v213
    v_cvt_pk_bf16_f32 v73, v214, v215
    v_cvt_pk_bf16_f32 v74, v216, v217
    v_cvt_pk_bf16_f32 v75, v218, v219
    s_waitcnt vmcnt(3) lgkmcnt(0)
    v_lshlrev_b32 v212, 16, v76
    v_and_b32 v213, 0xffff0000, v76
    v_lshlrev_b32 v214, 16, v77
    v_mfma_f32_32x32x16_bf16 v[100:115], a[84:87], v[72:75], v[100:115]
    v_and_b32 v215, 0xffff0000, v77
    v_lshlrev_b32 v216, 16, v78
    v_and_b32 v217, 0xffff0000, v78
    v_lshlrev_b32 v218, 16, v79
    v_and_b32 v219, 0xffff0000, v79
    v_fma_f32 v212, v212, v188, v180
    v_mfma_f32_32x32x16_bf16 v[132:147], a[88:91], v[72:75], v[132:147]
    v_fma_f32 v213, v213, v189, v181
    v_fma_f32 v214, v214, v190, v182
    v_fma_f32 v215, v215, v191, v183
    v_fma_f32 v216, v216, v192, v184
    v_fma_f32 v217, v217, v193, v185
    v_fma_f32 v218, v218, v194, v186
    v_mfma_f32_32x32x16_bf16 v[164:179], a[92:95], v[72:75], v[164:179]
    v_fma_f32 v219, v219, v195, v187
    v_cvt_pk_bf16_f32 v76, v212, v213
    v_cvt_pk_bf16_f32 v77, v214, v215
    v_cvt_pk_bf16_f32 v78, v216, v217
    v_cvt_pk_bf16_f32 v79, v218, v219
    v_lshlrev_b32 v212, 16, v80
    v_and_b32 v213, 0xffff0000, v80
    v_lshlrev_b32 v214, 16, v81
    s_waitcnt vmcnt(0)
    v_mfma_f32_32x32x16_bf16 v[84:99], a[96:99], v[76:79], v[84:99]
    v_and_b32 v215, 0xffff0000, v81
    v_lshlrev_b32 v216, 16, v82
    v_and_b32 v217, 0xffff0000, v82
    v_lshlrev_b32 v218, 16, v83
    v_and_b32 v219, 0xffff0000, v83
    v_fma_f32 v212, v212, v188, v180
    v_mfma_f32_32x32x16_bf16 v[116:131], a[100:103], v[76:79], v[116:131]
    v_fma_f32 v213, v213, v189, v181
    v_fma_f32 v214, v214, v190, v182
    v_fma_f32 v215, v215, v191, v183
    v_fma_f32 v216, v216, v192, v184
    v_fma_f32 v217, v217, v193, v185
    v_fma_f32 v218, v218, v194, v186
    v_mfma_f32_32x32x16_bf16 v[148:163], a[104:107], v[76:79], v[148:163]
    v_fma_f32 v219, v219, v195, v187
    v_cvt_pk_bf16_f32 v80, v212, v213
    v_cvt_pk_bf16_f32 v81, v214, v215
    v_cvt_pk_bf16_f32 v82, v216, v217
    v_cvt_pk_bf16_f32 v83, v218, v219
    s_nop 1
    v_mfma_f32_32x32x16_bf16 v[100:115], a[96:99], v[80:83], v[100:115]
    v_mfma_f32_32x32x16_bf16 v[132:147], a[100:103], v[80:83], v[132:147]
    v_mfma_f32_32x32x16_bf16 v[164:179], a[104:107], v[80:83], v[164:179]
    v_add_u32 v4, 49152, v8
    s_nop 11
    s_cmp_eq_u32 s12, 0
    s_cbranch_scc1 K2_W30
    ds_write_b128 v8, v[84:87] offset:0
    ds_write_b128 v8, v[100:103] offset:1024
    ds_write_b128 v8, v[116:119] offset:2048
    ds_write_b128 v8, v[132:135] offset:3072
    ds_write_b128 v8, v[148:151] offset:4096
    ds_write_b128 v8, v[164:167] offset:5120
K2_W30:
    s_cmp_eq_u32 s12, 1
    s_cbranch_scc1 K2_W31
    ds_write_b128 v8, v[88:91] offset:24576
    ds_write_b128 v8, v[104:107] offset:25600
    ds_write_b128 v8, v[120:123] offset:26624
    ds_write_b128 v8, v[136:139] offset:27648
    ds_write_b128 v8, v[152:155] offset:28672
    ds_write_b128 v8, v[168:171] offset:29696
K2_W31:
    s_cmp_eq_u32 s12, 2
    s_cbranch_scc1 K2_W32
    ds_write_b128 v4, v[92:95] offset:0
    ds_write_b128 v4, v[108:111] offset:1024
    ds_write_b128 v4, v[124:127] offset:2048
    ds_write_b128 v4, v[140:143] offset:3072
    ds_write_b128 v4, v[156:159] offset:4096
    ds_write_b128 v4, v[172:175] offset:5120
K2_W32:
    s_cmp_eq_u32 s12, 3
    s_cbranch_scc1 K2_W33
    ds_write_b128 v4, v[96:99] offset:24576
    ds_write_b128 v4, v[112:115] offset:25600
    ds_write_b128 v4, v[128:131] offset:26624
    ds_write_b128 v4, v[144:147] offset:27648
    ds_write_b128 v4, v[160:163] offset:28672
    ds_write_b128 v4, v[176:179] offset:29696
K2_W33:
    s_waitcnt lgkmcnt(0)
    s_barrier
    s_cmp_eq_u32 s12, 0
    s_cbranch_scc1 K2_R30
    ds_read_b128 v[84:87], v9 offset:0
    ds_read_b128 v[100:103], v9 offset:1024
    ds_read_b128 v[116:119], v9 offset:2048
    ds_read_b128 v[132:135], v9 offset:3072
    ds_read_b128 v[148:151], v9 offset:4096
    ds_read_b128 v[164:167], v9 offset:5120
K2_R30:
    s_cmp_eq_u32 s12, 1
    s_cbranch_scc1 K2_R31
    ds_read_b128 v[88:91], v9 offset:6144
    ds_read_b128 v[104:107], v9 offset:7168
    ds_read_b128 v[120:123], v9 offset:8192
    ds_read_b128 v[136:139], v9 offset:9216
    ds_read_b128 v[152:155], v9 offset:10240
    ds_read_b128 v[168:171], v9 offset:11264
K2_R31:
    s_cmp_eq_u32 s12, 2
    s_cbranch_scc1 K2_R32
    ds_read_b128 v[92:95], v9 offset:12288
    ds_read_b128 v[108:111], v9 offset:13312
    ds_read_b128 v[124:127], v9 offset:14336
    ds_read_b128 v[140:143], v9 offset:15360
    ds_read_b128 v[156:159], v9 offset:16384
    ds_read_b128 v[172:175], v9 offset:17408
K2_R32:
    s_cmp_eq_u32 s12, 3
    s_cbranch_scc1 K2_R33
    ds_read_b128 v[96:99], v9 offset:18432
    ds_read_b128 v[112:115], v9 offset:19456
    ds_read_b128 v[128:131], v9 offset:20480
    ds_read_b128 v[144:147], v9 offset:21504
    ds_read_b128 v[160:163], v9 offset:22528
    ds_read_b128 v[176:179], v9 offset:23552
K2_R33:
    s_waitcnt lgkmcnt(5)
    v_pk_add_f32 v[84:85], v[84:85], v[88:89]
    v_pk_add_f32 v[86:87], v[86:87], v[90:91]
    v_pk_add_f32 v[92:93], v[92:93], v[96:97]
    v_pk_add_f32 v[94:95], v[94:95], v[98:99]
    v_pk_add_f32 v[84:85], v[84:85], v[92:93]
    v_pk_add_f32 v[86:87], v[86:87], v[94:95]
    v_pk_mul_f32 v[84:85], v[84:85], s[26:27]
    v_pk_mul_f32 v[86:87], v[86:87], s[26:27]
    v_cvt_pk_bf16_f32 v88, v84, v85
    v_cvt_pk_bf16_f32 v89, v86, v87
    buffer_store_dwordx2 v[88:89], v220, s[8:11], s29 offen offset:0
    s_waitcnt lgkmcnt(4)
    v_pk_add_f32 v[100:101], v[100:101], v[104:105]
    v_pk_add_f32 v[102:103], v[102:103], v[106:107]
    v_pk_add_f32 v[108:109], v[108:109], v[112:113]
    v_pk_add_f32 v[110:111], v[110:111], v[114:115]
    v_pk_add_f32 v[100:101], v[100:101], v[108:109]
    v_pk_add_f32 v[102:103], v[102:103], v[110:111]
    v_pk_mul_f32 v[100:101], v[100:101], s[26:27]
    v_pk_mul_f32 v[102:103], v[102:103], s[26:27]
    v_cvt_pk_bf16_f32 v104, v100, v101
    v_cvt_pk_bf16_f32 v105, v102, v103
    buffer_store_dwordx2 v[104:105], v220, s[8:11], s29 offen offset:1280
    s_waitcnt lgkmcnt(3)
    v_pk_add_f32 v[116:117], v[116:117], v[120:121]
    v_pk_add_f32 v[118:119], v[118:119], v[122:123]
    v_pk_add_f32 v[124:125], v[124:125], v[128:129]
    v_pk_add_f32 v[126:127], v[126:127], v[130:131]
    v_pk_add_f32 v[116:117], v[116:117], v[124:125]
    v_pk_add_f32 v[118:119], v[118:119], v[126:127]
    v_pk_mul_f32 v[116:117], v[116:117], s[26:27]
    v_pk_mul_f32 v[118:119], v[118:119], s[26:27]
    v_cvt_pk_bf16_f32 v120, v116, v117
    v_cvt_pk_bf16_f32 v121, v118, v119
    buffer_store_dwordx2 v[120:121], v221, s[8:11], s29 offen offset:0
    s_waitcnt lgkmcnt(2)
    v_pk_add_f32 v[132:133], v[132:133], v[136:137]
    v_pk_add_f32 v[134:135], v[134:135], v[138:139]
    v_pk_add_f32 v[140:141], v[140:141], v[144:145]
    v_pk_add_f32 v[142:143], v[142:143], v[146:147]
    v_pk_add_f32 v[132:133], v[132:133], v[140:141]
    v_pk_add_f32 v[134:135], v[134:135], v[142:143]
    v_pk_mul_f32 v[132:133], v[132:133], s[26:27]
    v_pk_mul_f32 v[134:135], v[134:135], s[26:27]
    v_cvt_pk_bf16_f32 v136, v132, v133
    v_cvt_pk_bf16_f32 v137, v134, v135
    buffer_store_dwordx2 v[136:137], v221, s[8:11], s29 offen offset:1280
    s_cmp_eq_u32 s14, 6
    s_cbranch_scc1 K2_K
    s_waitcnt lgkmcnt(1)
    v_pk_add_f32 v[148:149], v[148:149], v[152:153]
    v_pk_add_f32 v[150:151], v[150:151], v[154:155]
    v_pk_add_f32 v[156:157], v[156:157], v[160:161]
    v_pk_add_f32 v[158:159], v[158:159], v[162:163]
    v_pk_add_f32 v[148:149], v[148:149], v[156:157]
    v_pk_add_f32 v[150:151], v[150:151], v[158:159]
    v_pk_mul_f32 v[148:149], v[148:149], s[26:27]
    v_pk_mul_f32 v[150:151], v[150:151], s[26:27]
    v_cvt_pk_bf16_f32 v152, v148, v149
    v_cvt_pk_bf16_f32 v153, v150, v151
    buffer_store_dwordx2 v[152:153], v222, s[8:11], s29 offen offset:0
    s_waitcnt lgkmcnt(0)
    v_pk_add_f32 v[164:165], v[164:165], v[168:169]
    v_pk_add_f32 v[166:167], v[166:167], v[170:171]
    v_pk_add_f32 v[172:173], v[172:173], v[176:177]
    v_pk_add_f32 v[174:175], v[174:175], v[178:179]
    v_pk_add_f32 v[164:165], v[164:165], v[172:173]
    v_pk_add_f32 v[166:167], v[166:167], v[174:175]
    v_pk_mul_f32 v[164:165], v[164:165], s[26:27]
    v_pk_mul_f32 v[166:167], v[166:167], s[26:27]
    v_cvt_pk_bf16_f32 v168, v164, v165
    v_cvt_pk_bf16_f32 v169, v166, v167
    buffer_store_dwordx2 v[168:169], v222, s[8:11], s29 offen offset:1280
    s_endpgm
K2_K:
    s_mul_i32 s25, s13, 4864
    s_add_u32 s25, s25, 8388608
    s_lshl_b32 s24, s12, 9
    s_add_u32 s24, s24, s25
    s_cmp_ge_u32 s12, 2
    s_cselect_b32 s24, 1073741824, s24
    s_cmp_eq_u32 s12, 2
    s_cselect_b32 s25, s25, 1073741824
    v_lshlrev_b32 v4, 4, v3
    v_lshl_add_u32 v4, v2, 3, v4
    v_lshlrev_b32 v5, 2, v3
    v_add_u32 v5, 2304, v5
    v_mov_b32 v6, 1073741824
    v_cmp_eq_u32 vcc, 0, v2
    s_nop 1
    v_cndmask_b32 v5, v6, v5, vcc
    s_waitcnt lgkmcnt(1)
    v_pk_add_f32 v[148:149], v[148:149], v[152:153]
    v_pk_add_f32 v[150:151], v[150:151], v[154:155]
    v_pk_add_f32 v[156:157], v[156:157], v[160:161]
    v_pk_add_f32 v[158:159], v[158:159], v[162:163]
    v_pk_add_f32 v[148:149], v[148:149], v[156:157]
    v_pk_add_f32 v[150:151], v[150:151], v[158:159]
    v_cvt_pk_bf16_f32 v152, v148, v149
    v_cvt_pk_bf16_f32 v153, v150, v151
    buffer_store_dwordx2 v[152:153], v4, s[8:11], s24 offen offset:0
    buffer_store_dword v152, v5, s[8:11], s25 offen offset:0
    s_waitcnt lgkmcnt(0)
    v_pk_add_f32 v[164:165], v[164:165], v[168:169]
    v_pk_add_f32 v[166:167], v[166:167], v[170:171]
    v_pk_add_f32 v[172:173], v[172:173], v[176:177]
    v_pk_add_f32 v[174:175], v[174:175], v[178:179]
    v_pk_add_f32 v[164:165], v[164:165], v[172:173]
    v_pk_add_f32 v[166:167], v[166:167], v[174:175]
    v_cvt_pk_bf16_f32 v168, v164, v165
    v_cvt_pk_bf16_f32 v169, v166, v167
    buffer_store_dwordx2 v[168:169], v4, s[8:11], s24 offen offset:2432
    buffer_store_dword v168, v5, s[8:11], s25 offen offset:2432
    s_endpgm
K2_V:
    s_mov_b32 m0, s19
    s_add_u32 s24, s20, 1280
    buffer_load_dwordx4 v1, s[8:11], s20 offen lds
    buffer_load_dwordx4 v1, s[8:11], s24 offen offset:1024 lds
    buffer_load_dwordx4 v[12:15], v1, s[8:11], s16 offen offset:0
    buffer_load_dwordx4 v[16:19], v1, s[8:11], s18 offen offset:0
    buffer_load_dwordx4 a[0:3], v1, s[8:11], s21 offen offset:0
    buffer_load_dwordx4 v[20:23], v1, s[8:11], s16 offen offset:1024
    buffer_load_dwordx4 v[24:27], v1, s[8:11], s18 offen offset:1024
    buffer_load_dwordx4 a[12:15], v1, s[8:11], s21 offen offset:1024
    buffer_load_dwordx4 v[28:31], v1, s[8:11], s16 offen offset:2048
    buffer_load_dwordx4 v[32:35], v1, s[8:11], s18 offen offset:2048
    buffer_load_dwordx4 a[24:27], v1, s[8:11], s21 offen offset:2048
    buffer_load_dwordx4 v[36:39], v1, s[8:11], s16 offen offset:3072
    buffer_load_dwordx4 v[40:43], v1, s[8:11], s18 offen offset:3072
    buffer_load_dwordx4 a[36:39], v1, s[8:11], s21 offen offset:3072
    s_add_u32 s16, s16, 4096
    s_add_u32 s18, s18, 4096
    s_add_u32 s21, s21, 4096
    v_lshrrev_b32 v2, 5, v0
    v_and_b32 v3, 31, v0
    v_lshlrev_b32 v7, 5, v2
    v_add_u32 v7, s19, v7
    s_mul_i32 s25, s12, 6144
    v_add_u32 v8, s25, v1
    s_mul_i32 s25, s12, 24576
    v_add_u32 v9, s25, v1
    s_waitcnt vmcnt(12)
    ds_read_b128 v[180:183], v7 offset:0
    ds_read_b128 v[188:191], v7 offset:1024
    ds_read_b128 v[184:187], v7 offset:16
    ds_read_b128 v[192:195], v7 offset:1040
    ds_read_b128 v[196:199], v7 offset:64
    ds_read_b128 v[204:207], v7 offset:1088
    ds_read_b128 v[200:203], v7 offset:80
    ds_read_b128 v[208:211], v7 offset:1104
    s_waitcnt vmcnt(10) lgkmcnt(4)
    buffer_load_dwordx4 v[44:47], v1, s[8:11], s16 offen offset:0
    buffer_load_dwordx4 v[48:51], v1, s[8:11], s18 offen offset:0
    buffer_load_dwordx4 a[48:51], v1, s[8:11], s21 offen offset:0
    v_lshlrev_b32 v212, 16, v12
    v_and_b32 v213, 0xffff0000, v12
    v_lshlrev_b32 v214, 16, v13
    v_and_b32 v215, 0xffff0000, v13
    v_lshlrev_b32 v216, 16, v14
    v_and_b32 v217, 0xffff0000, v14
    v_lshlrev_b32 v218, 16, v15
    v_and_b32 v219, 0xffff0000, v15
    v_fma_f32 v212, v212, v188, v180
    v_fma_f32 v213, v213, v189, v181
    v_fma_f32 v214, v214, v190, v182
    v_fma_f32 v215, v215, v191, v183
    v_fma_f32 v216, v216, v192, v184
    v_fma_f32 v217, v217, v193, v185
    v_fma_f32 v218, v218, v194, v186
    v_fma_f32 v219, v219, v195, v187
    v_cvt_pk_bf16_f32 v12, v212, v213
    v_cvt_pk_bf16_f32 v13, v214, v215
    v_cvt_pk_bf16_f32 v14, v216, v217
    v_cvt_pk_bf16_f32 v15, v218, v219
    v_lshlrev_b32 v212, 16, v16
    v_and_b32 v213, 0xffff0000, v16
    v_lshlrev_b32 v214, 16, v17
    s_waitcnt vmcnt(12)
    v_mfma_f32_32x32x16_bf16 v[84:99], v[12:15], a[0:3], 0
    v_and_b32 v215, 0xffff0000, v17
    v_lshlrev_b32 v216, 16, v18
    v_and_b32 v217, 0xffff0000, v18
    v_lshlrev_b32 v218, 16, v19
    v_and_b32 v219, 0xffff0000, v19
    v_fma_f32 v212, v212, v188, v180
    v_fma_f32 v213, v213, v189, v181
    v_fma_f32 v214, v214, v190, v182
    v_fma_f32 v215, v215, v191, v183
    v_fma_f32 v216, v216, v192, v184
    v_fma_f32 v217, v217, v193, v185
    v_fma_f32 v218, v218, v194, v186
    v_fma_f32 v219, v219, v195, v187
    v_cvt_pk_bf16_f32 v16, v212, v213
    v_cvt_pk_bf16_f32 v17, v214, v215
    v_cvt_pk_bf16_f32 v18, v216, v217
    v_cvt_pk_bf16_f32 v19, v218, v219
    ds_read_b128 v[180:183], v7 offset:128
    ds_read_b128 v[188:191], v7 offset:1152
    ds_read_b128 v[184:187], v7 offset:144
    ds_read_b128 v[192:195], v7 offset:1168
    s_waitcnt vmcnt(10) lgkmcnt(4)
    buffer_load_dwordx4 v[52:55], v1, s[8:11], s16 offen offset:1024
    buffer_load_dwordx4 v[56:59], v1, s[8:11], s18 offen offset:1024
    buffer_load_dwordx4 a[60:63], v1, s[8:11], s21 offen offset:1024
    v_lshlrev_b32 v212, 16, v20
    v_and_b32 v213, 0xffff0000, v20
    v_lshlrev_b32 v214, 16, v21
    v_mfma_f32_32x32x16_bf16 v[100:115], v[16:19], a[0:3], 0
    v_and_b32 v215, 0xffff0000, v21
    v_lshlrev_b32 v216, 16, v22
    v_and_b32 v217, 0xffff0000, v22
    v_lshlrev_b32 v218, 16, v23
    v_and_b32 v219, 0xffff0000, v23
    v_fma_f32 v212, v212, v204, v196
    v_fma_f32 v213, v213, v205, v197
    v_fma_f32 v214, v214, v206, v198
    v_fma_f32 v215, v215, v207, v199
    v_fma_f32 v216, v216, v208, v200
    v_fma_f32 v217, v217, v209, v201
    v_fma_f32 v218, v218, v210, v202
    v_fma_f32 v219, v219, v211, v203
    v_cvt_pk_bf16_f32 v20, v212, v213
    v_cvt_pk_bf16_f32 v21, v214, v215
    v_cvt_pk_bf16_f32 v22, v216, v217
    v_cvt_pk_bf16_f32 v23, v218, v219
    v_lshlrev_b32 v212, 16, v24
    v_and_b32 v213, 0xffff0000, v24
    v_lshlrev_b32 v214, 16, v25
    s_waitcnt vmcnt(12)
    v_mfma_f32_32x32x16_bf16 v[84:99], v[20:23], a[12:15], v[84:99]
    v_and_b32 v215, 0xffff0000, v25
    v_lshlrev_b32 v216, 16, v26
    v_and_b32 v217, 0xffff0000, v26
    v_lshlrev_b32 v218, 16, v27
    v_and_b32 v219, 0xffff0000, v27
    v_fma_f32 v212, v212, v204, v196
    v_fma_f32 v213, v213, v205, v197
    v_fma_f32 v214, v214, v206, v198
    v_fma_f32 v215, v215, v207, v199
    v_fma_f32 v216, v216, v208, v200
    v_fma_f32 v217, v217, v209, v201
    v_fma_f32 v218, v218, v210, v202
    v_fma_f32 v219, v219, v211, v203
    v_cvt_pk_bf16_f32 v24, v212, v213
    v_cvt_pk_bf16_f32 v25, v214, v215
    v_cvt_pk_bf16_f32 v26, v216, v217
    v_cvt_pk_bf16_f32 v27, v218, v219
    ds_read_b128 v[196:199], v7 offset:192
    ds_read_b128 v[204:207], v7 offset:1216
    ds_read_b128 v[200:203], v7 offset:208
    ds_read_b128 v[208:211], v7 offset:1232
    s_waitcnt vmcnt(10) lgkmcnt(4)
    buffer_load_dwordx4 v[60:63], v1, s[8:11], s16 offen offset:2048
    buffer_load_dwordx4 v[64:67], v1, s[8:11], s18 offen offset:2048
    buffer_load_dwordx4 a[72:75], v1, s[8:11], s21 offen offset:2048
    v_lshlrev_b32 v212, 16, v28
    v_and_b32 v213, 0xffff0000, v28
    v_lshlrev_b32 v214, 16, v29
    v_mfma_f32_32x32x16_bf16 v[100:115], v[24:27], a[12:15], v[100:115]
    v_and_b32 v215, 0xffff0000, v29
    v_lshlrev_b32 v216, 16, v30
    v_and_b32 v217, 0xffff0000, v30
    v_lshlrev_b32 v218, 16, v31
    v_and_b32 v219, 0xffff0000, v31
    v_fma_f32 v212, v212, v188, v180
    v_fma_f32 v213, v213, v189, v181
    v_fma_f32 v214, v214, v190, v182
    v_fma_f32 v215, v215, v191, v183
    v_fma_f32 v216, v216, v192, v184
    v_fma_f32 v217, v217, v193, v185
    v_fma_f32 v218, v218, v194, v186
    v_fma_f32 v219, v219, v195, v187
    v_cvt_pk_bf16_f32 v28, v212, v213
    v_cvt_pk_bf16_f32 v29, v214, v215
    v_cvt_pk_bf16_f32 v30, v216, v217
    v_cvt_pk_bf16_f32 v31, v218, v219
    v_lshlrev_b32 v212, 16, v32
    v_and_b32 v213, 0xffff0000, v32
    v_lshlrev_b32 v214, 16, v33
    s_waitcnt vmcnt(12)
    v_mfma_f32_32x32x16_bf16 v[84:99], v[28:31], a[24:27], v[84:99]
    v_and_b32 v215, 0xffff0000, v33
    v_lshlrev_b32 v216, 16, v34
    v_and_b32 v217, 0xffff0000, v34
    v_lshlrev_b32 v218, 16, v35
    v_and_b32 v219, 0xffff0000, v35
    v_fma_f32 v212, v212, v188, v180
    v_fma_f32 v213, v213, v189, v181
    v_fma_f32 v214, v214, v190, v182
    v_fma_f32 v215, v215, v191, v183
    v_fma_f32 v216, v216, v192, v184
    v_fma_f32 v217, v217, v193, v185
    v_fma_f32 v218, v218, v194, v186
    v_fma_f32 v219, v219, v195, v187
    v_cvt_pk_bf16_f32 v32, v212, v213
    v_cvt_pk_bf16_f32 v33, v214, v215
    v_cvt_pk_bf16_f32 v34, v216, v217
    v_cvt_pk_bf16_f32 v35, v218, v219
    ds_read_b128 v[180:183], v7 offset:256
    ds_read_b128 v[188:191], v7 offset:1280
    ds_read_b128 v[184:187], v7 offset:272
    ds_read_b128 v[192:195], v7 offset:1296
    s_waitcnt vmcnt(10) lgkmcnt(4)
    buffer_load_dwordx4 v[68:71], v1, s[8:11], s16 offen offset:3072
    buffer_load_dwordx4 v[72:75], v1, s[8:11], s18 offen offset:3072
    buffer_load_dwordx4 a[84:87], v1, s[8:11], s21 offen offset:3072
    s_add_u32 s16, s16, 4096
    s_add_u32 s18, s18, 4096
    s_add_u32 s21, s21, 4096
    v_lshlrev_b32 v212, 16, v36
    v_and_b32 v213, 0xffff0000, v36
    v_lshlrev_b32 v214, 16, v37
    v_mfma_f32_32x32x16_bf16 v[100:115], v[32:35], a[24:27], v[100:115]
    v_and_b32 v215, 0xffff0000, v37
    v_lshlrev_b32 v216, 16, v38
    v_and_b32 v217, 0xffff0000, v38
    v_lshlrev_b32 v218, 16, v39
    v_and_b32 v219, 0xffff0000, v39
    v_fma_f32 v212, v212, v204, v196
    v_fma_f32 v213, v213, v205, v197
    v_fma_f32 v214, v214, v206, v198
    v_fma_f32 v215, v215, v207, v199
    v_fma_f32 v216, v216, v208, v200
    v_fma_f32 v217, v217, v209, v201
    v_fma_f32 v218, v218, v210, v202
    v_fma_f32 v219, v219, v211, v203
    v_cvt_pk_bf16_f32 v36, v212, v213
    v_cvt_pk_bf16_f32 v37, v214, v215
    v_cvt_pk_bf16_f32 v38, v216, v217
    v_cvt_pk_bf16_f32 v39, v218, v219
    v_lshlrev_b32 v212, 16, v40
    v_and_b32 v213, 0xffff0000, v40
    v_lshlrev_b32 v214, 16, v41
    s_waitcnt vmcnt(12)
    v_mfma_f32_32x32x16_bf16 v[84:99], v[36:39], a[36:39], v[84:99]
    v_and_b32 v215, 0xffff0000, v41
    v_lshlrev_b32 v216, 16, v42
    v_and_b32 v217, 0xffff0000, v42
    v_lshlrev_b32 v218, 16, v43
    v_and_b32 v219, 0xffff0000, v43
    v_fma_f32 v212, v212, v204, v196
    v_fma_f32 v213, v213, v205, v197
    v_fma_f32 v214, v214, v206, v198
    v_fma_f32 v215, v215, v207, v199
    v_fma_f32 v216, v216, v208, v200
    v_fma_f32 v217, v217, v209, v201
    v_fma_f32 v218, v218, v210, v202
    v_fma_f32 v219, v219, v211, v203
    v_cvt_pk_bf16_f32 v40, v212, v213
    v_cvt_pk_bf16_f32 v41, v214, v215
    v_cvt_pk_bf16_f32 v42, v216, v217
    v_cvt_pk_bf16_f32 v43, v218, v219
    ds_read_b128 v[196:199], v7 offset:320
    ds_read_b128 v[204:207], v7 offset:1344
    ds_read_b128 v[200:203], v7 offset:336
    ds_read_b128 v[208:211], v7 offset:1360
    s_waitcnt vmcnt(10) lgkmcnt(4)
    buffer_load_dwordx4 v[76:79], v1, s[8:11], s16 offen offset:0
    buffer_load_dwordx4 v[80:83], v1, s[8:11], s18 offen offset:0
    buffer_load_dwordx4 a[96:99], v1, s[8:11], s21 offen offset:0
    v_lshlrev_b32 v212, 16, v44
    v_and_b32 v213, 0xffff0000, v44
    v_lshlrev_b32 v214, 16, v45
    v_mfma_f32_32x32x16_bf16 v[100:115], v[40:43], a[36:39], v[100:115]
    v_and_b32 v215, 0xffff0000, v45
    v_lshlrev_b32 v216, 16, v46
    v_and_b32 v217, 0xffff0000, v46
    v_lshlrev_b32 v218, 16, v47
    v_and_b32 v219, 0xffff0000, v47
    v_fma_f32 v212, v212, v188, v180
    v_fma_f32 v213, v213, v189, v181
    v_fma_f32 v214, v214, v190, v182
    v_fma_f32 v215, v215, v191, v183
    v_fma_f32 v216, v216, v192, v184
    v_fma_f32 v217, v217, v193, v185
    v_fma_f32 v218, v218, v194, v186
    v_fma_f32 v219, v219, v195, v187
    v_cvt_pk_bf16_f32 v44, v212, v213
    v_cvt_pk_bf16_f32 v45, v214, v215
    v_cvt_pk_bf16_f32 v46, v216, v217
    v_cvt_pk_bf16_f32 v47, v218, v219
    v_lshlrev_b32 v212, 16, v48
    v_and_b32 v213, 0xffff0000, v48
    v_lshlrev_b32 v214, 16, v49
    s_waitcnt vmcnt(12)
    v_mfma_f32_32x32x16_bf16 v[84:99], v[44:47], a[48:51], v[84:99]
    v_and_b32 v215, 0xffff0000, v49
    v_lshlrev_b32 v216, 16, v50
    v_and_b32 v217, 0xffff0000, v50
    v_lshlrev_b32 v218, 16, v51
    v_and_b32 v219, 0xffff0000, v51
    v_fma_f32 v212, v212, v188, v180
    v_fma_f32 v213, v213, v189, v181
    v_fma_f32 v214, v214, v190, v182
    v_fma_f32 v215, v215, v191, v183
    v_fma_f32 v216, v216, v192, v184
    v_fma_f32 v217, v217, v193, v185
    v_fma_f32 v218, v218, v194, v186
    v_fma_f32 v219, v219, v195, v187
    v_cvt_pk_bf16_f32 v48, v212, v213
    v_cvt_pk_bf16_f32 v49, v214, v215
    v_cvt_pk_bf16_f32 v50, v216, v217
    v_cvt_pk_bf16_f32 v51, v218, v219
    ds_read_b128 v[180:183], v7 offset:384
    ds_read_b128 v[188:191], v7 offset:1408
    ds_read_b128 v[184:187], v7 offset:400
    ds_read_b128 v[192:195], v7 offset:1424
    s_waitcnt vmcnt(10) lgkmcnt(4)
    v_lshlrev_b32 v212, 16, v52
    v_and_b32 v213, 0xffff0000, v52
    v_lshlrev_b32 v214, 16, v53
    v_mfma_f32_32x32x16_bf16 v[100:115], v[48:51], a[48:51], v[100:115]
    v_and_b32 v215, 0xffff0000, v53
    v_lshlrev_b32 v216, 16, v54
    v_and_b32 v217, 0xffff0000, v54
    v_lshlrev_b32 v218, 16, v55
    v_and_b32 v219, 0xffff0000, v55
    v_fma_f32 v212, v212, v204, v196
    v_fma_f32 v213, v213, v205, v197
    v_fma_f32 v214, v214, v206, v198
    v_fma_f32 v215, v215, v207, v199
    v_fma_f32 v216, v216, v208, v200
    v_fma_f32 v217, v217, v209, v201
    v_fma_f32 v218, v218, v210, v202
    v_fma_f32 v219, v219, v211, v203
    v_cvt_pk_bf16_f32 v52, v212, v213
    v_cvt_pk_bf16_f32 v53, v214, v215
    v_cvt_pk_bf16_f32 v54, v216, v217
    v_cvt_pk_bf16_f32 v55, v218, v219
    v_lshlrev_b32 v212, 16, v56
    v_and_b32 v213, 0xffff0000, v56
    v_lshlrev_b32 v214, 16, v57
    s_waitcnt vmcnt(9)
    v_mfma_f32_32x32x16_bf16 v[84:99], v[52:55], a[60:63], v[84:99]
    v_and_b32 v215, 0xffff0000, v57
    v_lshlrev_b32 v216, 16, v58
    v_and_b32 v217, 0xffff0000, v58
    v_lshlrev_b32 v218, 16, v59
    v_and_b32 v219, 0xffff0000, v59
    v_fma_f32 v212, v212, v204, v196
    v_fma_f32 v213, v213, v205, v197
    v_fma_f32 v214, v214, v206, v198
    v_fma_f32 v215, v215, v207, v199
    v_fma_f32 v216, v216, v208, v200
    v_fma_f32 v217, v217, v209, v201
    v_fma_f32 v218, v218, v210, v202
    v_fma_f32 v219, v219, v211, v203
    v_cvt_pk_bf16_f32 v56, v212, v213
    v_cvt_pk_bf16_f32 v57, v214, v215
    v_cvt_pk_bf16_f32 v58, v216, v217
    v_cvt_pk_bf16_f32 v59, v218, v219
    ds_read_b128 v[196:199], v7 offset:448
    ds_read_b128 v[204:207], v7 offset:1472
    ds_read_b128 v[200:203], v7 offset:464
    ds_read_b128 v[208:211], v7 offset:1488
    s_waitcnt vmcnt(7) lgkmcnt(4)
    v_lshlrev_b32 v212, 16, v60
    v_and_b32 v213, 0xffff0000, v60
    v_lshlrev_b32 v214, 16, v61
    v_mfma_f32_32x32x16_bf16 v[100:115], v[56:59], a[60:63], v[100:115]
    v_and_b32 v215, 0xffff0000, v61
    v_lshlrev_b32 v216, 16, v62
    v_and_b32 v217, 0xffff0000, v62
    v_lshlrev_b32 v218, 16, v63
    v_and_b32 v219, 0xffff0000, v63
    v_fma_f32 v212, v212, v188, v180
    v_fma_f32 v213, v213, v189, v181
    v_fma_f32 v214, v214, v190, v182
    v_fma_f32 v215, v215, v191, v183
    v_fma_f32 v216, v216, v192, v184
    v_fma_f32 v217, v217, v193, v185
    v_fma_f32 v218, v218, v194, v186
    v_fma_f32 v219, v219, v195, v187
    v_cvt_pk_bf16_f32 v60, v212, v213
    v_cvt_pk_bf16_f32 v61, v214, v215
    v_cvt_pk_bf16_f32 v62, v216, v217
    v_cvt_pk_bf16_f32 v63, v218, v219
    v_lshlrev_b32 v212, 16, v64
    v_and_b32 v213, 0xffff0000, v64
    v_lshlrev_b32 v214, 16, v65
    s_waitcnt vmcnt(6)
    v_mfma_f32_32x32x16_bf16 v[84:99], v[60:63], a[72:75], v[84:99]
    v_and_b32 v215, 0xffff0000, v65
    v_lshlrev_b32 v216, 16, v66
    v_and_b32 v217, 0xffff0000, v66
    v_lshlrev_b32 v218, 16, v67
    v_and_b32 v219, 0xffff0000, v67
    v_fma_f32 v212, v212, v188, v180
    v_fma_f32 v213, v213, v189, v181
    v_fma_f32 v214, v214, v190, v182
    v_fma_f32 v215, v215, v191, v183
    v_fma_f32 v216, v216, v192, v184
    v_fma_f32 v217, v217, v193, v185
    v_fma_f32 v218, v218, v194, v186
    v_fma_f32 v219, v219, v195, v187
    v_cvt_pk_bf16_f32 v64, v212, v213
    v_cvt_pk_bf16_f32 v65, v214, v215
    v_cvt_pk_bf16_f32 v66, v216, v217
    v_cvt_pk_bf16_f32 v67, v218, v219
    ds_read_b128 v[180:183], v7 offset:512
    ds_read_b128 v[188:191], v7 offset:1536
    ds_read_b128 v[184:187], v7 offset:528
    ds_read_b128 v[192:195], v7 offset:1552
    s_waitcnt vmcnt(4) lgkmcnt(4)
    v_lshlrev_b32 v212, 16, v68
    v_and_b32 v213, 0xffff0000, v68
    v_lshlrev_b32 v214, 16, v69
    v_mfma_f32_32x32x16_bf16 v[100:115], v[64:67], a[72:75], v[100:115]
    v_and_b32 v215, 0xffff0000, v69
    v_lshlrev_b32 v216, 16, v70
    v_and_b32 v217, 0xffff0000, v70
    v_lshlrev_b32 v218, 16, v71
    v_and_b32 v219, 0xffff0000, v71
    v_fma_f32 v212, v212, v204, v196
    v_fma_f32 v213, v213, v205, v197
    v_fma_f32 v214, v214, v206, v198
    v_fma_f32 v215, v215, v207, v199
    v_fma_f32 v216, v216, v208, v200
    v_fma_f32 v217, v217, v209, v201
    v_fma_f32 v218, v218, v210, v202
    v_fma_f32 v219, v219, v211, v203
    v_cvt_pk_bf16_f32 v68, v212, v213
    v_cvt_pk_bf16_f32 v69, v214, v215
    v_cvt_pk_bf16_f32 v70, v216, v217
    v_cvt_pk_bf16_f32 v71, v218, v219
    v_lshlrev_b32 v212, 16, v72
    v_and_b32 v213, 0xffff0000, v72
    v_lshlrev_b32 v214, 16, v73
    s_waitcnt vmcnt(3)
    v_mfma_f32_32x32x16_bf16 v[84:99], v[68:71], a[84:87], v[84:99]
    v_and_b32 v215, 0xffff0000, v73
    v_lshlrev_b32 v216, 16, v74
    v_and_b32 v217, 0xffff0000, v74
    v_lshlrev_b32 v218, 16, v75
    v_and_b32 v219, 0xffff0000, v75
    v_fma_f32 v212, v212, v204, v196
    v_fma_f32 v213, v213, v205, v197
    v_fma_f32 v214, v214, v206, v198
    v_fma_f32 v215, v215, v207, v199
    v_fma_f32 v216, v216, v208, v200
    v_fma_f32 v217, v217, v209, v201
    v_fma_f32 v218, v218, v210, v202
    v_fma_f32 v219, v219, v211, v203
    v_cvt_pk_bf16_f32 v72, v212, v213
    v_cvt_pk_bf16_f32 v73, v214, v215
    v_cvt_pk_bf16_f32 v74, v216, v217
    v_cvt_pk_bf16_f32 v75, v218, v219
    s_waitcnt vmcnt(1) lgkmcnt(0)
    v_lshlrev_b32 v212, 16, v76
    v_and_b32 v213, 0xffff0000, v76
    v_lshlrev_b32 v214, 16, v77
    v_mfma_f32_32x32x16_bf16 v[100:115], v[72:75], a[84:87], v[100:115]
    v_and_b32 v215, 0xffff0000, v77
    v_lshlrev_b32 v216, 16, v78
    v_and_b32 v217, 0xffff0000, v78
    v_lshlrev_b32 v218, 16, v79
    v_and_b32 v219, 0xffff0000, v79
    v_fma_f32 v212, v212, v188, v180
    v_fma_f32 v213, v213, v189, v181
    v_fma_f32 v214, v214, v190, v182
    v_fma_f32 v215, v215, v191, v183
    v_fma_f32 v216, v216, v192, v184
    v_fma_f32 v217, v217, v193, v185
    v_fma_f32 v218, v218, v194, v186
    v_fma_f32 v219, v219, v195, v187
    v_cvt_pk_bf16_f32 v76, v212, v213
    v_cvt_pk_bf16_f32 v77, v214, v215
    v_cvt_pk_bf16_f32 v78, v216, v217
    v_cvt_pk_bf16_f32 v79, v218, v219
    v_lshlrev_b32 v212, 16, v80
    v_and_b32 v213, 0xffff0000, v80
    v_lshlrev_b32 v214, 16, v81
    s_waitcnt vmcnt(0)
    v_mfma_f32_32x32x16_bf16 v[84:99], v[76:79], a[96:99], v[84:99]
    v_and_b32 v215, 0xffff0000, v81
    v_lshlrev_b32 v216, 16, v82
    v_and_b32 v217, 0xffff0000, v82
    v_lshlrev_b32 v218, 16, v83
    v_and_b32 v219, 0xffff0000, v83
    v_fma_f32 v212, v212, v188, v180
    v_fma_f32 v213, v213, v189, v181
    v_fma_f32 v214, v214, v190, v182
    v_fma_f32 v215, v215, v191, v183
    v_fma_f32 v216, v216, v192, v184
    v_fma_f32 v217, v217, v193, v185
    v_fma_f32 v218, v218, v194, v186
    v_fma_f32 v219, v219, v195, v187
    v_cvt_pk_bf16_f32 v80, v212, v213
    v_cvt_pk_bf16_f32 v81, v214, v215
    v_cvt_pk_bf16_f32 v82, v216, v217
    v_cvt_pk_bf16_f32 v83, v218, v219
    s_nop 1
    v_mfma_f32_32x32x16_bf16 v[100:115], v[80:83], a[96:99], v[100:115]
    v_add_u32 v4, 49152, v8
    s_nop 11
    s_cmp_eq_u32 s12, 0
    s_cbranch_scc1 K2_W10
    ds_write_b128 v8, v[84:87] offset:0
    ds_write_b128 v8, v[100:103] offset:1024
K2_W10:
    s_cmp_eq_u32 s12, 1
    s_cbranch_scc1 K2_W11
    ds_write_b128 v8, v[88:91] offset:24576
    ds_write_b128 v8, v[104:107] offset:25600
K2_W11:
    s_cmp_eq_u32 s12, 2
    s_cbranch_scc1 K2_W12
    ds_write_b128 v4, v[92:95] offset:0
    ds_write_b128 v4, v[108:111] offset:1024
K2_W12:
    s_cmp_eq_u32 s12, 3
    s_cbranch_scc1 K2_W13
    ds_write_b128 v4, v[96:99] offset:24576
    ds_write_b128 v4, v[112:115] offset:25600
K2_W13:
    s_waitcnt lgkmcnt(0)
    s_barrier
    s_cmp_eq_u32 s12, 0
    s_cbranch_scc1 K2_R10
    ds_read_b128 v[84:87], v9 offset:0
    ds_read_b128 v[100:103], v9 offset:1024
K2_R10:
    s_cmp_eq_u32 s12, 1
    s_cbranch_scc1 K2_R11
    ds_read_b128 v[88:91], v9 offset:6144
    ds_read_b128 v[104:107], v9 offset:7168
K2_R11:
    s_cmp_eq_u32 s12, 2
    s_cbranch_scc1 K2_R12
    ds_read_b128 v[92:95], v9 offset:12288
    ds_read_b128 v[108:111], v9 offset:13312
K2_R12:
    s_cmp_eq_u32 s12, 3
    s_cbranch_scc1 K2_R13
    ds_read_b128 v[96:99], v9 offset:18432
    ds_read_b128 v[112:115], v9 offset:19456
K2_R13:
    s_mul_i32 s25, s13, 4864
    s_lshr_b32 s24, s12, 1
    s_mul_i32 s24, s24, 640
    s_add_u32 s25, s25, s24
    s_and_b32 s24, s12, 1
    s_lshl_b32 s24, s24, 3
    s_add_u32 s25, s25, s24
    s_add_u32 s25, s25, 8389632
    v_mul_u32_u24 v4, 320, v2
    v_lshl_add_u32 v4, v3, 4, v4
    v_mov_b32 v6, 1073741824
    v_cmp_gt_u32 vcc, 20, v3
    s_nop 1
    v_cndmask_b32 v4, v6, v4, vcc
    v_mov_b32 v6, 0x3f803f80
    v_cmp_eq_u32 s[26:27], 18, v3
    s_waitcnt lgkmcnt(1)
    v_pk_add_f32 v[84:85], v[84:85], v[88:89]
    v_pk_add_f32 v[86:87], v[86:87], v[90:91]
    v_pk_add_f32 v[92:93], v[92:93], v[96:97]
    v_pk_add_f32 v[94:95], v[94:95], v[98:99]
    v_pk_add_f32 v[84:85], v[84:85], v[92:93]
    v_pk_add_f32 v[86:87], v[86:87], v[94:95]
    v_cvt_pk_bf16_f32 v88, v84, v85
    v_cndmask_b32 v88, v88, v6, s[26:27]
    v_cvt_pk_bf16_f32 v89, v86, v87
    v_cndmask_b32 v89, v89, v6, s[26:27]
    buffer_store_dwordx2 v[88:89], v4, s[8:11], s25 offen offset:0
    s_waitcnt lgkmcnt(0)
    v_pk_add_f32 v[100:101], v[100:101], v[104:105]
    v_pk_add_f32 v[102:103], v[102:103], v[106:107]
    v_pk_add_f32 v[108:109], v[108:109], v[112:113]
    v_pk_add_f32 v[110:111], v[110:111], v[114:115]
    v_pk_add_f32 v[100:101], v[100:101], v[108:109]
    v_pk_add_f32 v[102:103], v[102:103], v[110:111]
    v_cvt_pk_bf16_f32 v104, v100, v101
    v_cndmask_b32 v104, v104, v6, s[26:27]
    v_cvt_pk_bf16_f32 v105, v102, v103
    v_cndmask_b32 v105, v105, v6, s[26:27]
    buffer_store_dwordx2 v[104:105], v4, s[8:11], s25 offen offset:2432
K2_END:
    s_endpgm
.globl k3_attn_kernel
.p2align 8
.type k3_attn_kernel,@function
k3_attn_kernel:
    s_cmp_ge_u32 s2, 256
    s_cbranch_scc1 K3_END
    s_cmp_ge_u32 s2, 16
    s_cbranch_scc1 K3_NOPF
    s_getpc_b64 s[76:77]
K3_PF:
    s_mov_b32 s78, TEXT_END-K3_PF
    s_mov_b32 s79, 0x00020000
    v_lshlrev_b32 v100, 4, v0
    buffer_load_dwordx4 v[102:105], v100, s[76:79], 0 offen
K3_NOPF:
    s_load_dwordx2 s[4:5], s[0:1], 104
    s_load_dwordx2 s[6:7], s[0:1], 48
    s_load_dwordx2 s[8:9], s[0:1], 56
    s_load_dwordx2 s[10:11], s[0:1], 64
    s_load_dwordx2 s[12:13], s[0:1], 32
    v_and_b32 v1, 63, v0
    v_lshrrev_b32 v2, 6, v0
    s_nop 0
    v_readfirstlane_b32 s20, v2
    s_waitcnt lgkmcnt(0)
    s_mov_b32 s16, s4
    s_mov_b32 s17, s5
    s_mov_b32 s18, 268435456
    s_mov_b32 s19, 0x00020000
    s_cmp_ge_u32 s20, 8
    s_cbranch_scc1 K3_PACK
    v_lshlrev_b32 v3, 4, v1
    s_lshr_b32 s32, s20, 2
    s_and_b32 s33, s20, 3
    s_mul_i32 s34, s32, 77824
    v_lshrrev_b32 v4, 5, v1
    v_and_b32 v5, 31, v1
    s_and_b32 s21, s2, 7
    s_lshl_b32 s21, s21, 2
    s_lshr_b32 s22, s2, 6
    s_add_u32 s21, s21, s22
    s_lshl_b32 s21, s21, 1
    s_bfe_u32 s22, s2, 0x30003
    s_lshl_b32 s22, s22, 2
    s_add_u32 s22, s22, s33
    s_lshl_b32 s23, s22, 6
    s_add_u32 s23, s23, s21
    s_mul_i32 s23, s23, 1280
    s_add_u32 s23, s23, 5242880
    v_lshlrev_b32 v6, 3, v5
    v_mov_b32 v7, 1073741824
    v_cmp_eq_u32 vcc, 0, v4
    s_nop 1
    v_cndmask_b32 v6, v7, v6, vcc
    buffer_load_dwordx4 v[16:19], v3, s[16:19], s23 offen offset:0
    buffer_load_dwordx2 v[24:25], v6, s[16:19], s23 offen offset:1024
    buffer_load_dwordx4 v[20:23], v3, s[16:19], s23 offen offset:1280
    buffer_load_dwordx2 v[26:27], v6, s[16:19], s23 offen offset:2304
    s_lshl_b32 s24, s33, 10
    s_add_u32 s24, s24, s34
    s_add_u32 s25, s24, 8388608
    s_mov_b32 m0, s24
    s_nop 0
    buffer_load_dwordx4 v3, s[16:19], s25 offen lds
    s_add_u32 s24, s24, 4096
    s_add_u32 s25, s25, 4096
    s_mov_b32 m0, s24
    s_nop 0
    buffer_load_dwordx4 v3, s[16:19], s25 offen lds
    s_add_u32 s24, s24, 4096
    s_add_u32 s25, s25, 4096
    s_mov_b32 m0, s24
    s_nop 0
    buffer_load_dwordx4 v3, s[16:19], s25 offen lds
    s_add_u32 s24, s24, 4096
    s_add_u32 s25, s25, 4096
    s_mov_b32 m0, s24
    s_nop 0
    buffer_load_dwordx4 v3, s[16:19], s25 offen lds
    s_add_u32 s24, s24, 4096
    s_add_u32 s25, s25, 4096
    s_mov_b32 m0, s24
    s_nop 0
    buffer_load_dwordx4 v3, s[16:19], s25 offen lds
    s_add_u32 s24, s24, 4096
    s_add_u32 s25, s25, 4096
    s_mov_b32 m0, s24
    s_nop 0
    buffer_load_dwordx4 v3, s[16:19], s25 offen lds
    v_add_u32 v10, 0, v3
    v_lshlrev_b32 v11, 2, v5
    v_add_u32 v11, 2304, v11
    v_mov_b32 v6, 1328
    v_cmp_eq_u32 vcc, 0, v4
    s_nop 1
    v_cndmask_b32 v11, v6, v11, vcc
    v_add_u32 v11, 0, v11
    v_min_u32 v6, 19, v5
    v_mul_u32_u24 v12, 320, v4
    v_lshl_add_u32 v12, v6, 4, v12
    v_add_u32 v12, 1024, v12
    v_add_u32 v12, 0, v12
    v_mov_b32 v6, 0x3f803f80
    v_cndmask_b32 v109, 0, v6, vcc
    v_cndmask_b32 v111, 0, v6, vcc
    s_mov_b32 s26, 0
    s_waitcnt vmcnt(5)
    s_barrier
    ds_read_b128 v[100:103], v10
    ds_read_b32 v108, v11
    s_waitcnt lgkmcnt(0)
    v_mfma_f32_32x32x16_bf16 v[28:43], v[100:103], v[16:19], 0
    v_mfma_f32_32x32x8bf16_1k v[28:43], v[108:109], v[24:25], v[28:43]
    v_mfma_f32_32x32x16_bf16 v[44:59], v[100:103], v[20:23], 0
    v_mfma_f32_32x32x8bf16_1k v[44:59], v[108:109], v[26:27], v[44:59]
    s_nop 9
    v_max3_f32 v8, v28, v29, v30
    v_max_f32 v8, v8, v31
    v_max3_f32 v8, v8, v32, v33
    v_max3_f32 v8, v8, v34, v35
    v_max3_f32 v8, v8, v36, v37
    v_max3_f32 v8, v8, v38, v39
    v_max3_f32 v8, v8, v40, v41
    v_max3_f32 v8, v8, v42, v43
    v_mov_b32 v6, v8
    s_nop 1
    v_permlane32_swap_b32 v8, v6
    v_max_f32 v8, v8, v6
    v_cvt_pk_bf16_f32 v6, v8, v8
    v_lshlrev_b32 v6, 16, v6
    v_sub_f32 v7, v6, v8
    v_cvt_pk_bf16_f32 v6, -v6, v7
    v_cmp_eq_u32 vcc, 0, v4
    s_nop 1
    v_cndmask_b32 v25, 0, v6, vcc
    v_max3_f32 v8, v44, v45, v46
    v_max_f32 v8, v8, v47
    v_max3_f32 v8, v8, v48, v49
    v_max3_f32 v8, v8, v50, v51
    v_max3_f32 v8, v8, v52, v53
    v_max3_f32 v8, v8, v54, v55
    v_max3_f32 v8, v8, v56, v57
    v_max3_f32 v8, v8, v58, v59
    v_mov_b32 v6, v8
    s_nop 1
    v_permlane32_swap_b32 v8, v6
    v_max_f32 v8, v8, v6
    v_cvt_pk_bf16_f32 v6, v8, v8
    v_lshlrev_b32 v6, 16, v6
    v_sub_f32 v7, v6, v8
    v_cvt_pk_bf16_f32 v6, -v6, v7
    v_cmp_eq_u32 vcc, 0, v4
    s_nop 1
    v_cndmask_b32 v27, 0, v6, vcc
    s_waitcnt vmcnt(0)
    s_barrier
    s_cmp_eq_u32 s32, 0
    s_cbranch_scc1 K3_MAIN
    s_setprio 1
K3_MAIN:
    v_add_u32 v10, s34, v3
    v_lshlrev_b32 v11, 2, v5
    v_add_u32 v11, 2304, v11
    v_mov_b32 v6, 1328
    v_cmp_eq_u32 vcc, 0, v4
    s_nop 1
    v_cndmask_b32 v11, v6, v11, vcc
    v_add_u32 v11, s34, v11
    v_min_u32 v6, 19, v5
    v_mul_u32_u24 v12, 320, v4
    v_lshl_add_u32 v12, v6, 4, v12
    v_add_u32 v12, 1024, v12
    v_add_u32 v12, s34, v12
    ds_read_b128 v[100:103], v10
    ds_read_b32 v108, v11
    ds_read_b128 v[112:115], v12
    ds_read_b128 v[116:119], v12 offset:640
    v_mov_b32 v60, 0
    v_mov_b32 v61, 0
    v_mov_b32 v62, 0
    v_mov_b32 v63, 0
    v_mov_b32 v64, 0
    v_mov_b32 v65, 0
    v_mov_b32 v66, 0
    v_mov_b32 v67, 0
    v_mov_b32 v68, 0
    v_mov_b32 v69, 0
    v_mov_b32 v70, 0
    v_mov_b32 v71, 0
    v_mov_b32 v72, 0
    v_mov_b32 v73, 0
    v_mov_b32 v74, 0
    v_mov_b32 v75, 0
    v_mov_b32 v76, 0
    v_mov_b32 v77, 0
    v_mov_b32 v78, 0
    v_mov_b32 v79, 0
    v_mov_b32 v80, 0
    v_mov_b32 v81, 0
    v_mov_b32 v82, 0
    v_mov_b32 v83, 0
    v_mov_b32 v84, 0
    v_mov_b32 v85, 0
    v_mov_b32 v86, 0
    v_mov_b32 v87, 0
    v_mov_b32 v88, 0
    v_mov_b32 v89, 0
    v_mov_b32 v90, 0
    v_mov_b32 v91, 0
    v_mov_b32 v96, 0
    v_mov_b32 v97, 0
    v_mov_b32 v98, 0
    v_mov_b32 v99, 0
    v_mov_b32 v124, 0
    v_mov_b32 v125, 0
    v_mov_b32 v126, 0
    v_mov_b32 v127, 0
    s_waitcnt lgkmcnt(2)
    v_mfma_f32_32x32x16_bf16 v[28:43], v[100:103], v[16:19], 0
    v_mfma_f32_32x32x8bf16_1k v[28:43], v[108:109], v[24:25], v[28:43]
    s_mov_b32 s27, 0
    s_nop 7
    s_nop 3
K3_LOOP:
    v_mfma_f32_32x32x16_bf16 v[44:59], v[100:103], v[20:23], 0
    ds_read_b128 v[104:107], v10 offset:2432
    ds_read_b32 v110, v11 offset:2432
    v_exp_f32 v28, v28
    v_exp_f32 v29, v29
    v_exp_f32 v30, v30
    v_exp_f32 v31, v31
    v_mfma_f32_32x32x16_bf16 v[76:91], v[124:127], v[96:99], v[76:91]
    v_exp_f32 v32, v32
    v_exp_f32 v33, v33
    v_exp_f32 v34, v34
    v_exp_f32 v35, v35
    v_cvt_pk_bf16_f32 v92, v28, v29
    v_cvt_pk_bf16_f32 v93, v30, v31
    v_mfma_f32_32x32x8bf16_1k v[44:59], v[108:109], v[26:27], v[44:59]
    v_cvt_pk_bf16_f32 v94, v32, v33
    v_cvt_pk_bf16_f32 v95, v34, v35
    v_exp_f32 v36, v36
    v_exp_f32 v37, v37
    v_exp_f32 v38, v38
    v_exp_f32 v39, v39
    s_waitcnt lgkmcnt(2)
    v_mfma_f32_32x32x16_bf16 v[60:75], v[112:115], v[92:95], v[60:75]
    v_exp_f32 v40, v40
    v_exp_f32 v41, v41
    v_exp_f32 v42, v42
    v_exp_f32 v43, v43
    v_cvt_pk_bf16_f32 v96, v36, v37
    v_cvt_pk_bf16_f32 v97, v38, v39
    v_cvt_pk_bf16_f32 v98, v40, v41
    v_cvt_pk_bf16_f32 v99, v42, v43
    s_waitcnt lgkmcnt(0)
    v_mfma_f32_32x32x16_bf16 v[28:43], v[104:107], v[16:19], 0
    ds_read_b128 v[120:123], v12 offset:2432
    ds_read_b128 v[124:127], v12 offset:3072
    v_exp_f32 v44, v44
    v_exp_f32 v45, v45
    v_exp_f32 v46, v46
    v_exp_f32 v47, v47
    v_mfma_f32_32x32x16_bf16 v[60:75], v[116:119], v[96:99], v[60:75]
    v_exp_f32 v48, v48
    v_exp_f32 v49, v49
    v_exp_f32 v50, v50
    v_exp_f32 v51, v51
    v_cvt_pk_bf16_f32 v92, v44, v45
    v_cvt_pk_bf16_f32 v93, v46, v47
    v_mfma_f32_32x32x8bf16_1k v[28:43], v[110:111], v[24:25], v[28:43]
    v_cvt_pk_bf16_f32 v94, v48, v49
    v_cvt_pk_bf16_f32 v95, v50, v51
    v_exp_f32 v52, v52
    v_exp_f32 v53, v53
    v_exp_f32 v54, v54
    v_exp_f32 v55, v55
    v_mfma_f32_32x32x16_bf16 v[76:91], v[112:115], v[92:95], v[76:91]
    v_exp_f32 v56, v56
    v_exp_f32 v57, v57
    v_exp_f32 v58, v58
    v_exp_f32 v59, v59
    v_cvt_pk_bf16_f32 v96, v52, v53
    v_cvt_pk_bf16_f32 v97, v54, v55
    v_cvt_pk_bf16_f32 v98, v56, v57
    v_cvt_pk_bf16_f32 v99, v58, v59
    v_mfma_f32_32x32x16_bf16 v[44:59], v[104:107], v[20:23], 0
    ds_read_b128 v[100:103], v10 offset:4864
    ds_read_b32 v108, v11 offset:4864
    v_exp_f32 v28, v28
    v_exp_f32 v29, v29
    v_exp_f32 v30, v30
    v_exp_f32 v31, v31
    v_mfma_f32_32x32x16_bf16 v[76:91], v[116:119], v[96:99], v[76:91]
    v_exp_f32 v32, v32
    v_exp_f32 v33, v33
    v_exp_f32 v34, v34
    v_exp_f32 v35, v35
    v_cvt_pk_bf16_f32 v92, v28, v29
    v_cvt_pk_bf16_f32 v93, v30, v31
    v_mfma_f32_32x32x8bf16_1k v[44:59], v[110:111], v[26:27], v[44:59]
    v_cvt_pk_bf16_f32 v94, v32, v33
    v_cvt_pk_bf16_f32 v95, v34, v35
    v_exp_f32 v36, v36
    v_exp_f32 v37, v37
    v_exp_f32 v38, v38
    v_exp_f32 v39, v39
    s_waitcnt lgkmcnt(2)
    v_mfma_f32_32x32x16_bf16 v[60:75], v[120:123], v[92:95], v[60:75]
    v_exp_f32 v40, v40
    v_exp_f32 v41, v41
    v_exp_f32 v42, v42
    v_exp_f32 v43, v43
    v_cvt_pk_bf16_f32 v96, v36, v37
    v_cvt_pk_bf16_f32 v97, v38, v39
    v_cvt_pk_bf16_f32 v98, v40, v41
    v_cvt_pk_bf16_f32 v99, v42, v43
    s_waitcnt lgkmcnt(0)
    v_mfma_f32_32x32x16_bf16 v[28:43], v[100:103], v[16:19], 0
    ds_read_b128 v[112:115], v12 offset:4864
    ds_read_b128 v[116:119], v12 offset:5504
    v_exp_f32 v44, v44
    v_exp_f32 v45, v45
    v_exp_f32 v46, v46
    v_exp_f32 v47, v47
    v_mfma_f32_32x32x16_bf16 v[60:75], v[124:127], v[96:99], v[60:75]
    v_exp_f32 v48, v48
    v_exp_f32 v49, v49
    v_exp_f32 v50, v50
    v_exp_f32 v51, v51
    v_cvt_pk_bf16_f32 v92, v44, v45
    v_cvt_pk_bf16_f32 v93, v46, v47
    v_mfma_f32_32x32x8bf16_1k v[28:43], v[108:109], v[24:25], v[28:43]
    v_cvt_pk_bf16_f32 v94, v48, v49
    v_cvt_pk_bf16_f32 v95, v50, v51
    v_exp_f32 v52, v52
    v_exp_f32 v53, v53
    v_exp_f32 v54, v54
    v_exp_f32 v55, v55
    v_mfma_f32_32x32x16_bf16 v[76:91], v[120:123], v[92:95], v[76:91]
    v_exp_f32 v56, v56
    v_exp_f32 v57, v57
    v_exp_f32 v58, v58
    v_exp_f32 v59, v59
    v_cvt_pk_bf16_f32 v96, v52, v53
    v_cvt_pk_bf16_f32 v97, v54, v55
    v_cvt_pk_bf16_f32 v98, v56, v57
    v_cvt_pk_bf16_f32 v99, v58, v59
    v_mfma_f32_32x32x16_bf16 v[44:59], v[100:103], v[20:23], 0
    ds_read_b128 v[104:107], v10 offset:7296
    ds_read_b32 v110, v11 offset:7296
    v_exp_f32 v28, v28
    v_exp_f32 v29, v29
    v_exp_f32 v30, v30
    v_exp_f32 v31, v31
    v_mfma_f32_32x32x16_bf16 v[76:91], v[124:127], v[96:99], v[76:91]
    v_exp_f32 v32, v32
    v_exp_f32 v33, v33
    v_exp_f32 v34, v34
    v_exp_f32 v35, v35
    v_cvt_pk_bf16_f32 v92, v28, v29
    v_cvt_pk_bf16_f32 v93, v30, v31
    v_mfma_f32_32x32x8bf16_1k v[44:59], v[108:109], v[26:27], v[44:59]
    v_cvt_pk_bf16_f32 v94, v32, v33
    v_cvt_pk_bf16_f32 v95, v34, v35
    v_exp_f32 v36, v36
    v_exp_f32 v37, v37
    v_exp_f32 v38, v38
    v_exp_f32 v39, v39
    s_waitcnt lgkmcnt(2)
    v_mfma_f32_32x32x16_bf16 v[60:75], v[112:115], v[92:95], v[60:75]
    v_exp_f32 v40, v40
    v_exp_f32 v41, v41
    v_exp_f32 v42, v42
    v_exp_f32 v43, v43
    v_cvt_pk_bf16_f32 v96, v36, v37
    v_cvt_pk_bf16_f32 v97, v38, v39
    v_cvt_pk_bf16_f32 v98, v40, v41
    v_cvt_pk_bf16_f32 v99, v42, v43
    s_waitcnt lgkmcnt(0)
    v_mfma_f32_32x32x16_bf16 v[28:43], v[104:107], v[16:19], 0
    ds_read_b128 v[120:123], v12 offset:7296
    ds_read_b128 v[124:127], v12 offset:7936
    v_exp_f32 v44, v44
    v_exp_f32 v45, v45
    v_exp_f32 v46, v46
    v_exp_f32 v47, v47
    v_mfma_f32_32x32x16_bf16 v[60:75], v[116:119], v[96:99], v[60:75]
    v_exp_f32 v48, v48
    v_exp_f32 v49, v49
    v_exp_f32 v50, v50
    v_exp_f32 v51, v51
    v_cvt_pk_bf16_f32 v92, v44, v45
    v_cvt_pk_bf16_f32 v93, v46, v47
    v_mfma_f32_32x32x8bf16_1k v[28:43], v[110:111], v[24:25], v[28:43]
    v_cvt_pk_bf16_f32 v94, v48, v49
    v_cvt_pk_bf16_f32 v95, v50, v51
    v_exp_f32 v52, v52
    v_exp_f32 v53, v53
    v_exp_f32 v54, v54
    v_exp_f32 v55, v55
    v_mfma_f32_32x32x16_bf16 v[76:91], v[112:115], v[92:95], v[76:91]
    v_exp_f32 v56, v56
    v_exp_f32 v57, v57
    v_exp_f32 v58, v58
    v_exp_f32 v59, v59
    v_cvt_pk_bf16_f32 v96, v52, v53
    v_cvt_pk_bf16_f32 v97, v54, v55
    v_cvt_pk_bf16_f32 v98, v56, v57
    v_cvt_pk_bf16_f32 v99, v58, v59
    v_mfma_f32_32x32x16_bf16 v[44:59], v[104:107], v[20:23], 0
    ds_read_b128 v[100:103], v10 offset:9728
    ds_read_b32 v108, v11 offset:9728
    v_exp_f32 v28, v28
    v_exp_f32 v29, v29
    v_exp_f32 v30, v30
    v_exp_f32 v31, v31
    v_mfma_f32_32x32x16_bf16 v[76:91], v[116:119], v[96:99], v[76:91]
    v_exp_f32 v32, v32
    v_exp_f32 v33, v33
    v_exp_f32 v34, v34
    v_exp_f32 v35, v35
    v_cvt_pk_bf16_f32 v92, v28, v29
    v_cvt_pk_bf16_f32 v93, v30, v31
    v_mfma_f32_32x32x8bf16_1k v[44:59], v[110:111], v[26:27], v[44:59]
    v_cvt_pk_bf16_f32 v94, v32, v33
    v_cvt_pk_bf16_f32 v95, v34, v35
    v_exp_f32 v36, v36
    v_exp_f32 v37, v37
    v_exp_f32 v38, v38
    v_exp_f32 v39, v39
    s_waitcnt lgkmcnt(2)
    v_mfma_f32_32x32x16_bf16 v[60:75], v[120:123], v[92:95], v[60:75]
    v_exp_f32 v40, v40
    v_exp_f32 v41, v41
    v_exp_f32 v42, v42
    v_exp_f32 v43, v43
    v_cvt_pk_bf16_f32 v96, v36, v37
    v_cvt_pk_bf16_f32 v97, v38, v39
    v_cvt_pk_bf16_f32 v98, v40, v41
    v_cvt_pk_bf16_f32 v99, v42, v43
    s_waitcnt lgkmcnt(0)
    v_mfma_f32_32x32x16_bf16 v[28:43], v[100:103], v[16:19], 0
    ds_read_b128 v[112:115], v12 offset:9728
    ds_read_b128 v[116:119], v12 offset:10368
    v_exp_f32 v44, v44
    v_exp_f32 v45, v45
    v_exp_f32 v46, v46
    v_exp_f32 v47, v47
    v_mfma_f32_32x32x16_bf16 v[60:75], v[124:127], v[96:99], v[60:75]
    v_exp_f32 v48, v48
    v_exp_f32 v49, v49
    v_exp_f32 v50, v50
    v_exp_f32 v51, v51
    v_cvt_pk_bf16_f32 v92, v44, v45
    v_cvt_pk_bf16_f32 v93, v46, v47
    v_mfma_f32_32x32x8bf16_1k v[28:43], v[108:109], v[24:25], v[28:43]
    v_cvt_pk_bf16_f32 v94, v48, v49
    v_cvt_pk_bf16_f32 v95, v50, v51
    v_exp_f32 v52, v52
    v_exp_f32 v53, v53
    v_exp_f32 v54, v54
    v_exp_f32 v55, v55
    v_mfma_f32_32x32x16_bf16 v[76:91], v[120:123], v[92:95], v[76:91]
    v_exp_f32 v56, v56
    v_exp_f32 v57, v57
    v_exp_f32 v58, v58
    v_exp_f32 v59, v59
    v_cvt_pk_bf16_f32 v96, v52, v53
    v_cvt_pk_bf16_f32 v97, v54, v55
    v_cvt_pk_bf16_f32 v98, v56, v57
    v_cvt_pk_bf16_f32 v99, v58, v59
    v_add_u32 v10, 9728, v10
    v_add_u32 v11, 9728, v11
    v_add_u32 v12, 9728, v12
    s_add_u32 s27, s27, 1
    s_add_u32 s28, s27, s26
    s_cmp_lg_u32 s28, 2
    s_cbranch_scc1 K3_NOBAR
    s_barrier
K3_NOBAR:
    s_cmp_lg_u32 s27, 7
    s_cbranch_scc1 K3_NOPRIO
    s_setprio 0
K3_NOPRIO:
    s_cmp_lt_u32 s27, 8
    s_cbranch_scc1 K3_LOOP
    v_mfma_f32_32x32x16_bf16 v[76:91], v[124:127], v[96:99], v[76:91]
    s_waitcnt lgkmcnt(0)
    s_cmp_lg_u32 s26, 0
    s_cbranch_scc1 K3_MERGE
    v_mov_b32 v8, 0x71800000
    v_mul_f32 v7, 0, v60
    v_fmac_f32 v7, 0, v61
    v_fmac_f32 v7, 0, v62
    v_fmac_f32 v7, 0, v63
    v_fmac_f32 v7, 0, v64
    v_fmac_f32 v7, 0, v65
    v_fmac_f32 v7, 0, v66
    v_fmac_f32 v7, 0, v67
    v_fmac_f32 v7, 0, v68
    v_fmac_f32 v7, 0, v69
    v_fmac_f32 v7, 0, v76
    v_fmac_f32 v7, 0, v77
    v_fmac_f32 v7, 0, v78
    v_fmac_f32 v7, 0, v79
    v_fmac_f32 v7, 0, v80
    v_fmac_f32 v7, 0, v81
    v_fmac_f32 v7, 0, v82
    v_fmac_f32 v7, 0, v83
    v_fmac_f32 v7, 0, v84
    v_fmac_f32 v7, 0, v85
    v_add_f32 v7, v7, v70
    v_add_f32 v7, v7, v86
    v_cmp_nlt_f32 vcc, v7, v8
    s_lshl_b32 s28, s20, 2
    s_add_u32 s28, s28, 16384
    v_mov_b32 v6, s28
    s_cmp_lg_u64 vcc, 0
    s_cselect_b32 s28, 1, 0
    v_mov_b32 v7, s28
    ds_write_b32 v6, v7
    s_branch K3_MERGE2
K3_MERGE:
    s_barrier
K3_MERGE2:
    s_mul_i32 s28, s33, 3072
    s_add_u32 s29, s28, s34
    v_add_u32 v6, s29, v3
    s_sub_u32 s29, 77824, s34
    s_add_u32 s29, s29, s28
    v_add_u32 v7, s29, v3
    s_cmp_eq_u32 s32, 0
    s_cbranch_scc1 K3_M0
    ds_write_b128 v6, v[60:63] offset:0
    ds_write_b128 v6, v[64:67] offset:1024
    ds_write_b128 v6, v[68:71] offset:2048
    v_mov_b32 v60, v76
    v_mov_b32 v61, v77
    v_mov_b32 v62, v78
    v_mov_b32 v63, v79
    v_mov_b32 v64, v80
    v_mov_b32 v65, v81
    v_mov_b32 v66, v82
    v_mov_b32 v67, v83
    v_mov_b32 v68, v84
    v_mov_b32 v69, v85
    v_mov_b32 v70, v86
    v_mov_b32 v71, v87
    s_branch K3_M1
K3_M0:
    ds_write_b128 v6, v[76:79] offset:0
    ds_write_b128 v6, v[80:83] offset:1024
    ds_write_b128 v6, v[84:87] offset:2048
K3_M1:
    v_and_b32 v6, 7, v1
    v_lshlrev_b32 v6, 2, v6
    s_waitcnt lgkmcnt(0)
    s_barrier
    ds_read_b32 v6, v6 offset:16384
    ds_read_b128 v[28:31], v7 offset:0
    ds_read_b128 v[32:35], v7 offset:1024
    ds_read_b128 v[36:39], v7 offset:2048
    v_lshrrev_b32 v7, 4, v5
    v_mul_u32_u24 v7, 18432, v7
    v_and_b32 v8, 15, v5
    v_lshl_add_u32 v7, v8, 4, v7
    v_lshl_add_u32 v8, v4, 8, v7
    s_add_u32 s36, s21, s32
    s_mul_i32 s28, s36, 36864
    s_add_u32 s28, s28, 9437184
    s_lshl_b32 s29, s22, 9
    s_add_u32 s29, s29, s28
    s_lshr_b32 s30, s22, 4
    s_add_u32 s30, s30, 16
    s_lshl_b32 s30, s30, 10
    s_add_u32 s30, s30, s28
    s_bfe_u32 s31, s22, 0x20002
    s_lshl_b32 s31, s31, 8
    s_add_u32 s30, s30, s31
    s_and_b32 s31, s22, 3
    s_lshl_b32 s31, s31, 2
    s_add_u32 s30, s30, s31
    v_mov_b32 v9, 1073741824
    v_cmp_eq_u32 vcc, 0, v4
    s_nop 1
    v_cndmask_b32 v7, v9, v7, vcc
    s_waitcnt lgkmcnt(0)
    v_cmp_ne_u32 vcc, 0, v6
    s_cmp_lg_u32 s26, 0
    s_cbranch_scc1 K3_FIN
    s_nop 2
    s_cbranch_vccnz K3_SLOW
K3_FIN:
    v_add_f32 v60, v60, v28
    v_add_f32 v61, v61, v29
    v_add_f32 v62, v62, v30
    v_add_f32 v63, v63, v31
    v_add_f32 v64, v64, v32
    v_add_f32 v65, v65, v33
    v_add_f32 v66, v66, v34
    v_add_f32 v67, v67, v35
    v_add_f32 v68, v68, v36
    v_add_f32 v69, v69, v37
    v_add_f32 v70, v70, v38
    v_mov_b32 v6, v70
    v_mov_b32 v9, v70
    s_nop 1
    v_permlane32_swap_b32 v6, v9
    v_rcp_f32 v6, v6
    s_nop 0
    v_mul_f32 v60, v60, v6
    v_mul_f32 v61, v61, v6
    v_mul_f32 v62, v62, v6
    v_mul_f32 v63, v63, v6
    v_mul_f32 v64, v64, v6
    v_mul_f32 v65, v65, v6
    v_mul_f32 v66, v66, v6
    v_mul_f32 v67, v67, v6
    v_mul_f32 v68, v68, v6
    v_mul_f32 v69, v69, v6
    v_cvt_pk_bf16_f32 v92, v60, v61
    v_cvt_pk_bf16_f32 v93, v62, v63
    v_cvt_pk_bf16_f32 v94, v64, v65
    v_cvt_pk_bf16_f32 v95, v66, v67
    v_cvt_pk_bf16_f32 v96, v68, v69
    buffer_store_dwordx4 v[92:95], v8, s[16:19], s29 offen sc1
    buffer_store_dword v96, v7, s[16:19], s30 offen
    s_endpgm
K3_SLOW:
    s_barrier
    s_lshl_b32 s24, s33, 10
    s_add_u32 s24, s24, s34
    s_add_u32 s25, s24, 8388608
    s_mov_b32 m0, s24
    s_nop 0
    buffer_load_dwordx4 v3, s[16:19], s25 offen lds
    s_add_u32 s24, s24, 4096
    s_add_u32 s25, s25, 4096
    s_mov_b32 m0, s24
    s_nop 0
    buffer_load_dwordx4 v3, s[16:19], s25 offen lds
    s_add_u32 s24, s24, 4096
    s_add_u32 s25, s25, 4096
    s_mov_b32 m0, s24
    s_nop 0
    buffer_load_dwordx4 v3, s[16:19], s25 offen lds
    s_add_u32 s24, s24, 4096
    s_add_u32 s25, s25, 4096
    s_mov_b32 m0, s24
    s_nop 0
    buffer_load_dwordx4 v3, s[16:19], s25 offen lds
    s_add_u32 s24, s24, 4096
    s_add_u32 s25, s25, 4096
    s_mov_b32 m0, s24
    s_nop 0
    buffer_load_dwordx4 v3, s[16:19], s25 offen lds
    s_add_u32 s24, s24, 4096
    s_add_u32 s25, s25, 4096
    s_mov_b32 m0, s24
    s_nop 0
    buffer_load_dwordx4 v3, s[16:19], s25 offen lds
    s_waitcnt vmcnt(0)
    s_barrier
    v_add_u32 v10, 0, v3
    v_lshlrev_b32 v11, 2, v5
    v_add_u32 v11, 2304, v11
    v_mov_b32 v6, 1328
    v_cmp_eq_u32 vcc, 0, v4
    s_nop 1
    v_cndmask_b32 v11, v6, v11, vcc
    v_add_u32 v11, 0, v11
    v_min_u32 v6, 19, v5
    v_mul_u32_u24 v12, 320, v4
    v_lshl_add_u32 v12, v6, 4, v12
    v_add_u32 v12, 1024, v12
    v_add_u32 v12, 0, v12
    v_mov_b32 v25, 0
    v_mov_b32 v27, 0
    v_mov_b32 v8, 0xff800000
    v_mov_b32 v9, 0xff800000
    s_mov_b32 s27, 0
K3_MAXLOOP:
    ds_read_b128 v[100:103], v10
    ds_read_b32 v108, v11
    v_add_u32 v10, 2432, v10
    v_add_u32 v11, 2432, v11
    s_waitcnt lgkmcnt(0)
    v_mfma_f32_32x32x16_bf16 v[28:43], v[100:103], v[16:19], 0
    v_mfma_f32_32x32x8bf16_1k v[28:43], v[108:109], v[24:25], v[28:43]
    v_mfma_f32_32x32x16_bf16 v[44:59], v[100:103], v[20:23], 0
    v_mfma_f32_32x32x8bf16_1k v[44:59], v[108:109], v[26:27], v[44:59]
    s_nop 9
    v_max3_f32 v8, v8, v28, v29
    v_max3_f32 v8, v8, v30, v31
    v_max3_f32 v8, v8, v32, v33
    v_max3_f32 v8, v8, v34, v35
    v_max3_f32 v8, v8, v36, v37
    v_max3_f32 v8, v8, v38, v39
    v_max3_f32 v8, v8, v40, v41
    v_max3_f32 v8, v8, v42, v43
    v_max3_f32 v9, v9, v44, v45
    v_max3_f32 v9, v9, v46, v47
    v_max3_f32 v9, v9, v48, v49
    v_max3_f32 v9, v9, v50, v51
    v_max3_f32 v9, v9, v52, v53
    v_max3_f32 v9, v9, v54, v55
    v_max3_f32 v9, v9, v56, v57
    v_max3_f32 v9, v9, v58, v59
    s_add_u32 s27, s27, 1
    s_cmp_lt_u32 s27, 64
    s_cbranch_scc1 K3_MAXLOOP
    v_mov_b32 v6, v8
    s_nop 1
    v_permlane32_swap_b32 v8, v6
    v_max_f32 v8, v8, v6
    v_cvt_pk_bf16_f32 v6, v8, v8
    v_lshlrev_b32 v6, 16, v6
    v_sub_f32 v7, v6, v8
    v_cvt_pk_bf16_f32 v6, -v6, v7
    v_cmp_eq_u32 vcc, 0, v4
    s_nop 1
    v_cndmask_b32 v25, 0, v6, vcc
    v_mov_b32 v6, v9
    s_nop 1
    v_permlane32_swap_b32 v9, v6
    v_max_f32 v9, v9, v6
    v_cvt_pk_bf16_f32 v6, v9, v9
    v_lshlrev_b32 v6, 16, v6
    v_sub_f32 v7, v6, v9
    v_cvt_pk_bf16_f32 v6, -v6, v7
    v_cmp_eq_u32 vcc, 0, v4
    s_nop 1
    v_cndmask_b32 v27, 0, v6, vcc
    s_mov_b32 s26, 16
    s_branch K3_MAIN
K3_PACK:
    s_mov_b32 s24, s6
    s_mov_b32 s25, s7
    s_mov_b32 s26, 5308416
    s_mov_b32 s27, 0x00020000
    s_mov_b32 s28, s8
    s_mov_b32 s29, s9
    s_mov_b32 s30, 5308416
    s_mov_b32 s31, 0x00020000
    s_mov_b32 s32, s10
    s_mov_b32 s33, s11
    s_mov_b32 s34, 5308416
    s_mov_b32 s35, 0x00020000
    s_mov_b32 s36, s12
    s_mov_b32 s37, s13
    s_mov_b32 s38, 663552
    s_mov_b32 s39, 0x00020000
    s_sub_u32 s21, s20, 8
    s_mul_i32 s22, s21, 77824
    s_add_u32 s22, s22, 12288
    s_lshl_b32 s23, s21, 12
    s_add_u32 s23, s23, 147456
    s_cmp_ge_u32 s21, 2
    s_cselect_b32 s22, s23, s22
    v_lshlrev_b32 v10, 4, v1
    v_lshrrev_b32 v3, 3, v1
    v_and_b32 v4, 7, v1
    v_lshlrev_b32 v4, 4, v4
    v_mul_u32_u24 v5, 9216, v3
    v_add_u32 v5, v5, v4
    v_mul_u32_u24 v6, 1152, v3
    v_add_u32 v6, v6, v4
    v_and_b32 v8, 4, v3
    v_bfe_u32 v9, v3, 1, 1
    v_add_u32 v8, v8, v9
    v_mul_u32_u24 v8, 18, v8
    v_and_b32 v9, 1, v3
    v_add_u32 v8, v8, v9
    v_mul_u32_u24 v7, 1152, v8
    v_add_u32 v7, v7, v4
    v_add_u32 v11, s22, v10
    v_lshrrev_b32 v15, 4, v1
    v_and_b32 v16, 15, v1
    v_lshrrev_b32 v8, 2, v16
    v_and_b32 v9, 3, v16
    v_lshlrev_b32 v9, 3, v9
    v_add_u32 v9, s22, v9
    v_lshl_add_u32 v4, v15, 2, v8
    v_lshl_add_u32 v13, v4, 7, v9
    v_lshl_add_u32 v14, v8, 7, v9
    v_and_b32 v8, 1, v15
    v_lshl_add_u32 v14, v8, 9, v14
    v_lshrrev_b32 v8, 1, v15
    v_lshl_add_u32 v14, v8, 11, v14
    v_mov_b32 v17, 1073741824
    v_mov_b32 v8, 37376
    v_cmp_eq_u32 vcc, 0, v16
    s_nop 1
    v_cndmask_b32 v17, v17, v8, vcc
    v_mov_b32 v8, 36224
    v_cmp_eq_u32 vcc, 1, v16
    s_nop 1
    v_cndmask_b32 v17, v17, v8, vcc
    v_lshl_add_u32 v17, v15, 3, v17
    s_setprio 3
    s_barrier
    s_barrier
    s_and_b32 s40, s21, 1
    s_mul_i32 s40, s40, 76
    s_lshr_b32 s41, s21, 1
    s_add_u32 s40, s40, s41
    s_add_u32 s40, s40, 24
    s_lshl_b32 s40, s40, 10
    s_add_u32 s41, s40, 8388608
    s_mov_b32 s42, 0
K3_KVL:
    s_mov_b32 m0, s40
    s_add_u32 s40, s40, 2048
    buffer_load_dwordx4 v10, s[16:19], s41 offen lds
    s_add_u32 s41, s41, 2048
    s_add_u32 s42, s42, 1
    s_cmp_lt_u32 s42, 26
    s_cbranch_scc1 K3_KVL
    s_cmp_ge_u32 s2, 144
    s_cbranch_scc1 K3_PACK_B
    s_cmp_ge_u32 s2, 72
    s_cselect_b32 s24, s28, s24
    s_cselect_b32 s25, s29, s25
    s_cselect_b32 s42, 1024, 0
    s_cselect_b32 s40, 72, 0
    s_sub_u32 s71, s2, s40
    s_lshl_b32 s41, s71, 7
    s_lshl_b32 s65, s71, 2
    s_add_u32 s65, s65, 0
    s_mul_i32 s66, s65, 57
    s_lshr_b32 s66, s66, 9
    s_mul_i32 s67, s66, 9
    s_sub_u32 s67, s65, s67
    s_mul_i32 s66, s66, 350208
    s_add_u32 s66, s66, s42
    s_add_u32 s66, s66, 20971520
    s_mov_b32 s72, 0
    s_mov_b32 s76, 0
    s_cmp_eq_u32 s67, 0
    s_cselect_b32 s72, 0, s72
    s_cselect_b32 s76, 10240, s76
    s_cmp_eq_u32 s67, 1
    s_cselect_b32 s72, 2048, s72
    s_cselect_b32 s76, 10240, s76
    s_cmp_eq_u32 s67, 2
    s_cselect_b32 s72, 4096, s72
    s_cselect_b32 s76, 10240, s76
    s_cmp_eq_u32 s67, 3
    s_cselect_b32 s72, 6144, s72
    s_cselect_b32 s76, 10240, s76
    s_cmp_eq_u32 s67, 4
    s_cselect_b32 s72, 194560, s72
    s_cselect_b32 s76, 4096, s76
    s_cmp_eq_u32 s67, 5
    s_cselect_b32 s72, 196608, s72
    s_cselect_b32 s76, 4096, s76
    s_cmp_eq_u32 s67, 6
    s_cselect_b32 s72, 272384, s72
    s_cselect_b32 s76, 4096, s76
    s_cmp_eq_u32 s67, 7
    s_cselect_b32 s72, 274432, s72
    s_cselect_b32 s76, 4096, s76
    s_cmp_eq_u32 s67, 8
    s_cselect_b32 s72, 8192, s72
    s_cselect_b32 s76, 10240, s76
    s_add_u32 s72, s72, s66
    s_lshl_b32 s65, s71, 2
    s_add_u32 s65, s65, 1
    s_mul_i32 s66, s65, 57
    s_lshr_b32 s66, s66, 9
    s_mul_i32 s67, s66, 9
    s_sub_u32 s67, s65, s67
    s_mul_i32 s66, s66, 350208
    s_add_u32 s66, s66, s42
    s_add_u32 s66, s66, 20971520
    s_mov_b32 s73, 0
    s_mov_b32 s77, 0
    s_cmp_eq_u32 s67, 0
    s_cselect_b32 s73, 0, s73
    s_cselect_b32 s77, 10240, s77
    s_cmp_eq_u32 s67, 1
    s_cselect_b32 s73, 2048, s73
    s_cselect_b32 s77, 10240, s77
    s_cmp_eq_u32 s67, 2
    s_cselect_b32 s73, 4096, s73
    s_cselect_b32 s77, 10240, s77
    s_cmp_eq_u32 s67, 3
    s_cselect_b32 s73, 6144, s73
    s_cselect_b32 s77, 10240, s77
    s_cmp_eq_u32 s67, 4
    s_cselect_b32 s73, 194560, s73
    s_cselect_b32 s77, 4096, s77
    s_cmp_eq_u32 s67, 5
    s_cselect_b32 s73, 196608, s73
    s_cselect_b32 s77, 4096, s77
    s_cmp_eq_u32 s67, 6
    s_cselect_b32 s73, 272384, s73
    s_cselect_b32 s77, 4096, s77
    s_cmp_eq_u32 s67, 7
    s_cselect_b32 s73, 274432, s73
    s_cselect_b32 s77, 4096, s77
    s_cmp_eq_u32 s67, 8
    s_cselect_b32 s73, 8192, s73
    s_cselect_b32 s77, 10240, s77
    s_add_u32 s73, s73, s66
    s_lshl_b32 s65, s71, 2
    s_add_u32 s65, s65, 2
    s_mul_i32 s66, s65, 57
    s_lshr_b32 s66, s66, 9
    s_mul_i32 s67, s66, 9
    s_sub_u32 s67, s65, s67
    s_mul_i32 s66, s66, 350208
    s_add_u32 s66, s66, s42
    s_add_u32 s66, s66, 20971520
    s_mov_b32 s74, 0
    s_mov_b32 s78, 0
    s_cmp_eq_u32 s67, 0
    s_cselect_b32 s74, 0, s74
    s_cselect_b32 s78, 10240, s78
    s_cmp_eq_u32 s67, 1
    s_cselect_b32 s74, 2048, s74
    s_cselect_b32 s78, 10240, s78
    s_cmp_eq_u32 s67, 2
    s_cselect_b32 s74, 4096, s74
    s_cselect_b32 s78, 10240, s78
    s_cmp_eq_u32 s67, 3
    s_cselect_b32 s74, 6144, s74
    s_cselect_b32 s78, 10240, s78
    s_cmp_eq_u32 s67, 4
    s_cselect_b32 s74, 194560, s74
    s_cselect_b32 s78, 4096, s78
    s_cmp_eq_u32 s67, 5
    s_cselect_b32 s74, 196608, s74
    s_cselect_b32 s78, 4096, s78
    s_cmp_eq_u32 s67, 6
    s_cselect_b32 s74, 272384, s74
    s_cselect_b32 s78, 4096, s78
    s_cmp_eq_u32 s67, 7
    s_cselect_b32 s74, 274432, s74
    s_cselect_b32 s78, 4096, s78
    s_cmp_eq_u32 s67, 8
    s_cselect_b32 s74, 8192, s74
    s_cselect_b32 s78, 10240, s78
    s_add_u32 s74, s74, s66
    s_lshl_b32 s65, s71, 2
    s_add_u32 s65, s65, 3
    s_mul_i32 s66, s65, 57
    s_lshr_b32 s66, s66, 9
    s_mul_i32 s67, s66, 9
    s_sub_u32 s67, s65, s67
    s_mul_i32 s66, s66, 350208
    s_add_u32 s66, s66, s42
    s_add_u32 s66, s66, 20971520
    s_mov_b32 s75, 0
    s_mov_b32 s79, 0
    s_cmp_eq_u32 s67, 0
    s_cselect_b32 s75, 0, s75
    s_cselect_b32 s79, 10240, s79
    s_cmp_eq_u32 s67, 1
    s_cselect_b32 s75, 2048, s75
    s_cselect_b32 s79, 10240, s79
    s_cmp_eq_u32 s67, 2
    s_cselect_b32 s75, 4096, s75
    s_cselect_b32 s79, 10240, s79
    s_cmp_eq_u32 s67, 3
    s_cselect_b32 s75, 6144, s75
    s_cselect_b32 s79, 10240, s79
    s_cmp_eq_u32 s67, 4
    s_cselect_b32 s75, 194560, s75
    s_cselect_b32 s79, 4096, s79
    s_cmp_eq_u32 s67, 5
    s_cselect_b32 s75, 196608, s75
    s_cselect_b32 s79, 4096, s79
    s_cmp_eq_u32 s67, 6
    s_cselect_b32 s75, 272384, s75
    s_cselect_b32 s79, 4096, s79
    s_cmp_eq_u32 s67, 7
    s_cselect_b32 s75, 274432, s75
    s_cselect_b32 s79, 4096, s79
    s_cmp_eq_u32 s67, 8
    s_cselect_b32 s75, 8192, s75
    s_cselect_b32 s79, 10240, s79
    s_add_u32 s75, s75, s66
    s_add_u32 s40, s21, 0
    s_mul_i32 s66, s40, 57
    s_lshr_b32 s66, s66, 9
    s_mul_i32 s67, s66, 9
    s_sub_u32 s67, s40, s67
    s_lshr_b32 s68, s67, 2
    s_mul_i32 s68, s68, 9
    s_and_b32 s65, s67, 3
    s_lshl_b32 s65, s65, 1
    s_add_u32 s68, s68, s65
    s_mov_b32 s69, 1
    s_cmp_eq_u32 s67, 8
    s_cselect_b32 s68, 8, s68
    s_cselect_b32 s69, 9, s69
    s_mul_i32 s66, s66, 18
    s_add_u32 s68, s68, s66
    s_add_u32 s69, s69, s68
    s_mul_i32 s64, s68, 147456
    s_add_u32 s64, s64, s41
    s_mul_i32 s65, s69, 147456
    s_add_u32 s65, s65, s41
    s_lshl_b32 s68, s68, 5
    s_lshl_b32 s69, s69, 5
    s_mul_i32 s66, s40, s76
    s_add_u32 s44, s66, s72
    s_mul_i32 s66, s40, s77
    s_add_u32 s45, s66, s73
    s_mul_i32 s66, s40, s78
    s_add_u32 s46, s66, s74
    s_mul_i32 s66, s40, s79
    s_add_u32 s47, s66, s75
    s_add_u32 s66, s64, 73728
    s_add_u32 s67, s65, 73728
    buffer_load_dwordx4 v[20:23], v5, s[24:27], s64 offen
    buffer_load_dwordx4 v[24:27], v5, s[24:27], s66 offen
    buffer_load_dwordx4 v[28:31], v5, s[24:27], s65 offen
    buffer_load_dwordx4 v[32:35], v5, s[24:27], s67 offen
    buffer_load_dwordx2 v[36:37], v17, s[16:19], s68 offen
    buffer_load_dwordx2 v[38:39], v17, s[16:19], s69 offen
    s_add_u32 s40, s21, 4
    s_mul_i32 s66, s40, 57
    s_lshr_b32 s66, s66, 9
    s_mul_i32 s67, s66, 9
    s_sub_u32 s67, s40, s67
    s_lshr_b32 s68, s67, 2
    s_mul_i32 s68, s68, 9
    s_and_b32 s65, s67, 3
    s_lshl_b32 s65, s65, 1
    s_add_u32 s68, s68, s65
    s_mov_b32 s69, 1
    s_cmp_eq_u32 s67, 8
    s_cselect_b32 s68, 8, s68
    s_cselect_b32 s69, 9, s69
    s_mul_i32 s66, s66, 18
    s_add_u32 s68, s68, s66
    s_add_u32 s69, s69, s68
    s_mul_i32 s64, s68, 147456
    s_add_u32 s64, s64, s41
    s_mul_i32 s65, s69, 147456
    s_add_u32 s65, s65, s41
    s_lshl_b32 s68, s68, 5
    s_lshl_b32 s69, s69, 5
    s_mul_i32 s66, s40, s76
    s_add_u32 s48, s66, s72
    s_mul_i32 s66, s40, s77
    s_add_u32 s49, s66, s73
    s_mul_i32 s66, s40, s78
    s_add_u32 s50, s66, s74
    s_mul_i32 s66, s40, s79
    s_add_u32 s51, s66, s75
    s_add_u32 s66, s64, 73728
    s_add_u32 s67, s65, 73728
    buffer_load_dwordx4 v[40:43], v5, s[24:27], s64 offen
    buffer_load_dwordx4 v[44:47], v5, s[24:27], s66 offen
    buffer_load_dwordx4 v[48:51], v5, s[24:27], s65 offen
    buffer_load_dwordx4 v[52:55], v5, s[24:27], s67 offen
    buffer_load_dwordx2 v[56:57], v17, s[16:19], s68 offen
    buffer_load_dwordx2 v[58:59], v17, s[16:19], s69 offen
    s_waitcnt vmcnt(12)
    s_barrier
    s_add_u32 s40, s21, 8
    s_mul_i32 s66, s40, 57
    s_lshr_b32 s66, s66, 9
    s_mul_i32 s67, s66, 9
    s_sub_u32 s67, s40, s67
    s_lshr_b32 s68, s67, 2
    s_mul_i32 s68, s68, 9
    s_and_b32 s65, s67, 3
    s_lshl_b32 s65, s65, 1
    s_add_u32 s68, s68, s65
    s_mov_b32 s69, 1
    s_cmp_eq_u32 s67, 8
    s_cselect_b32 s68, 8, s68
    s_cselect_b32 s69, 9, s69
    s_mul_i32 s66, s66, 18
    s_add_u32 s68, s68, s66
    s_add_u32 s69, s69, s68
    s_mul_i32 s64, s68, 147456
    s_add_u32 s64, s64, s41
    s_mul_i32 s65, s69, 147456
    s_add_u32 s65, s65, s41
    s_lshl_b32 s68, s68, 5
    s_lshl_b32 s69, s69, 5
    s_mul_i32 s66, s40, s76
    s_add_u32 s52, s66, s72
    s_mul_i32 s66, s40, s77
    s_add_u32 s53, s66, s73
    s_mul_i32 s66, s40, s78
    s_add_u32 s54, s66, s74
    s_mul_i32 s66, s40, s79
    s_add_u32 s55, s66, s75
    s_add_u32 s66, s64, 73728
    s_add_u32 s67, s65, 73728
    buffer_load_dwordx4 v[60:63], v5, s[24:27], s64 offen
    buffer_load_dwordx4 v[64:67], v5, s[24:27], s66 offen
    buffer_load_dwordx4 v[68:71], v5, s[24:27], s65 offen
    buffer_load_dwordx4 v[72:75], v5, s[24:27], s67 offen
    buffer_load_dwordx2 v[76:77], v17, s[16:19], s68 offen
    buffer_load_dwordx2 v[78:79], v17, s[16:19], s69 offen
    s_add_u32 s40, s21, 12
    s_mul_i32 s66, s40, 57
    s_lshr_b32 s66, s66, 9
    s_mul_i32 s67, s66, 9
    s_sub_u32 s67, s40, s67
    s_lshr_b32 s68, s67, 2
    s_mul_i32 s68, s68, 9
    s_and_b32 s65, s67, 3
    s_lshl_b32 s65, s65, 1
    s_add_u32 s68, s68, s65
    s_mov_b32 s69, 1
    s_cmp_eq_u32 s67, 8
    s_cselect_b32 s68, 8, s68
    s_cselect_b32 s69, 9, s69
    s_mul_i32 s66, s66, 18
    s_add_u32 s68, s68, s66
    s_add_u32 s69, s69, s68
    s_mul_i32 s64, s68, 147456
    s_add_u32 s64, s64, s41
    s_mul_i32 s65, s69, 147456
    s_add_u32 s65, s65, s41
    s_lshl_b32 s68, s68, 5
    s_lshl_b32 s69, s69, 5
    s_mul_i32 s66, s40, s76
    s_add_u32 s56, s66, s72
    s_mul_i32 s66, s40, s77
    s_add_u32 s57, s66, s73
    s_mul_i32 s66, s40, s78
    s_add_u32 s58, s66, s74
    s_mul_i32 s66, s40, s79
    s_add_u32 s59, s66, s75
    s_add_u32 s66, s64, 73728
    s_add_u32 s67, s65, 73728
    buffer_load_dwordx4 v[80:83], v5, s[24:27], s64 offen
    buffer_load_dwordx4 v[84:87], v5, s[24:27], s66 offen
    buffer_load_dwordx4 v[88:91], v5, s[24:27], s65 offen
    buffer_load_dwordx4 v[92:95], v5, s[24:27], s67 offen
    buffer_load_dwordx2 v[96:97], v17, s[16:19], s68 offen
    buffer_load_dwordx2 v[98:99], v17, s[16:19], s69 offen
    s_add_u32 s40, s21, 16
    s_mul_i32 s66, s40, 57
    s_lshr_b32 s66, s66, 9
    s_mul_i32 s67, s66, 9
    s_sub_u32 s67, s40, s67
    s_lshr_b32 s68, s67, 2
    s_mul_i32 s68, s68, 9
    s_and_b32 s65, s67, 3
    s_lshl_b32 s65, s65, 1
    s_add_u32 s68, s68, s65
    s_mov_b32 s69, 1
    s_cmp_eq_u32 s67, 8
    s_cselect_b32 s68, 8, s68
    s_cselect_b32 s69, 9, s69
    s_mul_i32 s66, s66, 18
    s_add_u32 s68, s68, s66
    s_add_u32 s69, s69, s68
    s_mul_i32 s64, s68, 147456
    s_add_u32 s64, s64, s41
    s_mul_i32 s65, s69, 147456
    s_add_u32 s65, s65, s41
    s_lshl_b32 s68, s68, 5
    s_lshl_b32 s69, s69, 5
    s_mul_i32 s66, s40, s76
    s_add_u32 s60, s66, s72
    s_mul_i32 s66, s40, s77
    s_add_u32 s61, s66, s73
    s_mul_i32 s66, s40, s78
    s_add_u32 s62, s66, s74
    s_mul_i32 s66, s40, s79
    s_add_u32 s63, s66, s75
    s_cmp_ge_u32 s40, 18
    s_cselect_b32 s64, 1073741824, s64
    s_cselect_b32 s65, 1073741824, s65
    s_cselect_b32 s60, 1073741824, s60
    s_cselect_b32 s61, 1073741824, s61
    s_cselect_b32 s62, 1073741824, s62
    s_cselect_b32 s63, 1073741824, s63
    s_add_u32 s66, s64, 73728
    s_add_u32 s67, s65, 73728
    buffer_load_dwordx4 v[100:103], v5, s[24:27], s64 offen
    buffer_load_dwordx4 v[104:107], v5, s[24:27], s66 offen
    buffer_load_dwordx4 v[108:111], v5, s[24:27], s65 offen
    buffer_load_dwordx4 v[112:115], v5, s[24:27], s67 offen
    buffer_load_dwordx2 v[116:117], v17, s[16:19], s68 offen
    buffer_load_dwordx2 v[118:119], v17, s[16:19], s69 offen
    s_waitcnt vmcnt(24)
    ds_write_b128 v11, v[20:23] offset:0
    ds_write_b128 v11, v[24:27] offset:1024
    ds_write_b128 v11, v[28:31] offset:2048
    ds_write_b128 v11, v[32:35] offset:3072
    s_waitcnt lgkmcnt(0)
    ds_read_b64_tr_b16 v[120:121], v13 offset:0
    ds_read_b64_tr_b16 v[122:123], v13 offset:2048
    ds_read_b64_tr_b16 v[124:125], v13 offset:32
    ds_read_b64_tr_b16 v[126:127], v13 offset:2080
    ds_read_b64_tr_b16 v[128:129], v13 offset:64
    ds_read_b64_tr_b16 v[130:131], v13 offset:2112
    ds_read_b64_tr_b16 v[132:133], v13 offset:96
    ds_read_b64_tr_b16 v[134:135], v13 offset:2144
    s_waitcnt lgkmcnt(0)
    buffer_store_dwordx4 v[120:123], v10, s[16:19], s44 offen sc1
    buffer_store_dwordx4 v[124:127], v10, s[16:19], s45 offen sc1
    buffer_store_dwordx4 v[128:131], v10, s[16:19], s46 offen sc1
    buffer_store_dwordx4 v[132:135], v10, s[16:19], s47 offen sc1
    v_mfma_f32_16x16x32_bf16 v[136:139], v[36:39], v[120:123], 0
    v_mfma_f32_16x16x32_bf16 v[140:143], v[36:39], v[124:127], 0
    v_mfma_f32_16x16x32_bf16 v[144:147], v[36:39], v[128:131], 0
    v_mfma_f32_16x16x32_bf16 v[148:151], v[36:39], v[132:135], 0
    s_nop 1
    s_waitcnt vmcnt(22)
    ds_write_b128 v11, v[40:43] offset:0
    ds_write_b128 v11, v[44:47] offset:1024
    ds_write_b128 v11, v[48:51] offset:2048
    ds_write_b128 v11, v[52:55] offset:3072
    s_waitcnt lgkmcnt(0)
    ds_read_b64_tr_b16 v[120:121], v13 offset:0
    ds_read_b64_tr_b16 v[122:123], v13 offset:2048
    ds_read_b64_tr_b16 v[124:125], v13 offset:32
    ds_read_b64_tr_b16 v[126:127], v13 offset:2080
    ds_read_b64_tr_b16 v[128:129], v13 offset:64
    ds_read_b64_tr_b16 v[130:131], v13 offset:2112
    ds_read_b64_tr_b16 v[132:133], v13 offset:96
    ds_read_b64_tr_b16 v[134:135], v13 offset:2144
    s_waitcnt lgkmcnt(0)
    buffer_store_dwordx4 v[120:123], v10, s[16:19], s48 offen sc1
    buffer_store_dwordx4 v[124:127], v10, s[16:19], s49 offen sc1
    buffer_store_dwordx4 v[128:131], v10, s[16:19], s50 offen sc1
    buffer_store_dwordx4 v[132:135], v10, s[16:19], s51 offen sc1
    v_mfma_f32_16x16x32_bf16 v[136:139], v[56:59], v[120:123], v[136:139]
    v_mfma_f32_16x16x32_bf16 v[140:143], v[56:59], v[124:127], v[140:143]
    v_mfma_f32_16x16x32_bf16 v[144:147], v[56:59], v[128:131], v[144:147]
    v_mfma_f32_16x16x32_bf16 v[148:151], v[56:59], v[132:135], v[148:151]
    s_nop 1
    s_waitcnt vmcnt(20)
    ds_write_b128 v11, v[60:63] offset:0
    ds_write_b128 v11, v[64:67] offset:1024
    ds_write_b128 v11, v[68:71] offset:2048
    ds_write_b128 v11, v[72:75] offset:3072
    s_waitcnt lgkmcnt(0)
    ds_read_b64_tr_b16 v[120:121], v13 offset:0
    ds_read_b64_tr_b16 v[122:123], v13 offset:2048
    ds_read_b64_tr_b16 v[124:125], v13 offset:32
    ds_read_b64_tr_b16 v[126:127], v13 offset:2080
    ds_read_b64_tr_b16 v[128:129], v13 offset:64
    ds_read_b64_tr_b16 v[130:131], v13 offset:2112
    ds_read_b64_tr_b16 v[132:133], v13 offset:96
    ds_read_b64_tr_b16 v[134:135], v13 offset:2144
    s_waitcnt lgkmcnt(0)
    buffer_store_dwordx4 v[120:123], v10, s[16:19], s52 offen sc1
    buffer_store_dwordx4 v[124:127], v10, s[16:19], s53 offen sc1
    buffer_store_dwordx4 v[128:131], v10, s[16:19], s54 offen sc1
    buffer_store_dwordx4 v[132:135], v10, s[16:19], s55 offen sc1
    v_mfma_f32_16x16x32_bf16 v[136:139], v[76:79], v[120:123], v[136:139]
    v_mfma_f32_16x16x32_bf16 v[140:143], v[76:79], v[124:127], v[140:143]
    v_mfma_f32_16x16x32_bf16 v[144:147], v[76:79], v[128:131], v[144:147]
    v_mfma_f32_16x16x32_bf16 v[148:151], v[76:79], v[132:135], v[148:151]
    s_nop 1
    s_waitcnt vmcnt(18)
    ds_write_b128 v11, v[80:83] offset:0
    ds_write_b128 v11, v[84:87] offset:1024
    ds_write_b128 v11, v[88:91] offset:2048
    ds_write_b128 v11, v[92:95] offset:3072
    s_waitcnt lgkmcnt(0)
    ds_read_b64_tr_b16 v[120:121], v13 offset:0
    ds_read_b64_tr_b16 v[122:123], v13 offset:2048
    ds_read_b64_tr_b16 v[124:125], v13 offset:32
    ds_read_b64_tr_b16 v[126:127], v13 offset:2080
    ds_read_b64_tr_b16 v[128:129], v13 offset:64
    ds_read_b64_tr_b16 v[130:131], v13 offset:2112
    ds_read_b64_tr_b16 v[132:133], v13 offset:96
    ds_read_b64_tr_b16 v[134:135], v13 offset:2144
    s_waitcnt lgkmcnt(0)
    buffer_store_dwordx4 v[120:123], v10, s[16:19], s56 offen sc1
    buffer_store_dwordx4 v[124:127], v10, s[16:19], s57 offen sc1
    buffer_store_dwordx4 v[128:131], v10, s[16:19], s58 offen sc1
    buffer_store_dwordx4 v[132:135], v10, s[16:19], s59 offen sc1
    v_mfma_f32_16x16x32_bf16 v[136:139], v[96:99], v[120:123], v[136:139]
    v_mfma_f32_16x16x32_bf16 v[140:143], v[96:99], v[124:127], v[140:143]
    v_mfma_f32_16x16x32_bf16 v[144:147], v[96:99], v[128:131], v[144:147]
    v_mfma_f32_16x16x32_bf16 v[148:151], v[96:99], v[132:135], v[148:151]
    s_nop 1
    s_waitcnt vmcnt(16)
    ds_write_b128 v11, v[100:103] offset:0
    ds_write_b128 v11, v[104:107] offset:1024
    ds_write_b128 v11, v[108:111] offset:2048
    ds_write_b128 v11, v[112:115] offset:3072
    s_waitcnt lgkmcnt(0)
    ds_read_b64_tr_b16 v[120:121], v13 offset:0
    ds_read_b64_tr_b16 v[122:123], v13 offset:2048
    ds_read_b64_tr_b16 v[124:125], v13 offset:32
    ds_read_b64_tr_b16 v[126:127], v13 offset:2080
    ds_read_b64_tr_b16 v[128:129], v13 offset:64
    ds_read_b64_tr_b16 v[130:131], v13 offset:2112
    ds_read_b64_tr_b16 v[132:133], v13 offset:96
    ds_read_b64_tr_b16 v[134:135], v13 offset:2144
    s_waitcnt lgkmcnt(0)
    buffer_store_dwordx4 v[120:123], v10, s[16:19], s60 offen sc1
    buffer_store_dwordx4 v[124:127], v10, s[16:19], s61 offen sc1
    buffer_store_dwordx4 v[128:131], v10, s[16:19], s62 offen sc1
    buffer_store_dwordx4 v[132:135], v10, s[16:19], s63 offen sc1
    v_mfma_f32_16x16x32_bf16 v[136:139], v[116:119], v[120:123], v[136:139]
    v_mfma_f32_16x16x32_bf16 v[140:143], v[116:119], v[124:127], v[140:143]
    v_mfma_f32_16x16x32_bf16 v[144:147], v[116:119], v[128:131], v[144:147]
    v_mfma_f32_16x16x32_bf16 v[148:151], v[116:119], v[132:135], v[148:151]
    s_nop 1
    v_mov_b32 v9, 1073741824
    v_cmp_gt_u32 vcc, 16, v1
    s_nop 1
    v_cndmask_b32 v8, v9, v10, vcc
    s_lshl_b32 s41, s21, 8
    v_cvt_pk_bf16_f32 v20, v136, v136
    v_lshlrev_b32 v20, 16, v20
    v_sub_f32 v136, v136, v20
    v_cvt_pk_bf16_f32 v21, v136, v136
    v_lshlrev_b32 v21, 16, v21
    v_sub_f32 v136, v136, v21
    v_cvt_pk_bf16_f32 v22, v136, v136
    v_lshlrev_b32 v22, 16, v22
    v_cvt_pk_bf16_f32 v23, v137, v137
    v_lshlrev_b32 v23, 16, v23
    v_sub_f32 v137, v137, v23
    v_cvt_pk_bf16_f32 v24, v137, v137
    v_lshlrev_b32 v24, 16, v24
    v_sub_f32 v137, v137, v24
    v_cvt_pk_bf16_f32 v25, v137, v137
    v_lshlrev_b32 v25, 16, v25
    v_cvt_pk_bf16_f32 v120, v20, v21
    v_cvt_pk_bf16_f32 v121, v22, v23
    v_cvt_pk_bf16_f32 v122, v24, v25
    v_mov_b32 v123, 0
    s_mul_i32 s40, s76, 18
    s_add_u32 s40, s40, s72
    s_add_u32 s40, s40, s41
    buffer_store_dwordx4 v[120:123], v8, s[16:19], s40 offen sc1
    v_cvt_pk_bf16_f32 v20, v140, v140
    v_lshlrev_b32 v20, 16, v20
    v_sub_f32 v140, v140, v20
    v_cvt_pk_bf16_f32 v21, v140, v140
    v_lshlrev_b32 v21, 16, v21
    v_sub_f32 v140, v140, v21
    v_cvt_pk_bf16_f32 v22, v140, v140
    v_lshlrev_b32 v22, 16, v22
    v_cvt_pk_bf16_f32 v23, v141, v141
    v_lshlrev_b32 v23, 16, v23
    v_sub_f32 v141, v141, v23
    v_cvt_pk_bf16_f32 v24, v141, v141
    v_lshlrev_b32 v24, 16, v24
    v_sub_f32 v141, v141, v24
    v_cvt_pk_bf16_f32 v25, v141, v141
    v_lshlrev_b32 v25, 16, v25
    v_cvt_pk_bf16_f32 v124, v20, v21
    v_cvt_pk_bf16_f32 v125, v22, v23
    v_cvt_pk_bf16_f32 v126, v24, v25
    v_mov_b32 v127, 0
    s_mul_i32 s40, s77, 18
    s_add_u32 s40, s40, s73
    s_add_u32 s40, s40, s41
    buffer_store_dwordx4 v[124:127], v8, s[16:19], s40 offen sc1
    v_cvt_pk_bf16_f32 v20, v144, v144
    v_lshlrev_b32 v20, 16, v20
    v_sub_f32 v144, v144, v20
    v_cvt_pk_bf16_f32 v21, v144, v144
    v_lshlrev_b32 v21, 16, v21
    v_sub_f32 v144, v144, v21
    v_cvt_pk_bf16_f32 v22, v144, v144
    v_lshlrev_b32 v22, 16, v22
    v_cvt_pk_bf16_f32 v23, v145, v145
    v_lshlrev_b32 v23, 16, v23
    v_sub_f32 v145, v145, v23
    v_cvt_pk_bf16_f32 v24, v145, v145
    v_lshlrev_b32 v24, 16, v24
    v_sub_f32 v145, v145, v24
    v_cvt_pk_bf16_f32 v25, v145, v145
    v_lshlrev_b32 v25, 16, v25
    v_cvt_pk_bf16_f32 v128, v20, v21
    v_cvt_pk_bf16_f32 v129, v22, v23
    v_cvt_pk_bf16_f32 v130, v24, v25
    v_mov_b32 v131, 0
    s_mul_i32 s40, s78, 18
    s_add_u32 s40, s40, s74
    s_add_u32 s40, s40, s41
    buffer_store_dwordx4 v[128:131], v8, s[16:19], s40 offen sc1
    v_cvt_pk_bf16_f32 v20, v148, v148
    v_lshlrev_b32 v20, 16, v20
    v_sub_f32 v148, v148, v20
    v_cvt_pk_bf16_f32 v21, v148, v148
    v_lshlrev_b32 v21, 16, v21
    v_sub_f32 v148, v148, v21
    v_cvt_pk_bf16_f32 v22, v148, v148
    v_lshlrev_b32 v22, 16, v22
    v_cvt_pk_bf16_f32 v23, v149, v149
    v_lshlrev_b32 v23, 16, v23
    v_sub_f32 v149, v149, v23
    v_cvt_pk_bf16_f32 v24, v149, v149
    v_lshlrev_b32 v24, 16, v24
    v_sub_f32 v149, v149, v24
    v_cvt_pk_bf16_f32 v25, v149, v149
    v_lshlrev_b32 v25, 16, v25
    v_cvt_pk_bf16_f32 v132, v20, v21
    v_cvt_pk_bf16_f32 v133, v22, v23
    v_cvt_pk_bf16_f32 v134, v24, v25
    v_mov_b32 v135, 0
    s_mul_i32 s40, s79, 18
    s_add_u32 s40, s40, s75
    s_add_u32 s40, s40, s41
    buffer_store_dwordx4 v[132:135], v8, s[16:19], s40 offen sc1
    s_endpgm
K3_PACK_B:
    s_sub_u32 s70, s2, 144
    s_lshl_b32 s70, s70, 2
    s_add_u32 s70, s70, s21
    s_add_u32 s40, s70, 0
    s_mul_i32 s41, s40, 1821
    s_lshr_b32 s41, s41, 14
    s_mul_i32 s42, s41, 9
    s_sub_u32 s42, s40, s42
    s_lshl_b32 s64, s42, 7
    s_mul_i32 s43, s41, 41472
    s_mul_i32 s65, s41, 331776
    s_sub_u32 s65, s65, 5289984
    s_mov_b32 s68, 9216
    s_mov_b32 s69, 11520
    s_cmp_ge_u32 s41, 16
    s_cselect_b32 s43, s65, s43
    s_cselect_b64 s[66:67], -1, 0
    s_cselect_b32 s68, 41472, s68
    s_cselect_b32 s69, 124416, s69
    v_cndmask_b32 v8, v6, v7, s[66:67]
    s_add_u32 s43, s43, s64
    s_cmp_ge_u32 s40, 162
    s_cselect_b32 s43, 1073741824, s43
    buffer_load_dwordx4 v[20:23], v8, s[36:39], s43 offen
    s_add_u32 s43, s43, s68
    buffer_load_dwordx4 v[24:27], v8, s[36:39], s43 offen
    s_add_u32 s43, s43, s69
    buffer_load_dwordx4 v[28:31], v8, s[36:39], s43 offen
    s_add_u32 s43, s43, s68
    buffer_load_dwordx4 v[32:35], v8, s[36:39], s43 offen
    s_lshl_b32 s65, s42, 2
    s_add_u32 s65, s65, 0
    s_mul_i32 s66, s65, 29
    s_lshr_b32 s66, s66, 8
    s_mul_i32 s67, s66, 9
    s_sub_u32 s67, s65, s67
    s_mul_i32 s66, s66, 180
    s_mul_i32 s65, s41, 5
    s_min_u32 s68, s67, 4
    s_add_u32 s65, s65, s68
    s_lshl_b32 s68, s41, 2
    s_add_u32 s68, s68, s67
    s_add_u32 s68, s68, 86
    s_and_b32 s69, s67, 4
    s_cmp_lg_u32 s69, 0
    s_cselect_b32 s65, s68, s65
    s_add_u32 s65, s65, s66
    s_lshl_b32 s65, s65, 10
    s_add_u32 s65, s65, 12582912
    s_cmp_ge_u32 s40, 162
    s_cselect_b32 s44, 1073741824, s65
    s_lshl_b32 s65, s42, 2
    s_add_u32 s65, s65, 1
    s_mul_i32 s66, s65, 29
    s_lshr_b32 s66, s66, 8
    s_mul_i32 s67, s66, 9
    s_sub_u32 s67, s65, s67
    s_mul_i32 s66, s66, 180
    s_mul_i32 s65, s41, 5
    s_min_u32 s68, s67, 4
    s_add_u32 s65, s65, s68
    s_lshl_b32 s68, s41, 2
    s_add_u32 s68, s68, s67
    s_add_u32 s68, s68, 86
    s_and_b32 s69, s67, 4
    s_cmp_lg_u32 s69, 0
    s_cselect_b32 s65, s68, s65
    s_add_u32 s65, s65, s66
    s_lshl_b32 s65, s65, 10
    s_add_u32 s65, s65, 12582912
    s_cmp_ge_u32 s40, 162
    s_cselect_b32 s45, 1073741824, s65
    s_lshl_b32 s65, s42, 2
    s_add_u32 s65, s65, 2
    s_mul_i32 s66, s65, 29
    s_lshr_b32 s66, s66, 8
    s_mul_i32 s67, s66, 9
    s_sub_u32 s67, s65, s67
    s_mul_i32 s66, s66, 180
    s_mul_i32 s65, s41, 5
    s_min_u32 s68, s67, 4
    s_add_u32 s65, s65, s68
    s_lshl_b32 s68, s41, 2
    s_add_u32 s68, s68, s67
    s_add_u32 s68, s68, 86
    s_and_b32 s69, s67, 4
    s_cmp_lg_u32 s69, 0
    s_cselect_b32 s65, s68, s65
    s_add_u32 s65, s65, s66
    s_lshl_b32 s65, s65, 10
    s_add_u32 s65, s65, 12582912
    s_cmp_ge_u32 s40, 162
    s_cselect_b32 s46, 1073741824, s65
    s_lshl_b32 s65, s42, 2
    s_add_u32 s65, s65, 3
    s_mul_i32 s66, s65, 29
    s_lshr_b32 s66, s66, 8
    s_mul_i32 s67, s66, 9
    s_sub_u32 s67, s65, s67
    s_mul_i32 s66, s66, 180
    s_mul_i32 s65, s41, 5
    s_min_u32 s68, s67, 4
    s_add_u32 s65, s65, s68
    s_lshl_b32 s68, s41, 2
    s_add_u32 s68, s68, s67
    s_add_u32 s68, s68, 86
    s_and_b32 s69, s67, 4
    s_cmp_lg_u32 s69, 0
    s_cselect_b32 s65, s68, s65
    s_add_u32 s65, s65, s66
    s_lshl_b32 s65, s65, 10
    s_add_u32 s65, s65, 12582912
    s_cmp_ge_u32 s40, 162
    s_cselect_b32 s47, 1073741824, s65
    s_add_u32 s40, s70, 0
    s_mul_i32 s41, s40, 1821
    s_lshr_b32 s41, s41, 14
    s_mul_i32 s42, s41, 9
    s_sub_u32 s42, s40, s42
    s_lshl_b32 s64, s42, 7
    s_mul_i32 s66, s41, 57
    s_lshr_b32 s66, s66, 9
    s_mul_i32 s67, s66, 9
    s_sub_u32 s67, s41, s67
    s_lshr_b32 s43, s67, 2
    s_mul_i32 s43, s43, 9
    s_and_b32 s65, s67, 3
    s_lshl_b32 s65, s65, 1
    s_add_u32 s43, s43, s65
    s_mov_b32 s68, 9216
    s_cmp_eq_u32 s67, 8
    s_cselect_b32 s43, 8, s43
    s_cselect_b32 s68, 156672, s68
    s_mul_i32 s66, s66, 18
    s_add_u32 s43, s43, s66
    s_mul_i32 s43, s43, 18432
    s_add_u32 s43, s43, s64
    s_cmp_ge_u32 s40, 1296
    s_cselect_b32 s43, 1073741824, s43
    buffer_load_dwordx4 v[40:43], v6, s[32:35], s43 offen
    s_add_u32 s43, s43, 9216
    buffer_load_dwordx4 v[44:47], v6, s[32:35], s43 offen
    s_add_u32 s43, s43, s68
    buffer_load_dwordx4 v[48:51], v6, s[32:35], s43 offen
    s_add_u32 s43, s43, 9216
    buffer_load_dwordx4 v[52:55], v6, s[32:35], s43 offen
    s_mul_i32 s80, s41, 57
    s_lshr_b32 s80, s80, 11
    s_mul_i32 s81, s80, 36
    s_sub_u32 s81, s41, s81
    s_mul_i32 s82, s81, 29
    s_lshr_b32 s82, s82, 8
    s_mul_i32 s83, s82, 9
    s_sub_u32 s83, s81, s83
    s_mul_i32 s65, s82, 7
    s_add_u32 s65, s65, s83
    s_cmp_gt_u32 s83, 3
    s_subb_u32 s65, s65, 0
    s_cmp_gt_u32 s83, 7
    s_subb_u32 s65, s65, 0
    s_lshl_b32 s82, s82, 1
    s_lshr_b32 s66, s83, 2
    s_add_u32 s82, s82, s66
    s_add_u32 s82, s82, 28
    s_and_b32 s66, s83, 11
    s_cmp_eq_u32 s66, 3
    s_cselect_b32 s82, s82, s65
    s_mul_i32 s82, s82, 9
    s_lshl_b32 s65, s42, 2
    s_add_u32 s65, s65, 0
    s_mul_i32 s66, s65, 29
    s_lshr_b32 s66, s66, 8
    s_mul_i32 s67, s66, 9
    s_sub_u32 s67, s65, s67
    s_lshl_b32 s66, s66, 2
    s_add_u32 s66, s66, s80
    s_mul_i32 s66, s66, 324
    s_lshr_b32 s65, s67, 1
    s_sub_u32 s65, s65, s80
    s_add_u32 s65, s65, 3
    s_and_b32 s65, s65, 3
    s_lshl_b32 s68, s65, 1
    s_add_u32 s68, s68, s82
    s_add_u32 s69, s82, 7
    s_cmp_ge_u32 s65, 3
    s_cselect_b32 s68, s69, s68
    s_and_b32 s69, s67, 1
    s_add_u32 s68, s68, s69
    s_add_u32 s69, s82, 6
    s_cmp_eq_u32 s67, 8
    s_cselect_b32 s68, s69, s68
    s_add_u32 s66, s66, s68
    s_lshl_b32 s66, s66, 10
    s_add_u32 s66, s66, 33554432
    s_cmp_ge_u32 s40, 1296
    s_cselect_b32 s48, 1073741824, s66
    s_lshl_b32 s65, s42, 2
    s_add_u32 s65, s65, 1
    s_mul_i32 s66, s65, 29
    s_lshr_b32 s66, s66, 8
    s_mul_i32 s67, s66, 9
    s_sub_u32 s67, s65, s67
    s_lshl_b32 s66, s66, 2
    s_add_u32 s66, s66, s80
    s_mul_i32 s66, s66, 324
    s_lshr_b32 s65, s67, 1
    s_sub_u32 s65, s65, s80
    s_add_u32 s65, s65, 3
    s_and_b32 s65, s65, 3
    s_lshl_b32 s68, s65, 1
    s_add_u32 s68, s68, s82
    s_add_u32 s69, s82, 7
    s_cmp_ge_u32 s65, 3
    s_cselect_b32 s68, s69, s68
    s_and_b32 s69, s67, 1
    s_add_u32 s68, s68, s69
    s_add_u32 s69, s82, 6
    s_cmp_eq_u32 s67, 8
    s_cselect_b32 s68, s69, s68
    s_add_u32 s66, s66, s68
    s_lshl_b32 s66, s66, 10
    s_add_u32 s66, s66, 33554432
    s_cmp_ge_u32 s40, 1296
    s_cselect_b32 s49, 1073741824, s66
    s_lshl_b32 s65, s42, 2
    s_add_u32 s65, s65, 2
    s_mul_i32 s66, s65, 29
    s_lshr_b32 s66, s66, 8
    s_mul_i32 s67, s66, 9
    s_sub_u32 s67, s65, s67
    s_lshl_b32 s66, s66, 2
    s_add_u32 s66, s66, s80
    s_mul_i32 s66, s66, 324
    s_lshr_b32 s65, s67, 1
    s_sub_u32 s65, s65, s80
    s_add_u32 s65, s65, 3
    s_and_b32 s65, s65, 3
    s_lshl_b32 s68, s65, 1
    s_add_u32 s68, s68, s82
    s_add_u32 s69, s82, 7
    s_cmp_ge_u32 s65, 3
    s_cselect_b32 s68, s69, s68
    s_and_b32 s69, s67, 1
    s_add_u32 s68, s68, s69
    s_add_u32 s69, s82, 6
    s_cmp_eq_u32 s67, 8
    s_cselect_b32 s68, s69, s68
    s_add_u32 s66, s66, s68
    s_lshl_b32 s66, s66, 10
    s_add_u32 s66, s66, 33554432
    s_cmp_ge_u32 s40, 1296
    s_cselect_b32 s50, 1073741824, s66
    s_lshl_b32 s65, s42, 2
    s_add_u32 s65, s65, 3
    s_mul_i32 s66, s65, 29
    s_lshr_b32 s66, s66, 8
    s_mul_i32 s67, s66, 9
    s_sub_u32 s67, s65, s67
    s_lshl_b32 s66, s66, 2
    s_add_u32 s66, s66, s80
    s_mul_i32 s66, s66, 324
    s_lshr_b32 s65, s67, 1
    s_sub_u32 s65, s65, s80
    s_add_u32 s65, s65, 3
    s_and_b32 s65, s65, 3
    s_lshl_b32 s68, s65, 1
    s_add_u32 s68, s68, s82
    s_add_u32 s69, s82, 7
    s_cmp_ge_u32 s65, 3
    s_cselect_b32 s68, s69, s68
    s_and_b32 s69, s67, 1
    s_add_u32 s68, s68, s69
    s_add_u32 s69, s82, 6
    s_cmp_eq_u32 s67, 8
    s_cselect_b32 s68, s69, s68
    s_add_u32 s66, s66, s68
    s_lshl_b32 s66, s66, 10
    s_add_u32 s66, s66, 33554432
    s_cmp_ge_u32 s40, 1296
    s_cselect_b32 s51, 1073741824, s66
    s_waitcnt vmcnt(8)
    s_barrier
    s_add_u32 s40, s70, 448
    s_mul_i32 s41, s40, 1821
    s_lshr_b32 s41, s41, 14
    s_mul_i32 s42, s41, 9
    s_sub_u32 s42, s40, s42
    s_lshl_b32 s64, s42, 7
    s_mul_i32 s66, s41, 57
    s_lshr_b32 s66, s66, 9
    s_mul_i32 s67, s66, 9
    s_sub_u32 s67, s41, s67
    s_lshr_b32 s43, s67, 2
    s_mul_i32 s43, s43, 9
    s_and_b32 s65, s67, 3
    s_lshl_b32 s65, s65, 1
    s_add_u32 s43, s43, s65
    s_mov_b32 s68, 9216
    s_cmp_eq_u32 s67, 8
    s_cselect_b32 s43, 8, s43
    s_cselect_b32 s68, 156672, s68
    s_mul_i32 s66, s66, 18
    s_add_u32 s43, s43, s66
    s_mul_i32 s43, s43, 18432
    s_add_u32 s43, s43, s64
    s_cmp_ge_u32 s40, 1296
    s_cselect_b32 s43, 1073741824, s43
    buffer_load_dwordx4 v[60:63], v6, s[32:35], s43 offen
    s_add_u32 s43, s43, 9216
    buffer_load_dwordx4 v[64:67], v6, s[32:35], s43 offen
    s_add_u32 s43, s43, s68
    buffer_load_dwordx4 v[68:71], v6, s[32:35], s43 offen
    s_add_u32 s43, s43, 9216
    buffer_load_dwordx4 v[72:75], v6, s[32:35], s43 offen
    s_mul_i32 s80, s41, 57
    s_lshr_b32 s80, s80, 11
    s_mul_i32 s81, s80, 36
    s_sub_u32 s81, s41, s81
    s_mul_i32 s82, s81, 29
    s_lshr_b32 s82, s82, 8
    s_mul_i32 s83, s82, 9
    s_sub_u32 s83, s81, s83
    s_mul_i32 s65, s82, 7
    s_add_u32 s65, s65, s83
    s_cmp_gt_u32 s83, 3
    s_subb_u32 s65, s65, 0
    s_cmp_gt_u32 s83, 7
    s_subb_u32 s65, s65, 0
    s_lshl_b32 s82, s82, 1
    s_lshr_b32 s66, s83, 2
    s_add_u32 s82, s82, s66
    s_add_u32 s82, s82, 28
    s_and_b32 s66, s83, 11
    s_cmp_eq_u32 s66, 3
    s_cselect_b32 s82, s82, s65
    s_mul_i32 s82, s82, 9
    s_lshl_b32 s65, s42, 2
    s_add_u32 s65, s65, 0
    s_mul_i32 s66, s65, 29
    s_lshr_b32 s66, s66, 8
    s_mul_i32 s67, s66, 9
    s_sub_u32 s67, s65, s67
    s_lshl_b32 s66, s66, 2
    s_add_u32 s66, s66, s80
    s_mul_i32 s66, s66, 324
    s_lshr_b32 s65, s67, 1
    s_sub_u32 s65, s65, s80
    s_add_u32 s65, s65, 3
    s_and_b32 s65, s65, 3
    s_lshl_b32 s68, s65, 1
    s_add_u32 s68, s68, s82
    s_add_u32 s69, s82, 7
    s_cmp_ge_u32 s65, 3
    s_cselect_b32 s68, s69, s68
    s_and_b32 s69, s67, 1
    s_add_u32 s68, s68, s69
    s_add_u32 s69, s82, 6
    s_cmp_eq_u32 s67, 8
    s_cselect_b32 s68, s69, s68
    s_add_u32 s66, s66, s68
    s_lshl_b32 s66, s66, 10
    s_add_u32 s66, s66, 33554432
    s_cmp_ge_u32 s40, 1296
    s_cselect_b32 s52, 1073741824, s66
    s_lshl_b32 s65, s42, 2
    s_add_u32 s65, s65, 1
    s_mul_i32 s66, s65, 29
    s_lshr_b32 s66, s66, 8
    s_mul_i32 s67, s66, 9
    s_sub_u32 s67, s65, s67
    s_lshl_b32 s66, s66, 2
    s_add_u32 s66, s66, s80
    s_mul_i32 s66, s66, 324
    s_lshr_b32 s65, s67, 1
    s_sub_u32 s65, s65, s80
    s_add_u32 s65, s65, 3
    s_and_b32 s65, s65, 3
    s_lshl_b32 s68, s65, 1
    s_add_u32 s68, s68, s82
    s_add_u32 s69, s82, 7
    s_cmp_ge_u32 s65, 3
    s_cselect_b32 s68, s69, s68
    s_and_b32 s69, s67, 1
    s_add_u32 s68, s68, s69
    s_add_u32 s69, s82, 6
    s_cmp_eq_u32 s67, 8
    s_cselect_b32 s68, s69, s68
    s_add_u32 s66, s66, s68
    s_lshl_b32 s66, s66, 10
    s_add_u32 s66, s66, 33554432
    s_cmp_ge_u32 s40, 1296
    s_cselect_b32 s53, 1073741824, s66
    s_lshl_b32 s65, s42, 2
    s_add_u32 s65, s65, 2
    s_mul_i32 s66, s65, 29
    s_lshr_b32 s66, s66, 8
    s_mul_i32 s67, s66, 9
    s_sub_u32 s67, s65, s67
    s_lshl_b32 s66, s66, 2
    s_add_u32 s66, s66, s80
    s_mul_i32 s66, s66, 324
    s_lshr_b32 s65, s67, 1
    s_sub_u32 s65, s65, s80
    s_add_u32 s65, s65, 3
    s_and_b32 s65, s65, 3
    s_lshl_b32 s68, s65, 1
    s_add_u32 s68, s68, s82
    s_add_u32 s69, s82, 7
    s_cmp_ge_u32 s65, 3
    s_cselect_b32 s68, s69, s68
    s_and_b32 s69, s67, 1
    s_add_u32 s68, s68, s69
    s_add_u32 s69, s82, 6
    s_cmp_eq_u32 s67, 8
    s_cselect_b32 s68, s69, s68
    s_add_u32 s66, s66, s68
    s_lshl_b32 s66, s66, 10
    s_add_u32 s66, s66, 33554432
    s_cmp_ge_u32 s40, 1296
    s_cselect_b32 s54, 1073741824, s66
    s_lshl_b32 s65, s42, 2
    s_add_u32 s65, s65, 3
    s_mul_i32 s66, s65, 29
    s_lshr_b32 s66, s66, 8
    s_mul_i32 s67, s66, 9
    s_sub_u32 s67, s65, s67
    s_lshl_b32 s66, s66, 2
    s_add_u32 s66, s66, s80
    s_mul_i32 s66, s66, 324
    s_lshr_b32 s65, s67, 1
    s_sub_u32 s65, s65, s80
    s_add_u32 s65, s65, 3
    s_and_b32 s65, s65, 3
    s_lshl_b32 s68, s65, 1
    s_add_u32 s68, s68, s82
    s_add_u32 s69, s82, 7
    s_cmp_ge_u32 s65, 3
    s_cselect_b32 s68, s69, s68
    s_and_b32 s69, s67, 1
    s_add_u32 s68, s68, s69
    s_add_u32 s69, s82, 6
    s_cmp_eq_u32 s67, 8
    s_cselect_b32 s68, s69, s68
    s_add_u32 s66, s66, s68
    s_lshl_b32 s66, s66, 10
    s_add_u32 s66, s66, 33554432
    s_cmp_ge_u32 s40, 1296
    s_cselect_b32 s55, 1073741824, s66
    s_add_u32 s40, s70, 896
    s_mul_i32 s41, s40, 1821
    s_lshr_b32 s41, s41, 14
    s_mul_i32 s42, s41, 9
    s_sub_u32 s42, s40, s42
    s_lshl_b32 s64, s42, 7
    s_mul_i32 s66, s41, 57
    s_lshr_b32 s66, s66, 9
    s_mul_i32 s67, s66, 9
    s_sub_u32 s67, s41, s67
    s_lshr_b32 s43, s67, 2
    s_mul_i32 s43, s43, 9
    s_and_b32 s65, s67, 3
    s_lshl_b32 s65, s65, 1
    s_add_u32 s43, s43, s65
    s_mov_b32 s68, 9216
    s_cmp_eq_u32 s67, 8
    s_cselect_b32 s43, 8, s43
    s_cselect_b32 s68, 156672, s68
    s_mul_i32 s66, s66, 18
    s_add_u32 s43, s43, s66
    s_mul_i32 s43, s43, 18432
    s_add_u32 s43, s43, s64
    s_cmp_ge_u32 s40, 1296
    s_cselect_b32 s43, 1073741824, s43
    buffer_load_dwordx4 v[80:83], v6, s[32:35], s43 offen
    s_add_u32 s43, s43, 9216
    buffer_load_dwordx4 v[84:87], v6, s[32:35], s43 offen
    s_add_u32 s43, s43, s68
    buffer_load_dwordx4 v[88:91], v6, s[32:35], s43 offen
    s_add_u32 s43, s43, 9216
    buffer_load_dwordx4 v[92:95], v6, s[32:35], s43 offen
    s_mul_i32 s80, s41, 57
    s_lshr_b32 s80, s80, 11
    s_mul_i32 s81, s80, 36
    s_sub_u32 s81, s41, s81
    s_mul_i32 s82, s81, 29
    s_lshr_b32 s82, s82, 8
    s_mul_i32 s83, s82, 9
    s_sub_u32 s83, s81, s83
    s_mul_i32 s65, s82, 7
    s_add_u32 s65, s65, s83
    s_cmp_gt_u32 s83, 3
    s_subb_u32 s65, s65, 0
    s_cmp_gt_u32 s83, 7
    s_subb_u32 s65, s65, 0
    s_lshl_b32 s82, s82, 1
    s_lshr_b32 s66, s83, 2
    s_add_u32 s82, s82, s66
    s_add_u32 s82, s82, 28
    s_and_b32 s66, s83, 11
    s_cmp_eq_u32 s66, 3
    s_cselect_b32 s82, s82, s65
    s_mul_i32 s82, s82, 9
    s_lshl_b32 s65, s42, 2
    s_add_u32 s65, s65, 0
    s_mul_i32 s66, s65, 29
    s_lshr_b32 s66, s66, 8
    s_mul_i32 s67, s66, 9
    s_sub_u32 s67, s65, s67
    s_lshl_b32 s66, s66, 2
    s_add_u32 s66, s66, s80
    s_mul_i32 s66, s66, 324
    s_lshr_b32 s65, s67, 1
    s_sub_u32 s65, s65, s80
    s_add_u32 s65, s65, 3
    s_and_b32 s65, s65, 3
    s_lshl_b32 s68, s65, 1
    s_add_u32 s68, s68, s82
    s_add_u32 s69, s82, 7
    s_cmp_ge_u32 s65, 3
    s_cselect_b32 s68, s69, s68
    s_and_b32 s69, s67, 1
    s_add_u32 s68, s68, s69
    s_add_u32 s69, s82, 6
    s_cmp_eq_u32 s67, 8
    s_cselect_b32 s68, s69, s68
    s_add_u32 s66, s66, s68
    s_lshl_b32 s66, s66, 10
    s_add_u32 s66, s66, 33554432
    s_cmp_ge_u32 s40, 1296
    s_cselect_b32 s56, 1073741824, s66
    s_lshl_b32 s65, s42, 2
    s_add_u32 s65, s65, 1
    s_mul_i32 s66, s65, 29
    s_lshr_b32 s66, s66, 8
    s_mul_i32 s67, s66, 9
    s_sub_u32 s67, s65, s67
    s_lshl_b32 s66, s66, 2
    s_add_u32 s66, s66, s80
    s_mul_i32 s66, s66, 324
    s_lshr_b32 s65, s67, 1
    s_sub_u32 s65, s65, s80
    s_add_u32 s65, s65, 3
    s_and_b32 s65, s65, 3
    s_lshl_b32 s68, s65, 1
    s_add_u32 s68, s68, s82
    s_add_u32 s69, s82, 7
    s_cmp_ge_u32 s65, 3
    s_cselect_b32 s68, s69, s68
    s_and_b32 s69, s67, 1
    s_add_u32 s68, s68, s69
    s_add_u32 s69, s82, 6
    s_cmp_eq_u32 s67, 8
    s_cselect_b32 s68, s69, s68
    s_add_u32 s66, s66, s68
    s_lshl_b32 s66, s66, 10
    s_add_u32 s66, s66, 33554432
    s_cmp_ge_u32 s40, 1296
    s_cselect_b32 s57, 1073741824, s66
    s_lshl_b32 s65, s42, 2
    s_add_u32 s65, s65, 2
    s_mul_i32 s66, s65, 29
    s_lshr_b32 s66, s66, 8
    s_mul_i32 s67, s66, 9
    s_sub_u32 s67, s65, s67
    s_lshl_b32 s66, s66, 2
    s_add_u32 s66, s66, s80
    s_mul_i32 s66, s66, 324
    s_lshr_b32 s65, s67, 1
    s_sub_u32 s65, s65, s80
    s_add_u32 s65, s65, 3
    s_and_b32 s65, s65, 3
    s_lshl_b32 s68, s65, 1
    s_add_u32 s68, s68, s82
    s_add_u32 s69, s82, 7
    s_cmp_ge_u32 s65, 3
    s_cselect_b32 s68, s69, s68
    s_and_b32 s69, s67, 1
    s_add_u32 s68, s68, s69
    s_add_u32 s69, s82, 6
    s_cmp_eq_u32 s67, 8
    s_cselect_b32 s68, s69, s68
    s_add_u32 s66, s66, s68
    s_lshl_b32 s66, s66, 10
    s_add_u32 s66, s66, 33554432
    s_cmp_ge_u32 s40, 1296
    s_cselect_b32 s58, 1073741824, s66
    s_lshl_b32 s65, s42, 2
    s_add_u32 s65, s65, 3
    s_mul_i32 s66, s65, 29
    s_lshr_b32 s66, s66, 8
    s_mul_i32 s67, s66, 9
    s_sub_u32 s67, s65, s67
    s_lshl_b32 s66, s66, 2
    s_add_u32 s66, s66, s80
    s_mul_i32 s66, s66, 324
    s_lshr_b32 s65, s67, 1
    s_sub_u32 s65, s65, s80
    s_add_u32 s65, s65, 3
    s_and_b32 s65, s65, 3
    s_lshl_b32 s68, s65, 1
    s_add_u32 s68, s68, s82
    s_add_u32 s69, s82, 7
    s_cmp_ge_u32 s65, 3
    s_cselect_b32 s68, s69, s68
    s_and_b32 s69, s67, 1
    s_add_u32 s68, s68, s69
    s_add_u32 s69, s82, 6
    s_cmp_eq_u32 s67, 8
    s_cselect_b32 s68, s69, s68
    s_add_u32 s66, s66, s68
    s_lshl_b32 s66, s66, 10
    s_add_u32 s66, s66, 33554432
    s_cmp_ge_u32 s40, 1296
    s_cselect_b32 s59, 1073741824, s66
    s_waitcnt vmcnt(12)
    ds_write_b128 v11, v[20:23] offset:0
    ds_write_b128 v11, v[24:27] offset:1024
    ds_write_b128 v11, v[28:31] offset:2048
    ds_write_b128 v11, v[32:35] offset:3072
    s_waitcnt lgkmcnt(0)
    ds_read_b64_tr_b16 v[120:121], v14 offset:0
    ds_read_b64_tr_b16 v[122:123], v14 offset:1024
    ds_read_b64_tr_b16 v[124:125], v14 offset:32
    ds_read_b64_tr_b16 v[126:127], v14 offset:1056
    ds_read_b64_tr_b16 v[128:129], v14 offset:64
    ds_read_b64_tr_b16 v[130:131], v14 offset:1088
    ds_read_b64_tr_b16 v[132:133], v14 offset:96
    ds_read_b64_tr_b16 v[134:135], v14 offset:1120
    s_waitcnt lgkmcnt(0)
    buffer_store_dwordx4 v[120:123], v10, s[16:19], s44 offen sc1
    buffer_store_dwordx4 v[124:127], v10, s[16:19], s45 offen sc1
    buffer_store_dwordx4 v[128:131], v10, s[16:19], s46 offen sc1
    buffer_store_dwordx4 v[132:135], v10, s[16:19], s47 offen sc1
    s_nop 1
    s_waitcnt vmcnt(12)
    ds_write_b128 v11, v[40:43] offset:0
    ds_write_b128 v11, v[44:47] offset:1024
    ds_write_b128 v11, v[48:51] offset:2048
    ds_write_b128 v11, v[52:55] offset:3072
    s_waitcnt lgkmcnt(0)
    ds_read_b64_tr_b16 v[120:121], v13 offset:0
    ds_read_b64_tr_b16 v[122:123], v13 offset:2048
    ds_read_b64_tr_b16 v[124:125], v13 offset:32
    ds_read_b64_tr_b16 v[126:127], v13 offset:2080
    ds_read_b64_tr_b16 v[128:129], v13 offset:64
    ds_read_b64_tr_b16 v[130:131], v13 offset:2112
    ds_read_b64_tr_b16 v[132:133], v13 offset:96
    ds_read_b64_tr_b16 v[134:135], v13 offset:2144
    s_waitcnt lgkmcnt(0)
    buffer_store_dwordx4 v[120:123], v10, s[16:19], s48 offen sc1
    buffer_store_dwordx4 v[124:127], v10, s[16:19], s49 offen sc1
    buffer_store_dwordx4 v[128:131], v10, s[16:19], s50 offen sc1
    buffer_store_dwordx4 v[132:135], v10, s[16:19], s51 offen sc1
    s_nop 1
    s_waitcnt vmcnt(12)
    ds_write_b128 v11, v[60:63] offset:0
    ds_write_b128 v11, v[64:67] offset:1024
    ds_write_b128 v11, v[68:71] offset:2048
    ds_write_b128 v11, v[72:75] offset:3072
    s_waitcnt lgkmcnt(0)
    ds_read_b64_tr_b16 v[120:121], v13 offset:0
    ds_read_b64_tr_b16 v[122:123], v13 offset:2048
    ds_read_b64_tr_b16 v[124:125], v13 offset:32
    ds_read_b64_tr_b16 v[126:127], v13 offset:2080
    ds_read_b64_tr_b16 v[128:129], v13 offset:64
    ds_read_b64_tr_b16 v[130:131], v13 offset:2112
    ds_read_b64_tr_b16 v[132:133], v13 offset:96
    ds_read_b64_tr_b16 v[134:135], v13 offset:2144
    s_waitcnt lgkmcnt(0)
    buffer_store_dwordx4 v[120:123], v10, s[16:19], s52 offen sc1
    buffer_store_dwordx4 v[124:127], v10, s[16:19], s53 offen sc1
    buffer_store_dwordx4 v[128:131], v10, s[16:19], s54 offen sc1
    buffer_store_dwordx4 v[132:135], v10, s[16:19], s55 offen sc1
    s_nop 1
    s_waitcnt vmcnt(12)
    ds_write_b128 v11, v[80:83] offset:0
    ds_write_b128 v11, v[84:87] offset:1024
    ds_write_b128 v11, v[88:91] offset:2048
    ds_write_b128 v11, v[92:95] offset:3072
    s_waitcnt lgkmcnt(0)
    ds_read_b64_tr_b16 v[120:121], v13 offset:0
    ds_read_b64_tr_b16 v[122:123], v13 offset:2048
    ds_read_b64_tr_b16 v[124:125], v13 offset:32
    ds_read_b64_tr_b16 v[126:127], v13 offset:2080
    ds_read_b64_tr_b16 v[128:129], v13 offset:64
    ds_read_b64_tr_b16 v[130:131], v13 offset:2112
    ds_read_b64_tr_b16 v[132:133], v13 offset:96
    ds_read_b64_tr_b16 v[134:135], v13 offset:2144
    s_waitcnt lgkmcnt(0)
    buffer_store_dwordx4 v[120:123], v10, s[16:19], s56 offen sc1
    buffer_store_dwordx4 v[124:127], v10, s[16:19], s57 offen sc1
    buffer_store_dwordx4 v[128:131], v10, s[16:19], s58 offen sc1
    buffer_store_dwordx4 v[132:135], v10, s[16:19], s59 offen sc1
    s_nop 1
    s_endpgm
K3_END:
    s_endpgm
.globl k4_tail_kernel
.p2align 8
.type k4_tail_kernel,@function
k4_tail_kernel:
    s_cmp_ge_u32 s2, 256
    s_cbranch_scc1 K5_END
    s_cmp_ge_u32 s2, 16
    s_cbranch_scc1 K5_NOPF
    s_getpc_b64 s[48:49]
K5_PF:
    s_mov_b32 s50, TEXT_END-K5_PF
    s_mov_b32 s51, 0x00020000
    v_lshlrev_b32 v200, 4, v0
    buffer_load_dwordx4 v[202:205], v200, s[48:51], 0 offen
    v_add_u32 v200, 8192, v200
    buffer_load_dwordx4 v[202:205], v200, s[48:51], 0 offen
    v_add_u32 v200, 8192, v200
    buffer_load_dwordx4 v[202:205], v200, s[48:51], 0 offen
    v_add_u32 v200, 8192, v200
    buffer_load_dwordx4 v[202:205], v200, s[48:51], 0 offen
    v_add_u32 v200, 8192, v200
    buffer_load_dwordx4 v[202:205], v200, s[48:51], 0 offen
K5_NOPF:
    s_load_dwordx2 s[4:5], s[0:1], 104
    s_load_dwordx2 s[6:7], s[0:1], 88
    s_load_dwordx2 s[70:71], s[0:1], 0
    v_lshrrev_b32 v2, 6, v0
    s_nop 0
    v_readfirstlane_b32 s12, v2
    v_and_b32 v0, 63, v0
    v_lshlrev_b32 v1, 4, v0
    v_lshlrev_b32 v5, 3, v0
    s_and_b32 s16, s12, 3
    s_and_b32 s17, s2, 7
    s_lshr_b32 s18, s2, 3
    s_lshr_b32 s19, s18, 3
    s_lshl_b32 s17, s17, 2
    s_add_u32 s17, s17, s19
    s_lshl_b32 s17, s17, 2
    s_add_u32 s17, s17, s16
    s_and_b32 s26, s18, 7
    s_lshl_b32 s20, s16, 10
    s_mul_i32 s21, s26, 92160
    s_add_u32 s21, s21, s20
    s_add_u32 s21, s21, 12582912
    s_mul_i32 s22, s17, 18432
    s_add_u32 s23, s22, 9437184
    s_lshr_b32 s27, s26, 1
    s_and_b32 s28, s26, 1
    s_mul_i32 s29, s27, 9
    s_lshl_b32 s30, s28, 2
    s_add_u32 s30, s30, s29
    s_add_u32 s29, s29, 8
    s_and_b32 s44, s2, 7
    s_lshl_b32 s44, s44, 2
    s_and_b32 s45, s18, 3
    s_add_u32 s44, s44, s45
    s_mul_i32 s44, s44, 350208
    s_add_u32 s44, s44, s20
    s_add_u32 s44, s44, 20971520
    s_waitcnt lgkmcnt(0)
    s_mov_b32 s8, s4
    s_mov_b32 s9, s5
    s_mov_b32 s10, 268435456
    s_mov_b32 s11, 0x00020000
    s_cmp_ge_u32 s12, 4
    s_cbranch_scc1 K4_LOAD
    s_mov_b32 s72, s70
    s_mov_b32 s73, s71
    s_mov_b32 s74, 2359296
    s_mov_b32 s75, 0x00020000
    buffer_load_dwordx4 v[12:15], v1, s[8:11], s23 offen offset:0
    buffer_load_dwordx4 v[16:19], v1, s[8:11], s23 offen offset:1024
    buffer_load_dwordx4 v[20:23], v1, s[8:11], s23 offen offset:2048
    buffer_load_dwordx4 v[24:27], v1, s[8:11], s23 offen offset:3072
    s_add_u32 s23, s23, 4096
    buffer_load_dwordx4 v[28:31], v1, s[8:11], s23 offen offset:0
    buffer_load_dwordx4 v[32:35], v1, s[8:11], s23 offen offset:1024
    v_add_u32 v10, 71680, v1
    v_add_u32 v11, 120832, v1
    v_and_b32 v9, 15, v0
    v_lshrrev_b32 v6, 4, v0
    v_mul_u32_u24 v7, 1152, v9
    v_lshl_add_u32 v7, v6, 3, v7
    v_lshlrev_b32 v8, 4, v6
    v_add_u32 v8, 65536, v8
    s_mul_i32 s31, s17, 18432
    s_lshl_b32 s32, s30, 5
    s_add_u32 s32, s32, s31
    s_lshl_b32 s33, s29, 5
    s_add_u32 s33, s33, s31
    s_lshl_b32 s34, s30, 6
    s_add_u32 s34, s34, 4608
    s_lshl_b32 s35, s29, 6
    s_add_u32 s35, s35, 4608
    s_add_u32 s36, s34, 4608
    s_add_u32 s37, s35, 4608
    s_lshr_b32 s38, s27, 1
    s_mul_i32 s38, s38, 9
    s_lshl_b32 s38, s38, 10
    s_add_u32 s38, s38, s22
    s_and_b32 s39, s26, 3
    s_lshl_b32 s39, s39, 11
    s_add_u32 s39, s39, s38
    s_add_u32 s40, s39, 13631488
    s_add_u32 s41, s39, 16777216
    s_and_b32 s39, s27, 1
    s_lshl_b32 s39, s39, 9
    s_add_u32 s39, s39, s38
    s_add_u32 s42, s39, 13639680
    s_add_u32 s43, s39, 16785408
    s_lshl_b32 s38, s17, 10
    s_lshl_b32 s39, s26, 7
    s_add_u32 s38, s38, s39
    s_add_u32 s38, s38, 19922944
    s_cmp_eq_u32 s28, 1
    s_cbranch_scc1 K4_ODD
    s_barrier
    buffer_load_dwordx4 v[36:39], v1, s[8:11], s23 offen offset:2048
    buffer_load_dwordx4 v[40:43], v1, s[8:11], s23 offen offset:3072
    s_add_u32 s23, s23, 4096
    buffer_load_dwordx4 v[44:47], v1, s[8:11], s23 offen offset:0
    buffer_load_dwordx4 v[48:51], v1, s[8:11], s23 offen offset:1024
    buffer_load_dwordx4 v[52:55], v1, s[8:11], s23 offen offset:2048
    buffer_load_dwordx4 v[56:59], v1, s[8:11], s23 offen offset:3072
    ds_read_b128 v[104:107], v10 offset:0
    ds_read_b128 v[108:111], v10 offset:1024
    ds_read_b128 v[112:115], v10 offset:2048
    ds_read_b128 v[116:119], v10 offset:3072
    ds_read_b128 v[120:123], v10 offset:4096
    ds_read_b128 v[124:127], v10 offset:5120
    s_waitcnt vmcnt(11) lgkmcnt(5)
    v_mfma_f32_16x16x32_bf16 v[84:87], v[104:107], v[12:15], 0
    ds_read_b128 v[128:131], v10 offset:6144
    s_waitcnt lgkmcnt(5)
    v_mfma_f32_16x16x32_bf16 v[88:91], v[108:111], v[12:15], 0
    ds_read_b128 v[132:135], v10 offset:7168
    s_waitcnt lgkmcnt(5)
    v_mfma_f32_16x16x32_bf16 v[92:95], v[112:115], v[12:15], 0
    ds_read_b128 v[104:107], v10 offset:8192
    s_waitcnt lgkmcnt(5)
    v_mfma_f32_16x16x32_bf16 v[96:99], v[116:119], v[12:15], 0
    ds_read_b128 v[108:111], v10 offset:9216
    s_waitcnt lgkmcnt(5)
    v_mfma_f32_16x16x32_bf16 v[100:103], v[120:123], v[12:15], 0
    ds_read_b128 v[112:115], v10 offset:10240
    s_waitcnt vmcnt(10) lgkmcnt(5)
    v_mfma_f32_16x16x32_bf16 v[84:87], v[124:127], v[16:19], v[84:87]
    ds_read_b128 v[116:119], v10 offset:11264
    s_waitcnt lgkmcnt(5)
    v_mfma_f32_16x16x32_bf16 v[88:91], v[128:131], v[16:19], v[88:91]
    ds_read_b128 v[120:123], v10 offset:12288
    s_waitcnt lgkmcnt(5)
    v_mfma_f32_16x16x32_bf16 v[92:95], v[132:135], v[16:19], v[92:95]
    ds_read_b128 v[124:127], v10 offset:13312
    s_waitcnt lgkmcnt(5)
    v_mfma_f32_16x16x32_bf16 v[96:99], v[104:107], v[16:19], v[96:99]
    ds_read_b128 v[128:131], v10 offset:14336
    s_waitcnt lgkmcnt(5)
    v_mfma_f32_16x16x32_bf16 v[100:103], v[108:111], v[16:19], v[100:103]
    s_barrier
    s_add_u32 s23, s23, 4096
    buffer_load_dwordx4 v[60:63], v1, s[8:11], s23 offen offset:0
    buffer_load_dwordx4 v[64:67], v1, s[8:11], s23 offen offset:1024
    buffer_load_dwordx4 v[68:71], v1, s[8:11], s23 offen offset:2048
    buffer_load_dwordx4 v[72:75], v1, s[8:11], s23 offen offset:3072
    s_add_u32 s23, s23, 4096
    buffer_load_dwordx4 v[76:79], v1, s[8:11], s23 offen offset:0
    buffer_load_dwordx4 v[80:83], v1, s[8:11], s23 offen offset:1024
    ds_read_b128 v[132:135], v10 offset:15360
    s_waitcnt vmcnt(15) lgkmcnt(5)
    v_mfma_f32_16x16x32_bf16 v[84:87], v[112:115], v[20:23], v[84:87]
    ds_read_b128 v[104:107], v10 offset:16384
    s_waitcnt lgkmcnt(5)
    v_mfma_f32_16x16x32_bf16 v[88:91], v[116:119], v[20:23], v[88:91]
    ds_read_b128 v[108:111], v10 offset:17408
    s_waitcnt lgkmcnt(5)
    v_mfma_f32_16x16x32_bf16 v[92:95], v[120:123], v[20:23], v[92:95]
    ds_read_b128 v[112:115], v10 offset:18432
    s_waitcnt lgkmcnt(5)
    v_mfma_f32_16x16x32_bf16 v[96:99], v[124:127], v[20:23], v[96:99]
    ds_read_b128 v[116:119], v10 offset:19456
    s_waitcnt lgkmcnt(5)
    v_mfma_f32_16x16x32_bf16 v[100:103], v[128:131], v[20:23], v[100:103]
    ds_read_b128 v[120:123], v10 offset:20480
    s_waitcnt vmcnt(14) lgkmcnt(5)
    v_mfma_f32_16x16x32_bf16 v[84:87], v[132:135], v[24:27], v[84:87]
    ds_read_b128 v[124:127], v10 offset:21504
    s_waitcnt lgkmcnt(5)
    v_mfma_f32_16x16x32_bf16 v[88:91], v[104:107], v[24:27], v[88:91]
    ds_read_b128 v[128:131], v10 offset:22528
    s_waitcnt lgkmcnt(5)
    v_mfma_f32_16x16x32_bf16 v[92:95], v[108:111], v[24:27], v[92:95]
    ds_read_b128 v[132:135], v10 offset:23552
    s_waitcnt lgkmcnt(5)
    v_mfma_f32_16x16x32_bf16 v[96:99], v[112:115], v[24:27], v[96:99]
    ds_read_b128 v[104:107], v10 offset:24576
    s_waitcnt lgkmcnt(5)
    v_mfma_f32_16x16x32_bf16 v[100:103], v[116:119], v[24:27], v[100:103]
    ds_read_b128 v[108:111], v10 offset:25600
    s_waitcnt vmcnt(13) lgkmcnt(5)
    v_mfma_f32_16x16x32_bf16 v[84:87], v[120:123], v[28:31], v[84:87]
    ds_read_b128 v[112:115], v10 offset:26624
    s_waitcnt lgkmcnt(5)
    v_mfma_f32_16x16x32_bf16 v[88:91], v[124:127], v[28:31], v[88:91]
    ds_read_b128 v[116:119], v10 offset:27648
    s_waitcnt lgkmcnt(5)
    v_mfma_f32_16x16x32_bf16 v[92:95], v[128:131], v[28:31], v[92:95]
    ds_read_b128 v[120:123], v10 offset:28672
    s_waitcnt lgkmcnt(5)
    v_mfma_f32_16x16x32_bf16 v[96:99], v[132:135], v[28:31], v[96:99]
    ds_read_b128 v[124:127], v10 offset:29696
    s_waitcnt lgkmcnt(5)
    v_mfma_f32_16x16x32_bf16 v[100:103], v[104:107], v[28:31], v[100:103]
    s_barrier
    buffer_load_dwordx2 v[136:137], v7, s[72:75], s32 offen offset:0
    buffer_load_dwordx2 v[138:139], v7, s[72:75], s32 offen offset:32
    buffer_load_dwordx2 v[140:141], v7, s[72:75], s32 offen offset:64
    buffer_load_dwordx2 v[142:143], v7, s[72:75], s32 offen offset:96
    buffer_load_dwordx2 v[144:145], v7, s[72:75], s33 offen offset:0
    ds_read_b128 v[128:131], v10 offset:30720
    s_waitcnt vmcnt(17) lgkmcnt(5)
    v_mfma_f32_16x16x32_bf16 v[84:87], v[108:111], v[32:35], v[84:87]
    ds_read_b128 v[132:135], v10 offset:31744
    s_waitcnt lgkmcnt(5)
    v_mfma_f32_16x16x32_bf16 v[88:91], v[112:115], v[32:35], v[88:91]
    ds_read_b128 v[104:107], v10 offset:32768
    s_waitcnt lgkmcnt(5)
    v_mfma_f32_16x16x32_bf16 v[92:95], v[116:119], v[32:35], v[92:95]
    ds_read_b128 v[108:111], v10 offset:33792
    s_waitcnt lgkmcnt(5)
    v_mfma_f32_16x16x32_bf16 v[96:99], v[120:123], v[32:35], v[96:99]
    ds_read_b128 v[112:115], v10 offset:34816
    s_waitcnt lgkmcnt(5)
    v_mfma_f32_16x16x32_bf16 v[100:103], v[124:127], v[32:35], v[100:103]
    ds_read_b128 v[116:119], v10 offset:35840
    s_waitcnt vmcnt(16) lgkmcnt(5)
    v_mfma_f32_16x16x32_bf16 v[84:87], v[128:131], v[36:39], v[84:87]
    ds_read_b128 v[120:123], v10 offset:36864
    s_waitcnt lgkmcnt(5)
    v_mfma_f32_16x16x32_bf16 v[88:91], v[132:135], v[36:39], v[88:91]
    ds_read_b128 v[124:127], v10 offset:37888
    s_waitcnt lgkmcnt(5)
    v_mfma_f32_16x16x32_bf16 v[92:95], v[104:107], v[36:39], v[92:95]
    ds_read_b128 v[128:131], v10 offset:38912
    s_waitcnt lgkmcnt(5)
    v_mfma_f32_16x16x32_bf16 v[96:99], v[108:111], v[36:39], v[96:99]
    ds_read_b128 v[132:135], v10 offset:39936
    s_waitcnt lgkmcnt(5)
    v_mfma_f32_16x16x32_bf16 v[100:103], v[112:115], v[36:39], v[100:103]
    ds_read_b128 v[104:107], v10 offset:40960
    s_waitcnt vmcnt(15) lgkmcnt(5)
    v_mfma_f32_16x16x32_bf16 v[84:87], v[116:119], v[40:43], v[84:87]
    ds_read_b128 v[108:111], v10 offset:41984
    s_waitcnt lgkmcnt(5)
    v_mfma_f32_16x16x32_bf16 v[88:91], v[120:123], v[40:43], v[88:91]
    ds_read_b128 v[112:115], v10 offset:43008
    s_waitcnt lgkmcnt(5)
    v_mfma_f32_16x16x32_bf16 v[92:95], v[124:127], v[40:43], v[92:95]
    ds_read_b128 v[116:119], v10 offset:44032
    s_waitcnt lgkmcnt(5)
    v_mfma_f32_16x16x32_bf16 v[96:99], v[128:131], v[40:43], v[96:99]
    ds_read_b128 v[120:123], v10 offset:45056
    s_waitcnt lgkmcnt(5)
    v_mfma_f32_16x16x32_bf16 v[100:103], v[132:135], v[40:43], v[100:103]
    s_barrier
    ds_read_b128 v[124:127], v10 offset:46080
    s_waitcnt vmcnt(14) lgkmcnt(5)
    v_mfma_f32_16x16x32_bf16 v[84:87], v[104:107], v[44:47], v[84:87]
    ds_read_b128 v[128:131], v10 offset:47104
    s_waitcnt lgkmcnt(5)
    v_mfma_f32_16x16x32_bf16 v[88:91], v[108:111], v[44:47], v[88:91]
    ds_read_b128 v[132:135], v10 offset:48128
    s_waitcnt lgkmcnt(5)
    v_mfma_f32_16x16x32_bf16 v[92:95], v[112:115], v[44:47], v[92:95]
    ds_read_b128 v[104:107], v11 offset:0
    s_waitcnt lgkmcnt(5)
    v_mfma_f32_16x16x32_bf16 v[96:99], v[116:119], v[44:47], v[96:99]
    ds_read_b128 v[108:111], v11 offset:1024
    s_waitcnt lgkmcnt(5)
    v_mfma_f32_16x16x32_bf16 v[100:103], v[120:123], v[44:47], v[100:103]
    ds_read_b128 v[112:115], v11 offset:2048
    s_waitcnt vmcnt(13) lgkmcnt(5)
    v_mfma_f32_16x16x32_bf16 v[84:87], v[124:127], v[48:51], v[84:87]
    ds_read_b128 v[116:119], v11 offset:3072
    s_waitcnt lgkmcnt(5)
    v_mfma_f32_16x16x32_bf16 v[88:91], v[128:131], v[48:51], v[88:91]
    ds_read_b128 v[120:123], v11 offset:4096
    s_waitcnt lgkmcnt(5)
    v_mfma_f32_16x16x32_bf16 v[92:95], v[132:135], v[48:51], v[92:95]
    ds_read_b128 v[124:127], v11 offset:5120
    s_waitcnt lgkmcnt(5)
    v_mfma_f32_16x16x32_bf16 v[96:99], v[104:107], v[48:51], v[96:99]
    ds_read_b128 v[128:131], v11 offset:6144
    s_waitcnt lgkmcnt(5)
    v_mfma_f32_16x16x32_bf16 v[100:103], v[108:111], v[48:51], v[100:103]
    ds_read_b128 v[132:135], v11 offset:7168
    s_waitcnt vmcnt(12) lgkmcnt(5)
    v_mfma_f32_16x16x32_bf16 v[84:87], v[112:115], v[52:55], v[84:87]
    ds_read_b128 v[104:107], v11 offset:8192
    s_waitcnt lgkmcnt(5)
    v_mfma_f32_16x16x32_bf16 v[88:91], v[116:119], v[52:55], v[88:91]
    ds_read_b128 v[108:111], v11 offset:9216
    s_waitcnt lgkmcnt(5)
    v_mfma_f32_16x16x32_bf16 v[92:95], v[120:123], v[52:55], v[92:95]
    ds_read_b128 v[112:115], v11 offset:10240
    s_waitcnt lgkmcnt(5)
    v_mfma_f32_16x16x32_bf16 v[96:99], v[124:127], v[52:55], v[96:99]
    ds_read_b128 v[116:119], v11 offset:11264
    s_waitcnt lgkmcnt(5)
    v_mfma_f32_16x16x32_bf16 v[100:103], v[128:131], v[52:55], v[100:103]
    s_barrier
    ds_read_b128 v[120:123], v11 offset:12288
    s_waitcnt vmcnt(11) lgkmcnt(5)
    v_mfma_f32_16x16x32_bf16 v[84:87], v[132:135], v[56:59], v[84:87]
    ds_read_b128 v[124:127], v11 offset:13312
    s_waitcnt lgkmcnt(5)
    v_mfma_f32_16x16x32_bf16 v[88:91], v[104:107], v[56:59], v[88:91]
    ds_read_b128 v[128:131], v11 offset:14336
    s_waitcnt lgkmcnt(5)
    v_mfma_f32_16x16x32_bf16 v[92:95], v[108:111], v[56:59], v[92:95]
    ds_read_b128 v[132:135], v11 offset:15360
    s_waitcnt lgkmcnt(5)
    v_mfma_f32_16x16x32_bf16 v[96:99], v[112:115], v[56:59], v[96:99]
    ds_read_b128 v[104:107], v11 offset:16384
    s_waitcnt lgkmcnt(5)
    v_mfma_f32_16x16x32_bf16 v[100:103], v[116:119], v[56:59], v[100:103]
    ds_read_b128 v[108:111], v11 offset:17408
    s_waitcnt vmcnt(10) lgkmcnt(5)
    v_mfma_f32_16x16x32_bf16 v[84:87], v[120:123], v[60:63], v[84:87]
    ds_read_b128 v[112:115], v11 offset:18432
    s_waitcnt lgkmcnt(5)
    v_mfma_f32_16x16x32_bf16 v[88:91], v[124:127], v[60:63], v[88:91]
    ds_read_b128 v[116:119], v11 offset:19456
    s_waitcnt lgkmcnt(5)
    v_mfma_f32_16x16x32_bf16 v[92:95], v[128:131], v[60:63], v[92:95]
    ds_read_b128 v[120:123], v11 offset:20480
    s_waitcnt lgkmcnt(5)
    v_mfma_f32_16x16x32_bf16 v[96:99], v[132:135], v[60:63], v[96:99]
    ds_read_b128 v[124:127], v11 offset:21504
    s_waitcnt lgkmcnt(5)
    v_mfma_f32_16x16x32_bf16 v[100:103], v[104:107], v[60:63], v[100:103]
    ds_read_b128 v[128:131], v11 offset:22528
    s_waitcnt vmcnt(9) lgkmcnt(5)
    v_mfma_f32_16x16x32_bf16 v[84:87], v[108:111], v[64:67], v[84:87]
    ds_read_b128 v[132:135], v11 offset:23552
    s_waitcnt lgkmcnt(5)
    v_mfma_f32_16x16x32_bf16 v[88:91], v[112:115], v[64:67], v[88:91]
    ds_read_b128 v[104:107], v11 offset:24576
    s_waitcnt lgkmcnt(5)
    v_mfma_f32_16x16x32_bf16 v[92:95], v[116:119], v[64:67], v[92:95]
    ds_read_b128 v[108:111], v11 offset:25600
    s_waitcnt lgkmcnt(5)
    v_mfma_f32_16x16x32_bf16 v[96:99], v[120:123], v[64:67], v[96:99]
    ds_read_b128 v[112:115], v11 offset:26624
    s_waitcnt lgkmcnt(5)
    v_mfma_f32_16x16x32_bf16 v[100:103], v[124:127], v[64:67], v[100:103]
    s_barrier
    ds_read_b128 v[116:119], v11 offset:27648
    s_waitcnt vmcnt(8) lgkmcnt(5)
    v_mfma_f32_16x16x32_bf16 v[84:87], v[128:131], v[68:71], v[84:87]
    ds_read_b128 v[120:123], v11 offset:28672
    s_waitcnt lgkmcnt(5)
    v_mfma_f32_16x16x32_bf16 v[88:91], v[132:135], v[68:71], v[88:91]
    ds_read_b128 v[124:127], v11 offset:29696
    s_waitcnt lgkmcnt(5)
    v_mfma_f32_16x16x32_bf16 v[92:95], v[104:107], v[68:71], v[92:95]
    ds_read_b128 v[128:131], v11 offset:30720
    s_waitcnt lgkmcnt(5)
    v_mfma_f32_16x16x32_bf16 v[96:99], v[108:111], v[68:71], v[96:99]
    ds_read_b128 v[132:135], v11 offset:31744
    s_waitcnt lgkmcnt(5)
    v_mfma_f32_16x16x32_bf16 v[100:103], v[112:115], v[68:71], v[100:103]
    ds_read_b128 v[104:107], v11 offset:32768
    s_waitcnt vmcnt(7) lgkmcnt(5)
    v_mfma_f32_16x16x32_bf16 v[84:87], v[116:119], v[72:75], v[84:87]
    ds_read_b128 v[108:111], v11 offset:33792
    s_waitcnt lgkmcnt(5)
    v_mfma_f32_16x16x32_bf16 v[88:91], v[120:123], v[72:75], v[88:91]
    ds_read_b128 v[112:115], v11 offset:34816
    s_waitcnt lgkmcnt(5)
    v_mfma_f32_16x16x32_bf16 v[92:95], v[124:127], v[72:75], v[92:95]
    ds_read_b128 v[116:119], v11 offset:35840
    s_waitcnt lgkmcnt(5)
    v_mfma_f32_16x16x32_bf16 v[96:99], v[128:131], v[72:75], v[96:99]
    ds_read_b128 v[120:123], v11 offset:36864
    s_waitcnt lgkmcnt(5)
    v_mfma_f32_16x16x32_bf16 v[100:103], v[132:135], v[72:75], v[100:103]
    ds_read_b128 v[124:127], v11 offset:37888
    s_waitcnt vmcnt(6) lgkmcnt(5)
    v_mfma_f32_16x16x32_bf16 v[84:87], v[104:107], v[76:79], v[84:87]
    ds_read_b128 v[128:131], v11 offset:38912
    s_waitcnt lgkmcnt(5)
    v_mfma_f32_16x16x32_bf16 v[88:91], v[108:111], v[76:79], v[88:91]
    ds_read_b128 v[132:135], v11 offset:39936
    s_waitcnt lgkmcnt(5)
    v_mfma_f32_16x16x32_bf16 v[92:95], v[112:115], v[76:79], v[92:95]
    ds_read_b128 v[104:107], v11 offset:40960
    s_waitcnt lgkmcnt(5)
    v_mfma_f32_16x16x32_bf16 v[96:99], v[116:119], v[76:79], v[96:99]
    ds_read_b128 v[108:111], v11 offset:41984
    s_waitcnt lgkmcnt(5)
    v_mfma_f32_16x16x32_bf16 v[100:103], v[120:123], v[76:79], v[100:103]
    s_waitcnt vmcnt(5) lgkmcnt(4)
    v_mfma_f32_16x16x32_bf16 v[84:87], v[124:127], v[80:83], v[84:87]
    s_waitcnt lgkmcnt(3)
    v_mfma_f32_16x16x32_bf16 v[88:91], v[128:131], v[80:83], v[88:91]
    s_waitcnt lgkmcnt(2)
    v_mfma_f32_16x16x32_bf16 v[92:95], v[132:135], v[80:83], v[92:95]
    s_waitcnt lgkmcnt(1)
    v_mfma_f32_16x16x32_bf16 v[96:99], v[104:107], v[80:83], v[96:99]
    s_waitcnt lgkmcnt(0)
    v_mfma_f32_16x16x32_bf16 v[100:103], v[108:111], v[80:83], v[100:103]
    ds_read_b128 v[148:151], v8 offset:0
    ds_read_b128 v[168:171], v8 offset:1024
    ds_read_b128 v[152:155], v8 offset:64
    ds_read_b128 v[172:175], v8 offset:1088
    ds_read_b128 v[156:159], v8 offset:128
    ds_read_b128 v[176:179], v8 offset:1152
    ds_read_b128 v[160:163], v8 offset:192
    ds_read_b128 v[180:183], v8 offset:1216
    ds_read_b128 v[164:167], v8 offset:512
    ds_read_b128 v[184:187], v8 offset:1536
    s_waitcnt vmcnt(0) lgkmcnt(0)
    v_lshlrev_b32 v188, 16, v136
    v_and_b32 v189, 0xffff0000, v136
    v_lshlrev_b32 v190, 16, v137
    v_and_b32 v191, 0xffff0000, v137
    v_pk_fma_f32 v[84:85], v[84:85], v[148:149], v[188:189]
    v_pk_fma_f32 v[86:87], v[86:87], v[150:151], v[190:191]
    v_cvt_pk_bf16_f32 v192, v84, v85
    v_cvt_pk_bf16_f32 v193, v86, v87
    v_lshlrev_b32 v84, 16, v192
    v_and_b32 v85, 0xffff0000, v192
    v_lshlrev_b32 v86, 16, v193
    v_and_b32 v87, 0xffff0000, v193
    v_pk_mul_f32 v[188:189], v[84:85], v[168:169]
    v_pk_mul_f32 v[190:191], v[86:87], v[170:171]
    v_cvt_pk_bf16_f32 v204, v188, v189
    v_cvt_pk_bf16_f32 v205, v190, v191
    v_lshlrev_b32 v188, 16, v138
    v_and_b32 v189, 0xffff0000, v138
    v_lshlrev_b32 v190, 16, v139
    v_and_b32 v191, 0xffff0000, v139
    v_pk_fma_f32 v[88:89], v[88:89], v[152:153], v[188:189]
    v_pk_fma_f32 v[90:91], v[90:91], v[154:155], v[190:191]
    v_cvt_pk_bf16_f32 v194, v88, v89
    v_cvt_pk_bf16_f32 v195, v90, v91
    v_lshlrev_b32 v88, 16, v194
    v_and_b32 v89, 0xffff0000, v194
    v_lshlrev_b32 v90, 16, v195
    v_and_b32 v91, 0xffff0000, v195
    v_pk_mul_f32 v[188:189], v[88:89], v[172:173]
    v_pk_mul_f32 v[190:191], v[90:91], v[174:175]
    v_cvt_pk_bf16_f32 v206, v188, v189
    v_cvt_pk_bf16_f32 v207, v190, v191
    buffer_store_dwordx4 v[204:207], v1, s[8:11], s41 offen offset:0 sc1
    buffer_store_dwordx4 v[192:195], v1, s[8:11], s40 offen offset:0 sc1
    v_lshlrev_b32 v188, 16, v140
    v_and_b32 v189, 0xffff0000, v140
    v_lshlrev_b32 v190, 16, v141
    v_and_b32 v191, 0xffff0000, v141
    v_pk_fma_f32 v[92:93], v[92:93], v[156:157], v[188:189]
    v_pk_fma_f32 v[94:95], v[94:95], v[158:159], v[190:191]
    v_cvt_pk_bf16_f32 v196, v92, v93
    v_cvt_pk_bf16_f32 v197, v94, v95
    v_lshlrev_b32 v92, 16, v196
    v_and_b32 v93, 0xffff0000, v196
    v_lshlrev_b32 v94, 16, v197
    v_and_b32 v95, 0xffff0000, v197
    v_pk_mul_f32 v[188:189], v[92:93], v[176:177]
    v_pk_mul_f32 v[190:191], v[94:95], v[178:179]
    v_cvt_pk_bf16_f32 v208, v188, v189
    v_cvt_pk_bf16_f32 v209, v190, v191
    v_lshlrev_b32 v188, 16, v142
    v_and_b32 v189, 0xffff0000, v142
    v_lshlrev_b32 v190, 16, v143
    v_and_b32 v191, 0xffff0000, v143
    v_pk_fma_f32 v[96:97], v[96:97], v[160:161], v[188:189]
    v_pk_fma_f32 v[98:99], v[98:99], v[162:163], v[190:191]
    v_cvt_pk_bf16_f32 v198, v96, v97
    v_cvt_pk_bf16_f32 v199, v98, v99
    v_lshlrev_b32 v96, 16, v198
    v_and_b32 v97, 0xffff0000, v198
    v_lshlrev_b32 v98, 16, v199
    v_and_b32 v99, 0xffff0000, v199
    v_pk_mul_f32 v[188:189], v[96:97], v[180:181]
    v_pk_mul_f32 v[190:191], v[98:99], v[182:183]
    v_cvt_pk_bf16_f32 v210, v188, v189
    v_cvt_pk_bf16_f32 v211, v190, v191
    buffer_store_dwordx4 v[208:211], v1, s[8:11], s41 offen offset:1024 sc1
    buffer_store_dwordx4 v[196:199], v1, s[8:11], s40 offen offset:1024 sc1
    v_lshlrev_b32 v188, 16, v144
    v_and_b32 v189, 0xffff0000, v144
    v_lshlrev_b32 v190, 16, v145
    v_and_b32 v191, 0xffff0000, v145
    v_pk_fma_f32 v[100:101], v[100:101], v[164:165], v[188:189]
    v_pk_fma_f32 v[102:103], v[102:103], v[166:167], v[190:191]
    v_cvt_pk_bf16_f32 v200, v100, v101
    v_cvt_pk_bf16_f32 v201, v102, v103
    v_lshlrev_b32 v100, 16, v200
    v_and_b32 v101, 0xffff0000, v200
    v_lshlrev_b32 v102, 16, v201
    v_and_b32 v103, 0xffff0000, v201
    v_pk_mul_f32 v[188:189], v[100:101], v[184:185]
    v_pk_mul_f32 v[190:191], v[102:103], v[186:187]
    v_cvt_pk_bf16_f32 v212, v188, v189
    v_cvt_pk_bf16_f32 v213, v190, v191
    buffer_store_dwordx2 v[212:213], v5, s[8:11], s43 offen sc1
    buffer_store_dwordx2 v[200:201], v5, s[8:11], s42 offen sc1
    v_pk_add_f32 v[148:149], v[84:85], v[86:87]
    v_pk_mul_f32 v[150:151], v[84:85], v[84:85]
    v_pk_fma_f32 v[150:151], v[86:87], v[86:87], v[150:151]
    v_pk_add_f32 v[148:149], v[148:149], v[88:89]
    v_pk_fma_f32 v[150:151], v[88:89], v[88:89], v[150:151]
    v_pk_add_f32 v[148:149], v[148:149], v[90:91]
    v_pk_fma_f32 v[150:151], v[90:91], v[90:91], v[150:151]
    v_pk_add_f32 v[148:149], v[148:149], v[92:93]
    v_pk_fma_f32 v[150:151], v[92:93], v[92:93], v[150:151]
    v_pk_add_f32 v[148:149], v[148:149], v[94:95]
    v_pk_fma_f32 v[150:151], v[94:95], v[94:95], v[150:151]
    v_pk_add_f32 v[148:149], v[148:149], v[96:97]
    v_pk_fma_f32 v[150:151], v[96:97], v[96:97], v[150:151]
    v_pk_add_f32 v[148:149], v[148:149], v[98:99]
    v_pk_fma_f32 v[150:151], v[98:99], v[98:99], v[150:151]
    v_pk_add_f32 v[148:149], v[148:149], v[100:101]
    v_pk_fma_f32 v[150:151], v[100:101], v[100:101], v[150:151]
    v_pk_add_f32 v[148:149], v[148:149], v[102:103]
    v_pk_fma_f32 v[150:151], v[102:103], v[102:103], v[150:151]
    v_add_f32 v216, v148, v149
    v_add_f32 v217, v150, v151
    v_mov_b32 v188, v216
    v_mov_b32 v189, v217
    s_nop 0
    v_permlane32_swap_b32 v216, v188
    v_permlane32_swap_b32 v217, v189
    v_add_f32 v216, v216, v188
    v_add_f32 v217, v217, v189
    v_mov_b32 v188, v216
    v_mov_b32 v189, v217
    s_nop 0
    v_permlane16_swap_b32 v216, v188
    v_permlane16_swap_b32 v217, v189
    v_add_f32 v216, v216, v188
    v_add_f32 v217, v217, v189
    s_mov_b64 exec, 0xffff
    buffer_store_dwordx2 v[216:217], v5, s[8:11], s38 offen sc1
    s_mov_b64 exec, -1
    s_branch K4_JOIN
K4_ODD:
    s_barrier
    buffer_load_dwordx4 v[36:39], v1, s[8:11], s23 offen offset:2048
    buffer_load_dwordx4 v[40:43], v1, s[8:11], s23 offen offset:3072
    s_add_u32 s23, s23, 4096
    buffer_load_dwordx4 v[44:47], v1, s[8:11], s23 offen offset:0
    buffer_load_dwordx4 v[48:51], v1, s[8:11], s23 offen offset:1024
    buffer_load_dwordx4 v[52:55], v1, s[8:11], s23 offen offset:2048
    buffer_load_dwordx4 v[56:59], v1, s[8:11], s23 offen offset:3072
    ds_read_b128 v[104:107], v10 offset:0
    ds_read_b128 v[108:111], v10 offset:1024
    ds_read_b128 v[112:115], v10 offset:2048
    ds_read_b128 v[116:119], v10 offset:3072
    ds_read_b128 v[120:123], v10 offset:4096
    ds_read_b128 v[124:127], v10 offset:5120
    s_waitcnt vmcnt(11) lgkmcnt(5)
    v_mfma_f32_16x16x32_bf16 v[84:87], v[104:107], v[12:15], 0
    ds_read_b128 v[128:131], v10 offset:6144
    s_waitcnt lgkmcnt(5)
    v_mfma_f32_16x16x32_bf16 v[88:91], v[108:111], v[12:15], 0
    ds_read_b128 v[132:135], v10 offset:7168
    s_waitcnt lgkmcnt(5)
    v_mfma_f32_16x16x32_bf16 v[92:95], v[112:115], v[12:15], 0
    ds_read_b128 v[104:107], v10 offset:8192
    s_waitcnt lgkmcnt(5)
    v_mfma_f32_16x16x32_bf16 v[96:99], v[116:119], v[12:15], 0
    ds_read_b128 v[108:111], v10 offset:9216
    s_waitcnt vmcnt(10) lgkmcnt(5)
    v_mfma_f32_16x16x32_bf16 v[84:87], v[120:123], v[16:19], v[84:87]
    ds_read_b128 v[112:115], v10 offset:10240
    s_waitcnt lgkmcnt(5)
    v_mfma_f32_16x16x32_bf16 v[88:91], v[124:127], v[16:19], v[88:91]
    ds_read_b128 v[116:119], v10 offset:11264
    s_waitcnt lgkmcnt(5)
    v_mfma_f32_16x16x32_bf16 v[92:95], v[128:131], v[16:19], v[92:95]
    s_barrier
    s_add_u32 s23, s23, 4096
    buffer_load_dwordx4 v[60:63], v1, s[8:11], s23 offen offset:0
    buffer_load_dwordx4 v[64:67], v1, s[8:11], s23 offen offset:1024
    buffer_load_dwordx4 v[68:71], v1, s[8:11], s23 offen offset:2048
    buffer_load_dwordx4 v[72:75], v1, s[8:11], s23 offen offset:3072
    s_add_u32 s23, s23, 4096
    buffer_load_dwordx4 v[76:79], v1, s[8:11], s23 offen offset:0
    buffer_load_dwordx4 v[80:83], v1, s[8:11], s23 offen offset:1024
    ds_read_b128 v[120:123], v10 offset:12288
    s_waitcnt lgkmcnt(5)
    v_mfma_f32_16x16x32_bf16 v[96:99], v[132:135], v[16:19], v[96:99]
    ds_read_b128 v[124:127], v10 offset:13312
    s_waitcnt vmcnt(15) lgkmcnt(5)
    v_mfma_f32_16x16x32_bf16 v[84:87], v[104:107], v[20:23], v[84:87]
    ds_read_b128 v[128:131], v10 offset:14336
    s_waitcnt lgkmcnt(5)
    v_mfma_f32_16x16x32_bf16 v[88:91], v[108:111], v[20:23], v[88:91]
    ds_read_b128 v[132:135], v10 offset:15360
    s_waitcnt lgkmcnt(5)
    v_mfma_f32_16x16x32_bf16 v[92:95], v[112:115], v[20:23], v[92:95]
    ds_read_b128 v[104:107], v10 offset:16384
    s_waitcnt lgkmcnt(5)
    v_mfma_f32_16x16x32_bf16 v[96:99], v[116:119], v[20:23], v[96:99]
    ds_read_b128 v[108:111], v10 offset:17408
    s_waitcnt vmcnt(14) lgkmcnt(5)
    v_mfma_f32_16x16x32_bf16 v[84:87], v[120:123], v[24:27], v[84:87]
    ds_read_b128 v[112:115], v10 offset:18432
    s_waitcnt lgkmcnt(5)
    v_mfma_f32_16x16x32_bf16 v[88:91], v[124:127], v[24:27], v[88:91]
    ds_read_b128 v[116:119], v10 offset:19456
    s_waitcnt lgkmcnt(5)
    v_mfma_f32_16x16x32_bf16 v[92:95], v[128:131], v[24:27], v[92:95]
    ds_read_b128 v[120:123], v10 offset:20480
    s_waitcnt lgkmcnt(5)
    v_mfma_f32_16x16x32_bf16 v[96:99], v[132:135], v[24:27], v[96:99]
    ds_read_b128 v[124:127], v10 offset:21504
    s_waitcnt vmcnt(13) lgkmcnt(5)
    v_mfma_f32_16x16x32_bf16 v[84:87], v[104:107], v[28:31], v[84:87]
    ds_read_b128 v[128:131], v10 offset:22528
    s_waitcnt lgkmcnt(5)
    v_mfma_f32_16x16x32_bf16 v[88:91], v[108:111], v[28:31], v[88:91]
    ds_read_b128 v[132:135], v10 offset:23552
    s_waitcnt lgkmcnt(5)
    v_mfma_f32_16x16x32_bf16 v[92:95], v[112:115], v[28:31], v[92:95]
    s_barrier
    buffer_load_dwordx2 v[136:137], v7, s[72:75], s32 offen offset:0
    buffer_load_dwordx2 v[138:139], v7, s[72:75], s32 offen offset:32
    buffer_load_dwordx2 v[140:141], v7, s[72:75], s32 offen offset:64
    buffer_load_dwordx2 v[142:143], v7, s[72:75], s32 offen offset:96
    ds_read_b128 v[104:107], v10 offset:24576
    s_waitcnt lgkmcnt(5)
    v_mfma_f32_16x16x32_bf16 v[96:99], v[116:119], v[28:31], v[96:99]
    ds_read_b128 v[108:111], v10 offset:25600
    s_waitcnt vmcnt(16) lgkmcnt(5)
    v_mfma_f32_16x16x32_bf16 v[84:87], v[120:123], v[32:35], v[84:87]
    ds_read_b128 v[112:115], v10 offset:26624
    s_waitcnt lgkmcnt(5)
    v_mfma_f32_16x16x32_bf16 v[88:91], v[124:127], v[32:35], v[88:91]
    ds_read_b128 v[116:119], v10 offset:27648
    s_waitcnt lgkmcnt(5)
    v_mfma_f32_16x16x32_bf16 v[92:95], v[128:131], v[32:35], v[92:95]
    ds_read_b128 v[120:123], v10 offset:28672
    s_waitcnt lgkmcnt(5)
    v_mfma_f32_16x16x32_bf16 v[96:99], v[132:135], v[32:35], v[96:99]
    ds_read_b128 v[124:127], v10 offset:29696
    s_waitcnt vmcnt(15) lgkmcnt(5)
    v_mfma_f32_16x16x32_bf16 v[84:87], v[104:107], v[36:39], v[84:87]
    ds_read_b128 v[128:131], v10 offset:30720
    s_waitcnt lgkmcnt(5)
    v_mfma_f32_16x16x32_bf16 v[88:91], v[108:111], v[36:39], v[88:91]
    ds_read_b128 v[132:135], v10 offset:31744
    s_waitcnt lgkmcnt(5)
    v_mfma_f32_16x16x32_bf16 v[92:95], v[112:115], v[36:39], v[92:95]
    ds_read_b128 v[104:107], v10 offset:32768
    s_waitcnt lgkmcnt(5)
    v_mfma_f32_16x16x32_bf16 v[96:99], v[116:119], v[36:39], v[96:99]
    ds_read_b128 v[108:111], v10 offset:33792
    s_waitcnt vmcnt(14) lgkmcnt(5)
    v_mfma_f32_16x16x32_bf16 v[84:87], v[120:123], v[40:43], v[84:87]
    ds_read_b128 v[112:115], v10 offset:34816
    s_waitcnt lgkmcnt(5)
    v_mfma_f32_16x16x32_bf16 v[88:91], v[124:127], v[40:43], v[88:91]
    ds_read_b128 v[116:119], v10 offset:35840
    s_waitcnt lgkmcnt(5)
    v_mfma_f32_16x16x32_bf16 v[92:95], v[128:131], v[40:43], v[92:95]
    s_barrier
    ds_read_b128 v[120:123], v10 offset:36864
    s_waitcnt lgkmcnt(5)
    v_mfma_f32_16x16x32_bf16 v[96:99], v[132:135], v[40:43], v[96:99]
    ds_read_b128 v[124:127], v10 offset:37888
    s_waitcnt vmcnt(13) lgkmcnt(5)
    v_mfma_f32_16x16x32_bf16 v[84:87], v[104:107], v[44:47], v[84:87]
    ds_read_b128 v[128:131], v10 offset:38912
    s_waitcnt lgkmcnt(5)
    v_mfma_f32_16x16x32_bf16 v[88:91], v[108:111], v[44:47], v[88:91]
    ds_read_b128 v[132:135], v10 offset:39936
    s_waitcnt lgkmcnt(5)
    v_mfma_f32_16x16x32_bf16 v[92:95], v[112:115], v[44:47], v[92:95]
    ds_read_b128 v[104:107], v10 offset:40960
    s_waitcnt lgkmcnt(5)
    v_mfma_f32_16x16x32_bf16 v[96:99], v[116:119], v[44:47], v[96:99]
    ds_read_b128 v[108:111], v10 offset:41984
    s_waitcnt vmcnt(12) lgkmcnt(5)
    v_mfma_f32_16x16x32_bf16 v[84:87], v[120:123], v[48:51], v[84:87]
    ds_read_b128 v[112:115], v10 offset:43008
    s_waitcnt lgkmcnt(5)
    v_mfma_f32_16x16x32_bf16 v[88:91], v[124:127], v[48:51], v[88:91]
    ds_read_b128 v[116:119], v10 offset:44032
    s_waitcnt lgkmcnt(5)
    v_mfma_f32_16x16x32_bf16 v[92:95], v[128:131], v[48:51], v[92:95]
    ds_read_b128 v[120:123], v10 offset:45056
    s_waitcnt lgkmcnt(5)
    v_mfma_f32_16x16x32_bf16 v[96:99], v[132:135], v[48:51], v[96:99]
    ds_read_b128 v[124:127], v10 offset:46080
    s_waitcnt vmcnt(11) lgkmcnt(5)
    v_mfma_f32_16x16x32_bf16 v[84:87], v[104:107], v[52:55], v[84:87]
    ds_read_b128 v[128:131], v10 offset:47104
    s_waitcnt lgkmcnt(5)
    v_mfma_f32_16x16x32_bf16 v[88:91], v[108:111], v[52:55], v[88:91]
    ds_read_b128 v[132:135], v10 offset:48128
    s_waitcnt lgkmcnt(5)
    v_mfma_f32_16x16x32_bf16 v[92:95], v[112:115], v[52:55], v[92:95]
    s_barrier
    ds_read_b128 v[104:107], v11 offset:0
    s_waitcnt lgkmcnt(5)
    v_mfma_f32_16x16x32_bf16 v[96:99], v[116:119], v[52:55], v[96:99]
    ds_read_b128 v[108:111], v11 offset:1024
    s_waitcnt vmcnt(10) lgkmcnt(5)
    v_mfma_f32_16x16x32_bf16 v[84:87], v[120:123], v[56:59], v[84:87]
    ds_read_b128 v[112:115], v11 offset:2048
    s_waitcnt lgkmcnt(5)
    v_mfma_f32_16x16x32_bf16 v[88:91], v[124:127], v[56:59], v[88:91]
    ds_read_b128 v[116:119], v11 offset:3072
    s_waitcnt lgkmcnt(5)
    v_mfma_f32_16x16x32_bf16 v[92:95], v[128:131], v[56:59], v[92:95]
    ds_read_b128 v[120:123], v11 offset:4096
    s_waitcnt lgkmcnt(5)
    v_mfma_f32_16x16x32_bf16 v[96:99], v[132:135], v[56:59], v[96:99]
    ds_read_b128 v[124:127], v11 offset:5120
    s_waitcnt vmcnt(9) lgkmcnt(5)
    v_mfma_f32_16x16x32_bf16 v[84:87], v[104:107], v[60:63], v[84:87]
    ds_read_b128 v[128:131], v11 offset:6144
    s_waitcnt lgkmcnt(5)
    v_mfma_f32_16x16x32_bf16 v[88:91], v[108:111], v[60:63], v[88:91]
    ds_read_b128 v[132:135], v11 offset:7168
    s_waitcnt lgkmcnt(5)
    v_mfma_f32_16x16x32_bf16 v[92:95], v[112:115], v[60:63], v[92:95]
    ds_read_b128 v[104:107], v11 offset:8192
    s_waitcnt lgkmcnt(5)
    v_mfma_f32_16x16x32_bf16 v[96:99], v[116:119], v[60:63], v[96:99]
    ds_read_b128 v[108:111], v11 offset:9216
    s_waitcnt vmcnt(8) lgkmcnt(5)
    v_mfma_f32_16x16x32_bf16 v[84:87], v[120:123], v[64:67], v[84:87]
    ds_read_b128 v[112:115], v11 offset:10240
    s_waitcnt lgkmcnt(5)
    v_mfma_f32_16x16x32_bf16 v[88:91], v[124:127], v[64:67], v[88:91]
    ds_read_b128 v[116:119], v11 offset:11264
    s_waitcnt lgkmcnt(5)
    v_mfma_f32_16x16x32_bf16 v[92:95], v[128:131], v[64:67], v[92:95]
    s_barrier
    ds_read_b128 v[120:123], v11 offset:12288
    s_waitcnt lgkmcnt(5)
    v_mfma_f32_16x16x32_bf16 v[96:99], v[132:135], v[64:67], v[96:99]
    ds_read_b128 v[124:127], v11 offset:13312
    s_waitcnt vmcnt(7) lgkmcnt(5)
    v_mfma_f32_16x16x32_bf16 v[84:87], v[104:107], v[68:71], v[84:87]
    ds_read_b128 v[128:131], v11 offset:14336
    s_waitcnt lgkmcnt(5)
    v_mfma_f32_16x16x32_bf16 v[88:91], v[108:111], v[68:71], v[88:91]
    ds_read_b128 v[132:135], v11 offset:15360
    s_waitcnt lgkmcnt(5)
    v_mfma_f32_16x16x32_bf16 v[92:95], v[112:115], v[68:71], v[92:95]
    ds_read_b128 v[104:107], v11 offset:16384
    s_waitcnt lgkmcnt(5)
    v_mfma_f32_16x16x32_bf16 v[96:99], v[116:119], v[68:71], v[96:99]
    ds_read_b128 v[108:111], v11 offset:17408
    s_waitcnt vmcnt(6) lgkmcnt(5)
    v_mfma_f32_16x16x32_bf16 v[84:87], v[120:123], v[72:75], v[84:87]
    ds_read_b128 v[112:115], v11 offset:18432
    s_waitcnt lgkmcnt(5)
    v_mfma_f32_16x16x32_bf16 v[88:91], v[124:127], v[72:75], v[88:91]
    ds_read_b128 v[116:119], v11 offset:19456
    s_waitcnt lgkmcnt(5)
    v_mfma_f32_16x16x32_bf16 v[92:95], v[128:131], v[72:75], v[92:95]
    ds_read_b128 v[120:123], v11 offset:20480
    s_waitcnt lgkmcnt(5)
    v_mfma_f32_16x16x32_bf16 v[96:99], v[132:135], v[72:75], v[96:99]
    ds_read_b128 v[124:127], v11 offset:21504
    s_waitcnt vmcnt(5) lgkmcnt(5)
    v_mfma_f32_16x16x32_bf16 v[84:87], v[104:107], v[76:79], v[84:87]
    ds_read_b128 v[128:131], v11 offset:22528
    s_waitcnt lgkmcnt(5)
    v_mfma_f32_16x16x32_bf16 v[88:91], v[108:111], v[76:79], v[88:91]
    ds_read_b128 v[132:135], v11 offset:23552
    s_waitcnt lgkmcnt(5)
    v_mfma_f32_16x16x32_bf16 v[92:95], v[112:115], v[76:79], v[92:95]
    s_waitcnt lgkmcnt(4)
    v_mfma_f32_16x16x32_bf16 v[96:99], v[116:119], v[76:79], v[96:99]
    s_waitcnt vmcnt(4) lgkmcnt(3)
    v_mfma_f32_16x16x32_bf16 v[84:87], v[120:123], v[80:83], v[84:87]
    s_waitcnt lgkmcnt(2)
    v_mfma_f32_16x16x32_bf16 v[88:91], v[124:127], v[80:83], v[88:91]
    s_waitcnt lgkmcnt(1)
    v_mfma_f32_16x16x32_bf16 v[92:95], v[128:131], v[80:83], v[92:95]
    s_waitcnt lgkmcnt(0)
    v_mfma_f32_16x16x32_bf16 v[96:99], v[132:135], v[80:83], v[96:99]
    ds_read_b128 v[148:151], v8 offset:256
    ds_read_b128 v[168:171], v8 offset:1280
    ds_read_b128 v[152:155], v8 offset:320
    ds_read_b128 v[172:175], v8 offset:1344
    ds_read_b128 v[156:159], v8 offset:384
    ds_read_b128 v[176:179], v8 offset:1408
    ds_read_b128 v[160:163], v8 offset:448
    ds_read_b128 v[180:183], v8 offset:1472
    s_waitcnt vmcnt(0) lgkmcnt(0)
    v_lshlrev_b32 v188, 16, v136
    v_and_b32 v189, 0xffff0000, v136
    v_lshlrev_b32 v190, 16, v137
    v_and_b32 v191, 0xffff0000, v137
    v_pk_fma_f32 v[84:85], v[84:85], v[148:149], v[188:189]
    v_pk_fma_f32 v[86:87], v[86:87], v[150:151], v[190:191]
    v_cvt_pk_bf16_f32 v192, v84, v85
    v_cvt_pk_bf16_f32 v193, v86, v87
    v_lshlrev_b32 v84, 16, v192
    v_and_b32 v85, 0xffff0000, v192
    v_lshlrev_b32 v86, 16, v193
    v_and_b32 v87, 0xffff0000, v193
    v_pk_mul_f32 v[188:189], v[84:85], v[168:169]
    v_pk_mul_f32 v[190:191], v[86:87], v[170:171]
    v_cvt_pk_bf16_f32 v204, v188, v189
    v_cvt_pk_bf16_f32 v205, v190, v191
    v_lshlrev_b32 v188, 16, v138
    v_and_b32 v189, 0xffff0000, v138
    v_lshlrev_b32 v190, 16, v139
    v_and_b32 v191, 0xffff0000, v139
    v_pk_fma_f32 v[88:89], v[88:89], v[152:153], v[188:189]
    v_pk_fma_f32 v[90:91], v[90:91], v[154:155], v[190:191]
    v_cvt_pk_bf16_f32 v194, v88, v89
    v_cvt_pk_bf16_f32 v195, v90, v91
    v_lshlrev_b32 v88, 16, v194
    v_and_b32 v89, 0xffff0000, v194
    v_lshlrev_b32 v90, 16, v195
    v_and_b32 v91, 0xffff0000, v195
    v_pk_mul_f32 v[188:189], v[88:89], v[172:173]
    v_pk_mul_f32 v[190:191], v[90:91], v[174:175]
    v_cvt_pk_bf16_f32 v206, v188, v189
    v_cvt_pk_bf16_f32 v207, v190, v191
    buffer_store_dwordx4 v[204:207], v1, s[8:11], s41 offen offset:0 sc1
    buffer_store_dwordx4 v[192:195], v1, s[8:11], s40 offen offset:0 sc1
    v_lshlrev_b32 v188, 16, v140
    v_and_b32 v189, 0xffff0000, v140
    v_lshlrev_b32 v190, 16, v141
    v_and_b32 v191, 0xffff0000, v141
    v_pk_fma_f32 v[92:93], v[92:93], v[156:157], v[188:189]
    v_pk_fma_f32 v[94:95], v[94:95], v[158:159], v[190:191]
    v_cvt_pk_bf16_f32 v196, v92, v93
    v_cvt_pk_bf16_f32 v197, v94, v95
    v_lshlrev_b32 v92, 16, v196
    v_and_b32 v93, 0xffff0000, v196
    v_lshlrev_b32 v94, 16, v197
    v_and_b32 v95, 0xffff0000, v197
    v_pk_mul_f32 v[188:189], v[92:93], v[176:177]
    v_pk_mul_f32 v[190:191], v[94:95], v[178:179]
    v_cvt_pk_bf16_f32 v208, v188, v189
    v_cvt_pk_bf16_f32 v209, v190, v191
    v_lshlrev_b32 v188, 16, v142
    v_and_b32 v189, 0xffff0000, v142
    v_lshlrev_b32 v190, 16, v143
    v_and_b32 v191, 0xffff0000, v143
    v_pk_fma_f32 v[96:97], v[96:97], v[160:161], v[188:189]
    v_pk_fma_f32 v[98:99], v[98:99], v[162:163], v[190:191]
    v_cvt_pk_bf16_f32 v198, v96, v97
    v_cvt_pk_bf16_f32 v199, v98, v99
    v_lshlrev_b32 v96, 16, v198
    v_and_b32 v97, 0xffff0000, v198
    v_lshlrev_b32 v98, 16, v199
    v_and_b32 v99, 0xffff0000, v199
    v_pk_mul_f32 v[188:189], v[96:97], v[180:181]
    v_pk_mul_f32 v[190:191], v[98:99], v[182:183]
    v_cvt_pk_bf16_f32 v210, v188, v189
    v_cvt_pk_bf16_f32 v211, v190, v191
    buffer_store_dwordx4 v[208:211], v1, s[8:11], s41 offen offset:1024 sc1
    buffer_store_dwordx4 v[196:199], v1, s[8:11], s40 offen offset:1024 sc1
    v_pk_add_f32 v[148:149], v[84:85], v[86:87]
    v_pk_mul_f32 v[150:151], v[84:85], v[84:85]
    v_pk_fma_f32 v[150:151], v[86:87], v[86:87], v[150:151]
    v_pk_add_f32 v[148:149], v[148:149], v[88:89]
    v_pk_fma_f32 v[150:151], v[88:89], v[88:89], v[150:151]
    v_pk_add_f32 v[148:149], v[148:149], v[90:91]
    v_pk_fma_f32 v[150:151], v[90:91], v[90:91], v[150:151]
    v_pk_add_f32 v[148:149], v[148:149], v[92:93]
    v_pk_fma_f32 v[150:151], v[92:93], v[92:93], v[150:151]
    v_pk_add_f32 v[148:149], v[148:149], v[94:95]
    v_pk_fma_f32 v[150:151], v[94:95], v[94:95], v[150:151]
    v_pk_add_f32 v[148:149], v[148:149], v[96:97]
    v_pk_fma_f32 v[150:151], v[96:97], v[96:97], v[150:151]
    v_pk_add_f32 v[148:149], v[148:149], v[98:99]
    v_pk_fma_f32 v[150:151], v[98:99], v[98:99], v[150:151]
    v_add_f32 v216, v148, v149
    v_add_f32 v217, v150, v151
    v_mov_b32 v188, v216
    v_mov_b32 v189, v217
    s_nop 0
    v_permlane32_swap_b32 v216, v188
    v_permlane32_swap_b32 v217, v189
    v_add_f32 v216, v216, v188
    v_add_f32 v217, v217, v189
    v_mov_b32 v188, v216
    v_mov_b32 v189, v217
    s_nop 0
    v_permlane16_swap_b32 v216, v188
    v_permlane16_swap_b32 v217, v189
    v_add_f32 v216, v216, v188
    v_add_f32 v217, v217, v189
    s_mov_b64 exec, 0xffff
    buffer_store_dwordx2 v[216:217], v5, s[8:11], s38 offen sc1
    s_mov_b64 exec, -1
    s_branch K4_JOIN
K4_LOAD:
    s_cmp_eq_u32 s28, 1
    s_cbranch_scc1 K4_LOAD_ODD
    s_and_b32 s24, s16, 1
    s_lshl_b32 s25, s24, 10
    s_add_u32 m0, s25, 65536
    s_mul_i32 s24, s24, 4608
    s_mul_i32 s25, s27, 576
    s_add_u32 s24, s24, s25
    s_add_u32 s24, s24, 4608
    buffer_load_dwordx4 v1, s[8:11], s24 offen lds
    s_add_u32 m0, s20, 71680
    s_add_u32 s24, s21, 0
    buffer_load_dwordx4 v1, s[8:11], s24 offen lds
    s_add_u32 m0, s20, 75776
    s_add_u32 s24, s21, 4096
    buffer_load_dwordx4 v1, s[8:11], s24 offen lds
    s_add_u32 m0, s20, 79872
    s_add_u32 s24, s21, 8192
    buffer_load_dwordx4 v1, s[8:11], s24 offen lds
    s_add_u32 m0, s20, 83968
    s_add_u32 s24, s21, 12288
    buffer_load_dwordx4 v1, s[8:11], s24 offen lds
    s_add_u32 m0, s20, 88064
    s_add_u32 s24, s21, 16384
    buffer_load_dwordx4 v1, s[8:11], s24 offen lds
    s_add_u32 m0, s20, 92160
    s_add_u32 s24, s21, 20480
    buffer_load_dwordx4 v1, s[8:11], s24 offen lds
    s_add_u32 m0, s20, 96256
    s_add_u32 s24, s21, 24576
    buffer_load_dwordx4 v1, s[8:11], s24 offen lds
    s_add_u32 m0, s20, 100352
    s_add_u32 s24, s21, 28672
    buffer_load_dwordx4 v1, s[8:11], s24 offen lds
    s_add_u32 m0, s20, 104448
    s_add_u32 s24, s21, 32768
    buffer_load_dwordx4 v1, s[8:11], s24 offen lds
    s_add_u32 m0, s20, 108544
    s_add_u32 s24, s21, 36864
    buffer_load_dwordx4 v1, s[8:11], s24 offen lds
    s_add_u32 m0, s20, 112640
    s_add_u32 s24, s21, 40960
    buffer_load_dwordx4 v1, s[8:11], s24 offen lds
    s_add_u32 m0, s20, 116736
    s_add_u32 s24, s21, 45056
    buffer_load_dwordx4 v1, s[8:11], s24 offen lds
    s_add_u32 m0, s20, 120832
    s_add_u32 s24, s21, 49152
    buffer_load_dwordx4 v1, s[8:11], s24 offen lds
    s_add_u32 m0, s20, 124928
    s_add_u32 s24, s21, 53248
    buffer_load_dwordx4 v1, s[8:11], s24 offen lds
    s_add_u32 m0, s20, 129024
    s_add_u32 s24, s21, 57344
    buffer_load_dwordx4 v1, s[8:11], s24 offen lds
    s_add_u32 m0, s20, 133120
    s_add_u32 s24, s21, 61440
    buffer_load_dwordx4 v1, s[8:11], s24 offen lds
    s_waitcnt vmcnt(12)
    s_barrier
    s_add_u32 m0, s20, 137216
    s_add_u32 s24, s21, 65536
    buffer_load_dwordx4 v1, s[8:11], s24 offen lds
    s_add_u32 m0, s20, 141312
    s_add_u32 s24, s21, 69632
    buffer_load_dwordx4 v1, s[8:11], s24 offen lds
    s_add_u32 m0, s20, 145408
    s_add_u32 s24, s21, 73728
    buffer_load_dwordx4 v1, s[8:11], s24 offen lds
    s_add_u32 m0, s20, 149504
    s_add_u32 s24, s21, 77824
    buffer_load_dwordx4 v1, s[8:11], s24 offen lds
    s_add_u32 m0, s20, 153600
    s_add_u32 s24, s21, 81920
    buffer_load_dwordx4 v1, s[8:11], s24 offen lds
    s_add_u32 m0, s20, 157696
    s_add_u32 s24, s21, 86016
    buffer_load_dwordx4 v1, s[8:11], s24 offen lds
    s_add_u32 m0, s20, 161792
    s_add_u32 s24, s21, 90112
    buffer_load_dwordx4 v1, s[8:11], s24 offen lds
    s_waitcnt vmcnt(15)
    s_barrier
    s_waitcnt vmcnt(11)
    s_barrier
    s_waitcnt vmcnt(8)
    s_barrier
    s_waitcnt vmcnt(4)
    s_barrier
    s_waitcnt vmcnt(0)
    s_barrier
    s_add_u32 m0, s20, 0
    s_add_u32 s24, s44, 0
    buffer_load_dwordx4 v1, s[8:11], s24 offen lds
    s_add_u32 m0, s20, 4096
    s_add_u32 s24, s44, 4096
    buffer_load_dwordx4 v1, s[8:11], s24 offen lds
    s_add_u32 m0, s20, 8192
    s_add_u32 s24, s44, 8192
    buffer_load_dwordx4 v1, s[8:11], s24 offen lds
    s_add_u32 m0, s20, 12288
    s_add_u32 s24, s44, 12288
    buffer_load_dwordx4 v1, s[8:11], s24 offen lds
    s_add_u32 m0, s20, 16384
    s_add_u32 s24, s44, 16384
    buffer_load_dwordx4 v1, s[8:11], s24 offen lds
    s_add_u32 m0, s20, 20480
    s_add_u32 s24, s44, 20480
    buffer_load_dwordx4 v1, s[8:11], s24 offen lds
    s_add_u32 m0, s20, 24576
    s_add_u32 s24, s44, 24576
    buffer_load_dwordx4 v1, s[8:11], s24 offen lds
    s_add_u32 m0, s20, 28672
    s_add_u32 s24, s44, 28672
    buffer_load_dwordx4 v1, s[8:11], s24 offen lds
    s_add_u32 m0, s20, 32768
    s_add_u32 s24, s44, 32768
    buffer_load_dwordx4 v1, s[8:11], s24 offen lds
    s_add_u32 m0, s20, 36864
    s_add_u32 s24, s44, 36864
    buffer_load_dwordx4 v1, s[8:11], s24 offen lds
    s_branch K4_JOIN
K4_LOAD_ODD:
    s_and_b32 s24, s16, 1
    s_lshl_b32 s25, s24, 10
    s_add_u32 m0, s25, 65536
    s_mul_i32 s24, s24, 4608
    s_mul_i32 s25, s27, 576
    s_add_u32 s24, s24, s25
    s_add_u32 s24, s24, 4608
    buffer_load_dwordx4 v1, s[8:11], s24 offen lds
    s_add_u32 m0, s20, 71680
    s_add_u32 s24, s21, 0
    buffer_load_dwordx4 v1, s[8:11], s24 offen lds
    s_add_u32 m0, s20, 75776
    s_add_u32 s24, s21, 4096
    buffer_load_dwordx4 v1, s[8:11], s24 offen lds
    s_add_u32 m0, s20, 79872
    s_add_u32 s24, s21, 8192
    buffer_load_dwordx4 v1, s[8:11], s24 offen lds
    s_add_u32 m0, s20, 83968
    s_add_u32 s24, s21, 12288
    buffer_load_dwordx4 v1, s[8:11], s24 offen lds
    s_add_u32 m0, s20, 88064
    s_add_u32 s24, s21, 16384
    buffer_load_dwordx4 v1, s[8:11], s24 offen lds
    s_add_u32 m0, s20, 92160
    s_add_u32 s24, s21, 20480
    buffer_load_dwordx4 v1, s[8:11], s24 offen lds
    s_add_u32 m0, s20, 96256
    s_add_u32 s24, s21, 24576
    buffer_load_dwordx4 v1, s[8:11], s24 offen lds
    s_add_u32 m0, s20, 100352
    s_add_u32 s24, s21, 28672
    buffer_load_dwordx4 v1, s[8:11], s24 offen lds
    s_add_u32 m0, s20, 104448
    s_add_u32 s24, s21, 32768
    buffer_load_dwordx4 v1, s[8:11], s24 offen lds
    s_add_u32 m0, s20, 108544
    s_add_u32 s24, s21, 36864
    buffer_load_dwordx4 v1, s[8:11], s24 offen lds
    s_add_u32 m0, s20, 112640
    s_add_u32 s24, s21, 40960
    buffer_load_dwordx4 v1, s[8:11], s24 offen lds
    s_add_u32 m0, s20, 116736
    s_add_u32 s24, s21, 45056
    buffer_load_dwordx4 v1, s[8:11], s24 offen lds
    s_add_u32 m0, s20, 120832
    s_add_u32 s24, s21, 49152
    buffer_load_dwordx4 v1, s[8:11], s24 offen lds
    s_waitcnt vmcnt(10)
    s_barrier
    s_add_u32 m0, s20, 124928
    s_add_u32 s24, s21, 53248
    buffer_load_dwordx4 v1, s[8:11], s24 offen lds
    s_add_u32 m0, s20, 129024
    s_add_u32 s24, s21, 57344
    buffer_load_dwordx4 v1, s[8:11], s24 offen lds
    s_add_u32 m0, s20, 133120
    s_add_u32 s24, s21, 61440
    buffer_load_dwordx4 v1, s[8:11], s24 offen lds
    s_add_u32 m0, s20, 137216
    s_add_u32 s24, s21, 65536
    buffer_load_dwordx4 v1, s[8:11], s24 offen lds
    s_add_u32 m0, s20, 141312
    s_add_u32 s24, s21, 69632
    buffer_load_dwordx4 v1, s[8:11], s24 offen lds
    s_waitcnt vmcnt(12)
    s_barrier
    s_waitcnt vmcnt(9)
    s_barrier
    s_waitcnt vmcnt(6)
    s_barrier
    s_waitcnt vmcnt(3)
    s_barrier
    s_waitcnt vmcnt(0)
    s_barrier
    s_add_u32 m0, s20, 0
    s_add_u32 s24, s44, 0
    buffer_load_dwordx4 v1, s[8:11], s24 offen lds
    s_add_u32 m0, s20, 4096
    s_add_u32 s24, s44, 4096
    buffer_load_dwordx4 v1, s[8:11], s24 offen lds
    s_add_u32 m0, s20, 8192
    s_add_u32 s24, s44, 8192
    buffer_load_dwordx4 v1, s[8:11], s24 offen lds
    s_add_u32 m0, s20, 12288
    s_add_u32 s24, s44, 12288
    buffer_load_dwordx4 v1, s[8:11], s24 offen lds
    s_add_u32 m0, s20, 16384
    s_add_u32 s24, s44, 16384
    buffer_load_dwordx4 v1, s[8:11], s24 offen lds
    s_add_u32 m0, s20, 20480
    s_add_u32 s24, s44, 20480
    buffer_load_dwordx4 v1, s[8:11], s24 offen lds
    s_add_u32 m0, s20, 24576
    s_add_u32 s24, s44, 24576
    buffer_load_dwordx4 v1, s[8:11], s24 offen lds
    s_add_u32 m0, s20, 28672
    s_add_u32 s24, s44, 28672
    buffer_load_dwordx4 v1, s[8:11], s24 offen lds
    s_add_u32 m0, s20, 32768
    s_add_u32 s24, s44, 32768
    buffer_load_dwordx4 v1, s[8:11], s24 offen lds
    s_add_u32 m0, s20, 36864
    s_add_u32 s24, s44, 36864
    buffer_load_dwordx4 v1, s[8:11], s24 offen lds
K4_JOIN:
    s_and_b32 s46, s2, 7
    s_lshl_b32 s46, s46, 7
    s_lshr_b32 s47, s2, 3
    s_lshl_b32 s47, s47, 2
    s_add_u32 s46, s46, s47
    s_add_u32 s46, s46, 20721664
    s_lshr_b32 s47, s2, 5
    s_lshl_b32 s47, s47, 7
    s_add_u32 s47, s47, 20721664
    s_and_b32 s13, s2, 7
    s_lshr_b32 s14, s2, 3
    s_and_b32 s15, s14, 3
    s_lshl_b32 s13, s13, 2
    s_add_u32 s13, s13, s15
    s_lshr_b32 s14, s14, 2
    s_lshl_b32 s14, s14, 4
    s_lshl_b32 s15, s12, 1
    s_add_u32 s14, s14, s15
    s_mul_i32 s16, s13, 350208
    s_add_u32 s16, s16, 20971520
    s_lshl_b32 s20, s12, 10
    s_add_u32 s21, s20, s16
    s_mul_i32 s26, s14, 18432
    s_add_u32 s26, s26, 16777216
    s_add_u32 s27, s26, 18432
    s_lshr_b32 s64, s2, 3
    s_and_b32 s64, s64, 3
    s_lshl_b32 s64, s64, 2
    s_bfe_u32 s65, s2, 0x20001
    s_add_u32 s64, s64, s65
    s_mul_i32 s64, s64, 331776
    s_add_u32 s64, s64, 33554432
    s_and_b32 s65, s12, 3
    s_lshl_b32 s65, s65, 10
    s_add_u32 s66, s65, s64
    s_add_u32 s64, s64, s20
    s_lshr_b32 s67, s2, 5
    s_lshl_b32 s67, s67, 2
    s_lshr_b32 s68, s13, 3
    s_add_u32 s67, s67, s68
    s_lshl_b32 s67, s67, 7
    s_and_b32 s68, s13, 7
    s_lshl_b32 s68, s68, 2
    s_add_u32 s67, s67, s68
    s_add_u32 s67, s67, 20717568
    s_and_b32 s70, s2, 1
    s_lshl_b32 s70, s70, 2
    s_lshr_b32 s71, s2, 6
    s_add_u32 s70, s70, s71
    s_lshl_b32 s70, s70, 2
    s_bfe_u32 s71, s2, 0x20001
    s_add_u32 s70, s70, s71
    s_lshl_b32 s70, s70, 7
    s_add_u32 s70, s70, 20717568
    v_add_u32 v3, 57344, v1
    v_add_u32 v4, 114688, v1
    s_waitcnt vmcnt(0) lgkmcnt(0)
    s_barrier
    s_cmp_lg_u32 s12, 0
    s_cbranch_scc1 K4_SIGD
    v_mov_b32 v2, 0
    v_mov_b32 v176, 1
    s_mov_b64 exec, 1
    buffer_store_dword v176, v2, s[8:11], s46 offen sc1
    s_mov_b64 exec, -1
K4_SIGD:
    s_add_u32 m0, s20, 40960
    s_add_u32 s17, s21, 40960
    buffer_load_dwordx4 v1, s[8:11], s17 offen lds
    s_add_u32 m0, s20, 49152
    s_add_u32 s17, s21, 49152
    buffer_load_dwordx4 v1, s[8:11], s17 offen lds
    s_add_u32 m0, s20, 57344
    s_add_u32 s17, s21, 57344
    buffer_load_dwordx4 v1, s[8:11], s17 offen lds
    s_add_u32 m0, s20, 65536
    s_add_u32 s17, s21, 65536
    buffer_load_dwordx4 v1, s[8:11], s17 offen lds
    s_add_u32 m0, s20, 73728
    s_add_u32 s17, s21, 73728
    buffer_load_dwordx4 v1, s[8:11], s17 offen lds
    s_add_u32 m0, s20, 81920
    s_add_u32 s17, s21, 81920
    buffer_load_dwordx4 v1, s[8:11], s17 offen lds
    s_add_u32 m0, s20, 90112
    s_add_u32 s17, s21, 90112
    buffer_load_dwordx4 v1, s[8:11], s17 offen lds
    s_add_u32 m0, s20, 98304
    s_add_u32 s17, s21, 98304
    buffer_load_dwordx4 v1, s[8:11], s17 offen lds
    s_add_u32 m0, s20, 106496
    s_add_u32 s17, s21, 106496
    buffer_load_dwordx4 v1, s[8:11], s17 offen lds
    s_add_u32 m0, s20, 114688
    s_add_u32 s17, s21, 114688
    buffer_load_dwordx4 v1, s[8:11], s17 offen lds
    s_cmp_lg_u32 s12, 0
    s_cbranch_scc1 K4_WAITED
    s_mov_b32 exec_lo, 0xffffffff
    s_mov_b32 exec_hi, 0
    v_lshlrev_b32 v2, 2, v0
    s_mov_b32 s56, 0
K4_POLL:
    buffer_load_dword v176, v2, s[8:11], s47 offen sc1
    s_add_u32 s56, s56, 1
    s_waitcnt vmcnt(0)
    v_cmp_ne_u32 vcc, 1, v176
    s_nop 4
    s_cbranch_vccz K4_POLLED
    s_cmp_lt_u32 s56, 0x40000
    s_cbranch_scc1 K4_POLL
K4_POLLED:
    s_mov_b64 exec, -1
K4_WAITED:
    s_barrier
    buffer_load_dwordx4 v[8:11], v1, s[8:11], s26 offen offset:0 sc1
    buffer_load_dwordx4 v[12:15], v1, s[8:11], s27 offen offset:0 sc1
    buffer_load_dwordx4 v[16:19], v1, s[8:11], s26 offen offset:1024 sc1
    buffer_load_dwordx4 v[20:23], v1, s[8:11], s27 offen offset:1024 sc1
    buffer_load_dwordx4 v[24:27], v1, s[8:11], s26 offen offset:2048 sc1
    buffer_load_dwordx4 v[28:31], v1, s[8:11], s27 offen offset:2048 sc1
    buffer_load_dwordx4 v[32:35], v1, s[8:11], s26 offen offset:3072 sc1
    buffer_load_dwordx4 v[36:39], v1, s[8:11], s27 offen offset:3072 sc1
    s_lshl_b32 s30, s14, 10
    s_add_u32 s30, s30, 19922944
    s_lshr_b32 s31, s13, 1
    s_mul_i32 s31, s31, 9
    s_mul_i32 s32, s14, 144
    s_add_u32 s31, s31, s32
    s_lshl_b32 s31, s31, 10
    s_add_u32 s31, s31, 41943040
    s_and_b32 s32, s13, 1
    s_lshl_b32 s33, s32, 12
    s_add_u32 s36, s31, s33
    s_lshl_b32 s33, s32, 9
    s_add_u32 s40, s31, s33
    s_add_u32 s40, s40, 8192
    s_add_u32 s37, s36, 147456
    s_add_u32 s41, s40, 147456
    ds_read_b128 v[160:163], v1 offset:0
    ds_read_b128 v[164:167], v1 offset:1024
    ds_read_b128 v[168:171], v1 offset:2048
    s_waitcnt vmcnt(6) lgkmcnt(2)
    v_mfma_f32_16x16x32_bf16 v[176:179], v[160:163], v[8:11], 0
    ds_read_b128 v[172:175], v1 offset:3072
    v_mfma_f32_16x16x32_bf16 v[180:183], v[160:163], v[12:15], 0
    s_waitcnt lgkmcnt(2)
    v_mfma_f32_16x16x32_bf16 v[184:187], v[164:167], v[8:11], 0
    ds_read_b128 v[160:163], v1 offset:4096
    v_mfma_f32_16x16x32_bf16 v[188:191], v[164:167], v[12:15], 0
    s_add_u32 s26, s26, 4096
    s_add_u32 s27, s27, 4096
    buffer_load_dwordx4 v[40:43], v1, s[8:11], s26 offen offset:0 sc1
    buffer_load_dwordx4 v[44:47], v1, s[8:11], s27 offen offset:0 sc1
    s_waitcnt lgkmcnt(2)
    v_mfma_f32_16x16x32_bf16 v[192:195], v[168:171], v[8:11], 0
    ds_read_b128 v[164:167], v1 offset:5120
    v_mfma_f32_16x16x32_bf16 v[196:199], v[168:171], v[12:15], 0
    s_waitcnt lgkmcnt(2)
    v_mfma_f32_16x16x32_bf16 v[200:203], v[172:175], v[8:11], 0
    ds_read_b128 v[168:171], v1 offset:6144
    v_mfma_f32_16x16x32_bf16 v[204:207], v[172:175], v[12:15], 0
    s_waitcnt lgkmcnt(2)
    v_mfma_f32_16x16x32_bf16 v[208:211], v[160:163], v[8:11], 0
    ds_read_b128 v[172:175], v1 offset:7168
    v_mfma_f32_16x16x32_bf16 v[212:215], v[160:163], v[12:15], 0
    s_waitcnt lgkmcnt(2)
    v_mfma_f32_16x16x32_bf16 v[216:219], v[164:167], v[8:11], 0
    ds_read_b128 v[160:163], v1 offset:8192
    v_mfma_f32_16x16x32_bf16 v[220:223], v[164:167], v[12:15], 0
    s_waitcnt lgkmcnt(2)
    v_mfma_f32_16x16x32_bf16 v[224:227], v[168:171], v[8:11], 0
    ds_read_b128 v[164:167], v1 offset:9216
    v_mfma_f32_16x16x32_bf16 v[228:231], v[168:171], v[12:15], 0
    s_waitcnt lgkmcnt(2)
    v_mfma_f32_16x16x32_bf16 v[232:235], v[172:175], v[8:11], 0
    ds_read_b128 v[168:171], v1 offset:10240
    v_mfma_f32_16x16x32_bf16 v[236:239], v[172:175], v[12:15], 0
    buffer_load_dwordx4 v[48:51], v1, s[8:11], s26 offen offset:1024 sc1
    buffer_load_dwordx4 v[52:55], v1, s[8:11], s27 offen offset:1024 sc1
    s_waitcnt lgkmcnt(2)
    v_mfma_f32_16x16x32_bf16 v[240:243], v[160:163], v[8:11], 0
    ds_read_b128 v[172:175], v1 offset:11264
    v_mfma_f32_16x16x32_bf16 v[244:247], v[160:163], v[12:15], 0
    s_waitcnt lgkmcnt(2)
    v_mfma_f32_16x16x32_bf16 v[248:251], v[164:167], v[8:11], 0
    ds_read_b128 v[160:163], v1 offset:12288
    v_mfma_f32_16x16x32_bf16 v[252:255], v[164:167], v[12:15], 0
    s_waitcnt vmcnt(8) lgkmcnt(2)
    v_mfma_f32_16x16x32_bf16 v[176:179], v[168:171], v[16:19], v[176:179]
    ds_read_b128 v[164:167], v1 offset:13312
    v_mfma_f32_16x16x32_bf16 v[180:183], v[168:171], v[20:23], v[180:183]
    s_waitcnt lgkmcnt(2)
    v_mfma_f32_16x16x32_bf16 v[184:187], v[172:175], v[16:19], v[184:187]
    ds_read_b128 v[168:171], v1 offset:14336
    v_mfma_f32_16x16x32_bf16 v[188:191], v[172:175], v[20:23], v[188:191]
    s_waitcnt lgkmcnt(2)
    v_mfma_f32_16x16x32_bf16 v[192:195], v[160:163], v[16:19], v[192:195]
    ds_read_b128 v[172:175], v1 offset:15360
    v_mfma_f32_16x16x32_bf16 v[196:199], v[160:163], v[20:23], v[196:199]
    s_waitcnt lgkmcnt(2)
    v_mfma_f32_16x16x32_bf16 v[200:203], v[164:167], v[16:19], v[200:203]
    ds_read_b128 v[160:163], v1 offset:16384
    v_mfma_f32_16x16x32_bf16 v[204:207], v[164:167], v[20:23], v[204:207]
    buffer_load_dwordx4 v[56:59], v1, s[8:11], s26 offen offset:2048 sc1
    buffer_load_dwordx4 v[60:63], v1, s[8:11], s27 offen offset:2048 sc1
    s_waitcnt lgkmcnt(2)
    v_mfma_f32_16x16x32_bf16 v[208:211], v[168:171], v[16:19], v[208:211]
    ds_read_b128 v[164:167], v1 offset:17408
    v_mfma_f32_16x16x32_bf16 v[212:215], v[168:171], v[20:23], v[212:215]
    s_waitcnt lgkmcnt(2)
    v_mfma_f32_16x16x32_bf16 v[216:219], v[172:175], v[16:19], v[216:219]
    ds_read_b128 v[168:171], v1 offset:18432
    v_mfma_f32_16x16x32_bf16 v[220:223], v[172:175], v[20:23], v[220:223]
    s_waitcnt lgkmcnt(2)
    v_mfma_f32_16x16x32_bf16 v[224:227], v[160:163], v[16:19], v[224:227]
    ds_read_b128 v[172:175], v1 offset:19456
    v_mfma_f32_16x16x32_bf16 v[228:231], v[160:163], v[20:23], v[228:231]
    s_waitcnt lgkmcnt(2)
    v_mfma_f32_16x16x32_bf16 v[232:235], v[164:167], v[16:19], v[232:235]
    ds_read_b128 v[160:163], v1 offset:20480
    v_mfma_f32_16x16x32_bf16 v[236:239], v[164:167], v[20:23], v[236:239]
    s_waitcnt lgkmcnt(2)
    v_mfma_f32_16x16x32_bf16 v[240:243], v[168:171], v[16:19], v[240:243]
    ds_read_b128 v[164:167], v1 offset:21504
    v_mfma_f32_16x16x32_bf16 v[244:247], v[168:171], v[20:23], v[244:247]
    s_waitcnt lgkmcnt(2)
    v_mfma_f32_16x16x32_bf16 v[248:251], v[172:175], v[16:19], v[248:251]
    ds_read_b128 v[168:171], v1 offset:22528
    v_mfma_f32_16x16x32_bf16 v[252:255], v[172:175], v[20:23], v[252:255]
    buffer_load_dwordx4 v[64:67], v1, s[8:11], s26 offen offset:3072 sc1
    buffer_load_dwordx4 v[68:71], v1, s[8:11], s27 offen offset:3072 sc1
    s_waitcnt vmcnt(10) lgkmcnt(2)
    v_mfma_f32_16x16x32_bf16 v[176:179], v[160:163], v[24:27], v[176:179]
    ds_read_b128 v[172:175], v1 offset:23552
    v_mfma_f32_16x16x32_bf16 v[180:183], v[160:163], v[28:31], v[180:183]
    s_waitcnt lgkmcnt(2)
    v_mfma_f32_16x16x32_bf16 v[184:187], v[164:167], v[24:27], v[184:187]
    ds_read_b128 v[160:163], v1 offset:24576
    v_mfma_f32_16x16x32_bf16 v[188:191], v[164:167], v[28:31], v[188:191]
    v_and_b32 v142, 0x300, v1
    v_and_b32 v143, 0x78, v5
    v_add_u32 v142, v142, v143
    buffer_load_dwordx2 v[136:137], v142, s[8:11], s30 offen offset:0 sc1
    buffer_load_dwordx2 v[138:139], v142, s[8:11], s30 offen offset:128 sc1
    buffer_load_dwordx2 v[144:145], v142, s[8:11], s30 offen offset:1024 sc1
    buffer_load_dwordx2 v[146:147], v142, s[8:11], s30 offen offset:1152 sc1
    s_waitcnt lgkmcnt(2)
    v_mfma_f32_16x16x32_bf16 v[192:195], v[168:171], v[24:27], v[192:195]
    ds_read_b128 v[164:167], v1 offset:25600
    v_mfma_f32_16x16x32_bf16 v[196:199], v[168:171], v[28:31], v[196:199]
    s_waitcnt lgkmcnt(2)
    v_mfma_f32_16x16x32_bf16 v[200:203], v[172:175], v[24:27], v[200:203]
    ds_read_b128 v[168:171], v1 offset:26624
    v_mfma_f32_16x16x32_bf16 v[204:207], v[172:175], v[28:31], v[204:207]
    s_waitcnt lgkmcnt(2)
    v_mfma_f32_16x16x32_bf16 v[208:211], v[160:163], v[24:27], v[208:211]
    ds_read_b128 v[172:175], v1 offset:27648
    v_mfma_f32_16x16x32_bf16 v[212:215], v[160:163], v[28:31], v[212:215]
    s_waitcnt lgkmcnt(2)
    v_mfma_f32_16x16x32_bf16 v[216:219], v[164:167], v[24:27], v[216:219]
    ds_read_b128 v[160:163], v1 offset:28672
    v_mfma_f32_16x16x32_bf16 v[220:223], v[164:167], v[28:31], v[220:223]
    s_add_u32 s26, s26, 4096
    s_add_u32 s27, s27, 4096
    buffer_load_dwordx2 v[72:73], v5, s[8:11], s26 offen offset:0 sc1
    buffer_load_dwordx2 v[74:75], v5, s[8:11], s26 offen offset:512 sc1
    buffer_load_dwordx2 v[76:77], v5, s[8:11], s27 offen offset:0 sc1
    buffer_load_dwordx2 v[78:79], v5, s[8:11], s27 offen offset:512 sc1
    s_waitcnt lgkmcnt(2)
    v_mfma_f32_16x16x32_bf16 v[224:227], v[168:171], v[24:27], v[224:227]
    ds_read_b128 v[164:167], v1 offset:29696
    v_mfma_f32_16x16x32_bf16 v[228:231], v[168:171], v[28:31], v[228:231]
    s_waitcnt lgkmcnt(2)
    v_mfma_f32_16x16x32_bf16 v[232:235], v[172:175], v[24:27], v[232:235]
    ds_read_b128 v[168:171], v1 offset:30720
    v_mfma_f32_16x16x32_bf16 v[236:239], v[172:175], v[28:31], v[236:239]
    s_waitcnt lgkmcnt(2)
    v_mfma_f32_16x16x32_bf16 v[240:243], v[160:163], v[24:27], v[240:243]
    ds_read_b128 v[172:175], v1 offset:31744
    v_mfma_f32_16x16x32_bf16 v[244:247], v[160:163], v[28:31], v[244:247]
    s_waitcnt lgkmcnt(2)
    v_mfma_f32_16x16x32_bf16 v[248:251], v[164:167], v[24:27], v[248:251]
    ds_read_b128 v[160:163], v1 offset:32768
    v_mfma_f32_16x16x32_bf16 v[252:255], v[164:167], v[28:31], v[252:255]
    s_waitcnt vmcnt(16) lgkmcnt(2)
    v_mfma_f32_16x16x32_bf16 v[176:179], v[168:171], v[32:35], v[176:179]
    ds_read_b128 v[164:167], v1 offset:33792
    v_mfma_f32_16x16x32_bf16 v[180:183], v[168:171], v[36:39], v[180:183]
    s_waitcnt lgkmcnt(2)
    v_mfma_f32_16x16x32_bf16 v[184:187], v[172:175], v[32:35], v[184:187]
    ds_read_b128 v[168:171], v1 offset:34816
    v_mfma_f32_16x16x32_bf16 v[188:191], v[172:175], v[36:39], v[188:191]
    buffer_load_dwordx4 v[80:83], v1, s[8:11], s26 offen offset:1024 sc1
    buffer_load_dwordx4 v[84:87], v1, s[8:11], s27 offen offset:1024 sc1
    s_waitcnt lgkmcnt(2)
    v_mfma_f32_16x16x32_bf16 v[192:195], v[160:163], v[32:35], v[192:195]
    ds_read_b128 v[172:175], v1 offset:35840
    v_mfma_f32_16x16x32_bf16 v[196:199], v[160:163], v[36:39], v[196:199]
    s_waitcnt lgkmcnt(2)
    v_mfma_f32_16x16x32_bf16 v[200:203], v[164:167], v[32:35], v[200:203]
    ds_read_b128 v[160:163], v1 offset:36864
    v_mfma_f32_16x16x32_bf16 v[204:207], v[164:167], v[36:39], v[204:207]
    s_waitcnt lgkmcnt(2)
    v_mfma_f32_16x16x32_bf16 v[208:211], v[168:171], v[32:35], v[208:211]
    ds_read_b128 v[164:167], v1 offset:37888
    v_mfma_f32_16x16x32_bf16 v[212:215], v[168:171], v[36:39], v[212:215]
    s_waitcnt lgkmcnt(2)
    v_mfma_f32_16x16x32_bf16 v[216:219], v[172:175], v[32:35], v[216:219]
    ds_read_b128 v[168:171], v1 offset:38912
    v_mfma_f32_16x16x32_bf16 v[220:223], v[172:175], v[36:39], v[220:223]
    s_waitcnt lgkmcnt(2)
    v_mfma_f32_16x16x32_bf16 v[224:227], v[160:163], v[32:35], v[224:227]
    ds_read_b128 v[172:175], v1 offset:39936
    v_mfma_f32_16x16x32_bf16 v[228:231], v[160:163], v[36:39], v[228:231]
    s_waitcnt lgkmcnt(2)
    v_mfma_f32_16x16x32_bf16 v[232:235], v[164:167], v[32:35], v[232:235]
    s_barrier
    ds_read_b128 v[160:163], v1 offset:40960
    v_mfma_f32_16x16x32_bf16 v[236:239], v[164:167], v[36:39], v[236:239]
    buffer_load_dwordx4 v[88:91], v1, s[8:11], s26 offen offset:2048 sc1
    buffer_load_dwordx4 v[92:95], v1, s[8:11], s27 offen offset:2048 sc1
    s_waitcnt lgkmcnt(2)
    v_mfma_f32_16x16x32_bf16 v[240:243], v[168:171], v[32:35], v[240:243]
    ds_read_b128 v[164:167], v1 offset:41984
    v_mfma_f32_16x16x32_bf16 v[244:247], v[168:171], v[36:39], v[244:247]
    s_waitcnt lgkmcnt(2)
    v_mfma_f32_16x16x32_bf16 v[248:251], v[172:175], v[32:35], v[248:251]
    ds_read_b128 v[168:171], v1 offset:43008
    v_mfma_f32_16x16x32_bf16 v[252:255], v[172:175], v[36:39], v[252:255]
    s_waitcnt vmcnt(18) lgkmcnt(2)
    v_mfma_f32_16x16x32_bf16 v[176:179], v[160:163], v[40:43], v[176:179]
    ds_read_b128 v[172:175], v1 offset:44032
    v_mfma_f32_16x16x32_bf16 v[180:183], v[160:163], v[44:47], v[180:183]
    s_waitcnt vmcnt(8)
    v_add_f32 v136, v136, v138
    s_waitcnt lgkmcnt(2)
    v_mfma_f32_16x16x32_bf16 v[184:187], v[164:167], v[40:43], v[184:187]
    ds_read_b128 v[160:163], v1 offset:45056
    v_mfma_f32_16x16x32_bf16 v[188:191], v[164:167], v[44:47], v[188:191]
    v_add_f32 v137, v137, v139
    v_mov_b32 v138, v136
    s_waitcnt lgkmcnt(2)
    v_mfma_f32_16x16x32_bf16 v[192:195], v[168:171], v[40:43], v[192:195]
    ds_read_b128 v[164:167], v1 offset:46080
    v_mfma_f32_16x16x32_bf16 v[196:199], v[168:171], v[44:47], v[196:199]
    v_mov_b32 v139, v137
    v_permlane32_swap_b32 v136, v138
    s_waitcnt lgkmcnt(2)
    v_mfma_f32_16x16x32_bf16 v[200:203], v[172:175], v[40:43], v[200:203]
    ds_read_b128 v[168:171], v1 offset:47104
    v_mfma_f32_16x16x32_bf16 v[204:207], v[172:175], v[44:47], v[204:207]
    buffer_load_dwordx4 v[96:99], v1, s[8:11], s26 offen offset:3072 sc1
    buffer_load_dwordx4 v[100:103], v1, s[8:11], s27 offen offset:3072 sc1
    v_permlane32_swap_b32 v137, v139
    v_add_f32 v136, v136, v138
    s_waitcnt lgkmcnt(2)
    v_mfma_f32_16x16x32_bf16 v[208:211], v[160:163], v[40:43], v[208:211]
    ds_read_b128 v[172:175], v1 offset:48128
    v_mfma_f32_16x16x32_bf16 v[212:215], v[160:163], v[44:47], v[212:215]
    s_add_u32 m0, s20, 122880
    s_add_u32 s17, s21, 122880
    buffer_load_dwordx4 v1, s[8:11], s17 offen lds
    v_add_f32 v137, v137, v139
    v_mov_b32 v138, v136
    s_waitcnt lgkmcnt(2)
    v_mfma_f32_16x16x32_bf16 v[216:219], v[164:167], v[40:43], v[216:219]
    ds_read_b128 v[160:163], v1 offset:49152
    v_mfma_f32_16x16x32_bf16 v[220:223], v[164:167], v[44:47], v[220:223]
    v_mov_b32 v139, v137
    v_permlane16_swap_b32 v136, v138
    s_waitcnt lgkmcnt(2)
    v_mfma_f32_16x16x32_bf16 v[224:227], v[168:171], v[40:43], v[224:227]
    ds_read_b128 v[164:167], v1 offset:50176
    v_mfma_f32_16x16x32_bf16 v[228:231], v[168:171], v[44:47], v[228:231]
    v_permlane16_swap_b32 v137, v139
    v_add_f32 v136, v136, v138
    s_waitcnt lgkmcnt(2)
    v_mfma_f32_16x16x32_bf16 v[232:235], v[172:175], v[40:43], v[232:235]
    ds_read_b128 v[168:171], v1 offset:51200
    v_mfma_f32_16x16x32_bf16 v[236:239], v[172:175], v[44:47], v[236:239]
    v_add_f32 v137, v137, v139
    v_mul_f32 v136, 0x3ae38e39, v136
    s_waitcnt lgkmcnt(2)
    v_mfma_f32_16x16x32_bf16 v[240:243], v[160:163], v[40:43], v[240:243]
    ds_read_b128 v[172:175], v1 offset:52224
    v_mfma_f32_16x16x32_bf16 v[244:247], v[160:163], v[44:47], v[244:247]
    v_mul_f32 v137, 0x3ae38e39, v137
    v_fma_f32 v137, -v136, v136, v137
    s_waitcnt lgkmcnt(2)
    v_mfma_f32_16x16x32_bf16 v[248:251], v[164:167], v[40:43], v[248:251]
    ds_read_b128 v[160:163], v1 offset:53248
    v_mfma_f32_16x16x32_bf16 v[252:255], v[164:167], v[44:47], v[252:255]
    s_add_u32 s26, s26, 4096
    s_add_u32 s27, s27, 4096
    buffer_load_dwordx4 v[104:107], v1, s[8:11], s26 offen offset:0 sc1
    buffer_load_dwordx4 v[108:111], v1, s[8:11], s27 offen offset:0 sc1
    v_max_f32 v137, 0, v137
    v_cvt_pk_bf16_f32 v138, v137, v137
    s_waitcnt lgkmcnt(2)
    v_mfma_f32_16x16x32_bf16 v[176:179], v[168:171], v[48:51], v[176:179]
    ds_read_b128 v[164:167], v1 offset:54272
    v_mfma_f32_16x16x32_bf16 v[180:183], v[168:171], v[52:55], v[180:183]
    s_add_u32 m0, s20, 131072
    s_add_u32 s17, s21, 131072
    buffer_load_dwordx4 v1, s[8:11], s17 offen lds
    v_lshlrev_b32 v137, 16, v138
    v_add_f32 v137, 0x3727c5ac, v137
    s_waitcnt lgkmcnt(2)
    v_mfma_f32_16x16x32_bf16 v[184:187], v[172:175], v[48:51], v[184:187]
    ds_read_b128 v[168:171], v1 offset:55296
    v_mfma_f32_16x16x32_bf16 v[188:191], v[172:175], v[52:55], v[188:191]
    v_cvt_pk_bf16_f32 v138, v137, v137
    v_lshlrev_b32 v137, 16, v138
    s_waitcnt lgkmcnt(2)
    v_mfma_f32_16x16x32_bf16 v[192:195], v[160:163], v[48:51], v[192:195]
    ds_read_b128 v[172:175], v1 offset:56320
    v_mfma_f32_16x16x32_bf16 v[196:199], v[160:163], v[52:55], v[196:199]
    v_sqrt_f32 v137, v137
    v_cvt_pk_bf16_f32 v152, -v136, -v136
    s_waitcnt lgkmcnt(2)
    v_mfma_f32_16x16x32_bf16 v[200:203], v[164:167], v[48:51], v[200:203]
    ds_read_b128 v[160:163], v3 offset:0
    v_mfma_f32_16x16x32_bf16 v[204:207], v[164:167], v[52:55], v[204:207]
    v_cvt_pk_bf16_f32 v153, -v136, v137
    v_cvt_pk_bf16_f32 v154, v137, v137
    s_waitcnt lgkmcnt(2)
    v_mfma_f32_16x16x32_bf16 v[208:211], v[168:171], v[48:51], v[208:211]
    ds_read_b128 v[164:167], v3 offset:1024
    v_mfma_f32_16x16x32_bf16 v[212:215], v[168:171], v[52:55], v[212:215]
    v_mov_b32 v155, 0
    v_add_f32 v144, v144, v146
    s_waitcnt lgkmcnt(2)
    v_mfma_f32_16x16x32_bf16 v[216:219], v[172:175], v[48:51], v[216:219]
    ds_read_b128 v[168:171], v3 offset:2048
    v_mfma_f32_16x16x32_bf16 v[220:223], v[172:175], v[52:55], v[220:223]
    buffer_load_dwordx4 v[112:115], v1, s[8:11], s26 offen offset:1024 sc1
    buffer_load_dwordx4 v[116:119], v1, s[8:11], s27 offen offset:1024 sc1
    v_add_f32 v145, v145, v147
    v_mov_b32 v146, v144
    s_waitcnt lgkmcnt(2)
    v_mfma_f32_16x16x32_bf16 v[224:227], v[160:163], v[48:51], v[224:227]
    ds_read_b128 v[172:175], v3 offset:3072
    v_mfma_f32_16x16x32_bf16 v[228:231], v[160:163], v[52:55], v[228:231]
    s_add_u32 m0, s20, 139264
    s_add_u32 s17, s21, 139264
    buffer_load_dwordx4 v1, s[8:11], s17 offen lds
    v_mov_b32 v147, v145
    v_permlane32_swap_b32 v144, v146
    s_waitcnt lgkmcnt(2)
    v_mfma_f32_16x16x32_bf16 v[232:235], v[164:167], v[48:51], v[232:235]
    ds_read_b128 v[160:163], v3 offset:4096
    v_mfma_f32_16x16x32_bf16 v[236:239], v[164:167], v[52:55], v[236:239]
    v_permlane32_swap_b32 v145, v147
    v_add_f32 v144, v144, v146
    s_waitcnt lgkmcnt(2)
    v_mfma_f32_16x16x32_bf16 v[240:243], v[168:171], v[48:51], v[240:243]
    ds_read_b128 v[164:167], v3 offset:5120
    v_mfma_f32_16x16x32_bf16 v[244:247], v[168:171], v[52:55], v[244:247]
    v_add_f32 v145, v145, v147
    v_mov_b32 v146, v144
    s_waitcnt lgkmcnt(2)
    v_mfma_f32_16x16x32_bf16 v[248:251], v[172:175], v[48:51], v[248:251]
    ds_read_b128 v[168:171], v3 offset:6144
    v_mfma_f32_16x16x32_bf16 v[252:255], v[172:175], v[52:55], v[252:255]
    v_mov_b32 v147, v145
    v_permlane16_swap_b32 v144, v146
    s_waitcnt lgkmcnt(2)
    v_mfma_f32_16x16x32_bf16 v[176:179], v[160:163], v[56:59], v[176:179]
    ds_read_b128 v[172:175], v3 offset:7168
    v_mfma_f32_16x16x32_bf16 v[180:183], v[160:163], v[60:63], v[180:183]
    v_permlane16_swap_b32 v145, v147
    v_add_f32 v144, v144, v146
    s_waitcnt lgkmcnt(2)
    v_mfma_f32_16x16x32_bf16 v[184:187], v[164:167], v[56:59], v[184:187]
    ds_read_b128 v[160:163], v3 offset:8192
    v_mfma_f32_16x16x32_bf16 v[188:191], v[164:167], v[60:63], v[188:191]
    buffer_load_dwordx4 v[120:123], v1, s[8:11], s26 offen offset:2048 sc1
    buffer_load_dwordx4 v[124:127], v1, s[8:11], s27 offen offset:2048 sc1
    v_add_f32 v145, v145, v147
    v_mul_f32 v144, 0x3ae38e39, v144
    s_waitcnt lgkmcnt(2)
    v_mfma_f32_16x16x32_bf16 v[192:195], v[168:171], v[56:59], v[192:195]
    ds_read_b128 v[164:167], v3 offset:9216
    v_mfma_f32_16x16x32_bf16 v[196:199], v[168:171], v[60:63], v[196:199]
    s_add_u32 m0, s20, 147456
    s_add_u32 s17, s21, 147456
    buffer_load_dwordx4 v1, s[8:11], s17 offen lds
    v_mul_f32 v145, 0x3ae38e39, v145
    v_fma_f32 v145, -v144, v144, v145
    s_waitcnt lgkmcnt(2)
    v_mfma_f32_16x16x32_bf16 v[200:203], v[172:175], v[56:59], v[200:203]
    ds_read_b128 v[168:171], v3 offset:10240
    v_mfma_f32_16x16x32_bf16 v[204:207], v[172:175], v[60:63], v[204:207]
    v_max_f32 v145, 0, v145
    v_cvt_pk_bf16_f32 v146, v145, v145
    s_waitcnt lgkmcnt(2)
    v_mfma_f32_16x16x32_bf16 v[208:211], v[160:163], v[56:59], v[208:211]
    ds_read_b128 v[172:175], v3 offset:11264
    v_mfma_f32_16x16x32_bf16 v[212:215], v[160:163], v[60:63], v[212:215]
    v_lshlrev_b32 v145, 16, v146
    v_add_f32 v145, 0x3727c5ac, v145
    s_waitcnt lgkmcnt(2)
    v_mfma_f32_16x16x32_bf16 v[216:219], v[164:167], v[56:59], v[216:219]
    ds_read_b128 v[160:163], v3 offset:12288
    v_mfma_f32_16x16x32_bf16 v[220:223], v[164:167], v[60:63], v[220:223]
    v_cvt_pk_bf16_f32 v146, v145, v145
    v_lshlrev_b32 v145, 16, v146
    s_waitcnt lgkmcnt(2)
    v_mfma_f32_16x16x32_bf16 v[224:227], v[168:171], v[56:59], v[224:227]
    ds_read_b128 v[164:167], v3 offset:13312
    v_mfma_f32_16x16x32_bf16 v[228:231], v[168:171], v[60:63], v[228:231]
    v_sqrt_f32 v145, v145
    v_cvt_pk_bf16_f32 v156, -v144, -v144
    s_waitcnt lgkmcnt(2)
    v_mfma_f32_16x16x32_bf16 v[232:235], v[172:175], v[56:59], v[232:235]
    ds_read_b128 v[168:171], v3 offset:14336
    v_mfma_f32_16x16x32_bf16 v[236:239], v[172:175], v[60:63], v[236:239]
    buffer_load_dwordx4 v[128:131], v1, s[8:11], s26 offen offset:3072 sc1
    buffer_load_dwordx4 v[132:135], v1, s[8:11], s27 offen offset:3072 sc1
    v_cvt_pk_bf16_f32 v157, -v144, v145
    v_cvt_pk_bf16_f32 v158, v145, v145
    s_waitcnt lgkmcnt(2)
    v_mfma_f32_16x16x32_bf16 v[240:243], v[160:163], v[56:59], v[240:243]
    ds_read_b128 v[172:175], v3 offset:15360
    v_mfma_f32_16x16x32_bf16 v[244:247], v[160:163], v[60:63], v[244:247]
    s_add_u32 m0, s20, 155648
    s_add_u32 s17, s21, 155648
    buffer_load_dwordx4 v1, s[8:11], s17 offen lds
    v_mov_b32 v159, 0
    s_waitcnt lgkmcnt(2)
    v_mfma_f32_16x16x32_bf16 v[248:251], v[164:167], v[56:59], v[248:251]
    ds_read_b128 v[160:163], v3 offset:16384
    v_mfma_f32_16x16x32_bf16 v[252:255], v[164:167], v[60:63], v[252:255]
    s_waitcnt lgkmcnt(2)
    v_mfma_f32_16x16x32_bf16 v[176:179], v[168:171], v[64:67], v[176:179]
    ds_read_b128 v[164:167], v3 offset:17408
    v_mfma_f32_16x16x32_bf16 v[180:183], v[168:171], v[68:71], v[180:183]
    s_waitcnt lgkmcnt(2)
    v_mfma_f32_16x16x32_bf16 v[184:187], v[172:175], v[64:67], v[184:187]
    ds_read_b128 v[168:171], v3 offset:18432
    v_mfma_f32_16x16x32_bf16 v[188:191], v[172:175], v[68:71], v[188:191]
    s_waitcnt lgkmcnt(2)
    v_mfma_f32_16x16x32_bf16 v[192:195], v[160:163], v[64:67], v[192:195]
    ds_read_b128 v[172:175], v3 offset:19456
    v_mfma_f32_16x16x32_bf16 v[196:199], v[160:163], v[68:71], v[196:199]
    s_waitcnt lgkmcnt(2)
    v_mfma_f32_16x16x32_bf16 v[200:203], v[164:167], v[64:67], v[200:203]
    ds_read_b128 v[160:163], v3 offset:20480
    v_mfma_f32_16x16x32_bf16 v[204:207], v[164:167], v[68:71], v[204:207]
    s_add_u32 s26, s26, 4096
    s_add_u32 s27, s27, 4096
    buffer_load_dwordx4 v[136:139], v1, s[8:11], s26 offen offset:0 sc1
    buffer_load_dwordx4 v[140:143], v1, s[8:11], s27 offen offset:0 sc1
    s_waitcnt lgkmcnt(2)
    v_mfma_f32_16x16x32_bf16 v[208:211], v[168:171], v[64:67], v[208:211]
    ds_read_b128 v[164:167], v3 offset:21504
    v_mfma_f32_16x16x32_bf16 v[212:215], v[168:171], v[68:71], v[212:215]
    s_waitcnt lgkmcnt(2)
    v_mfma_f32_16x16x32_bf16 v[216:219], v[172:175], v[64:67], v[216:219]
    ds_read_b128 v[168:171], v3 offset:22528
    v_mfma_f32_16x16x32_bf16 v[220:223], v[172:175], v[68:71], v[220:223]
    s_waitcnt lgkmcnt(2)
    v_mfma_f32_16x16x32_bf16 v[224:227], v[160:163], v[64:67], v[224:227]
    ds_read_b128 v[172:175], v3 offset:23552
    v_mfma_f32_16x16x32_bf16 v[228:231], v[160:163], v[68:71], v[228:231]
    s_waitcnt lgkmcnt(2)
    v_mfma_f32_16x16x32_bf16 v[232:235], v[164:167], v[64:67], v[232:235]
    s_barrier
    ds_read_b128 v[160:163], v3 offset:24576
    v_mfma_f32_16x16x32_bf16 v[236:239], v[164:167], v[68:71], v[236:239]
    s_waitcnt lgkmcnt(2)
    v_mfma_f32_16x16x32_bf16 v[240:243], v[168:171], v[64:67], v[240:243]
    ds_read_b128 v[164:167], v3 offset:25600
    v_mfma_f32_16x16x32_bf16 v[244:247], v[168:171], v[68:71], v[244:247]
    s_add_u32 m0, s20, 0
    s_add_u32 s17, s21, 163840
    buffer_load_dwordx4 v1, s[8:11], s17 offen lds
    s_waitcnt lgkmcnt(2)
    v_mfma_f32_16x16x32_bf16 v[248:251], v[172:175], v[64:67], v[248:251]
    ds_read_b128 v[168:171], v3 offset:26624
    v_mfma_f32_16x16x32_bf16 v[252:255], v[172:175], v[68:71], v[252:255]
    buffer_load_dwordx2 v[144:145], v5, s[8:11], s26 offen offset:1024 sc1
    buffer_load_dwordx2 v[146:147], v5, s[8:11], s26 offen offset:1536 sc1
    buffer_load_dwordx2 v[148:149], v5, s[8:11], s27 offen offset:1024 sc1
    buffer_load_dwordx2 v[150:151], v5, s[8:11], s27 offen offset:1536 sc1
    s_waitcnt vmcnt(26) lgkmcnt(2)
    v_mfma_f32_16x16x32_bf16 v[176:179], v[160:163], v[72:75], v[176:179]
    ds_read_b128 v[172:175], v3 offset:27648
    v_mfma_f32_16x16x32_bf16 v[180:183], v[160:163], v[76:79], v[180:183]
    s_waitcnt lgkmcnt(2)
    v_mfma_f32_16x16x32_bf16 v[184:187], v[164:167], v[72:75], v[184:187]
    ds_read_b128 v[160:163], v3 offset:28672
    v_mfma_f32_16x16x32_bf16 v[188:191], v[164:167], v[76:79], v[188:191]
    s_waitcnt lgkmcnt(2)
    v_mfma_f32_16x16x32_bf16 v[192:195], v[168:171], v[72:75], v[192:195]
    ds_read_b128 v[164:167], v3 offset:29696
    v_mfma_f32_16x16x32_bf16 v[196:199], v[168:171], v[76:79], v[196:199]
    s_add_u32 m0, s20, 8192
    s_add_u32 s17, s21, 172032
    buffer_load_dwordx4 v1, s[8:11], s17 offen lds
    s_waitcnt lgkmcnt(2)
    v_mfma_f32_16x16x32_bf16 v[200:203], v[172:175], v[72:75], v[200:203]
    ds_read_b128 v[168:171], v3 offset:30720
    v_mfma_f32_16x16x32_bf16 v[204:207], v[172:175], v[76:79], v[204:207]
    s_waitcnt lgkmcnt(2)
    v_mfma_f32_16x16x32_bf16 v[208:211], v[160:163], v[72:75], v[208:211]
    ds_read_b128 v[172:175], v3 offset:31744
    v_mfma_f32_16x16x32_bf16 v[212:215], v[160:163], v[76:79], v[212:215]
    s_waitcnt lgkmcnt(2)
    v_mfma_f32_16x16x32_bf16 v[216:219], v[164:167], v[72:75], v[216:219]
    ds_read_b128 v[160:163], v3 offset:32768
    v_mfma_f32_16x16x32_bf16 v[220:223], v[164:167], v[76:79], v[220:223]
    s_waitcnt lgkmcnt(2)
    v_mfma_f32_16x16x32_bf16 v[224:227], v[168:171], v[72:75], v[224:227]
    ds_read_b128 v[164:167], v3 offset:33792
    v_mfma_f32_16x16x32_bf16 v[228:231], v[168:171], v[76:79], v[228:231]
    s_add_u32 m0, s20, 16384
    s_add_u32 s17, s21, 180224
    buffer_load_dwordx4 v1, s[8:11], s17 offen lds
    s_waitcnt lgkmcnt(2)
    v_mfma_f32_16x16x32_bf16 v[232:235], v[172:175], v[72:75], v[232:235]
    ds_read_b128 v[168:171], v3 offset:34816
    v_mfma_f32_16x16x32_bf16 v[236:239], v[172:175], v[76:79], v[236:239]
    s_waitcnt lgkmcnt(2)
    v_mfma_f32_16x16x32_bf16 v[240:243], v[160:163], v[72:75], v[240:243]
    ds_read_b128 v[172:175], v3 offset:35840
    v_mfma_f32_16x16x32_bf16 v[244:247], v[160:163], v[76:79], v[244:247]
    s_waitcnt lgkmcnt(2)
    v_mfma_f32_16x16x32_bf16 v[248:251], v[164:167], v[72:75], v[248:251]
    ds_read_b128 v[160:163], v3 offset:36864
    v_mfma_f32_16x16x32_bf16 v[252:255], v[164:167], v[76:79], v[252:255]
    s_waitcnt vmcnt(26) lgkmcnt(2)
    v_mfma_f32_16x16x32_bf16 v[176:179], v[168:171], v[80:83], v[176:179]
    ds_read_b128 v[164:167], v3 offset:37888
    v_mfma_f32_16x16x32_bf16 v[180:183], v[168:171], v[84:87], v[180:183]
    s_add_u32 m0, s20, 24576
    s_add_u32 s17, s21, 188416
    buffer_load_dwordx4 v1, s[8:11], s17 offen lds
    s_waitcnt lgkmcnt(2)
    v_mfma_f32_16x16x32_bf16 v[184:187], v[172:175], v[80:83], v[184:187]
    ds_read_b128 v[168:171], v3 offset:38912
    v_mfma_f32_16x16x32_bf16 v[188:191], v[172:175], v[84:87], v[188:191]
    s_waitcnt lgkmcnt(2)
    v_mfma_f32_16x16x32_bf16 v[192:195], v[160:163], v[80:83], v[192:195]
    ds_read_b128 v[172:175], v3 offset:39936
    v_mfma_f32_16x16x32_bf16 v[196:199], v[160:163], v[84:87], v[196:199]
    s_waitcnt lgkmcnt(2)
    v_mfma_f32_16x16x32_bf16 v[200:203], v[164:167], v[80:83], v[200:203]
    ds_read_b128 v[160:163], v3 offset:40960
    v_mfma_f32_16x16x32_bf16 v[204:207], v[164:167], v[84:87], v[204:207]
    s_waitcnt lgkmcnt(2)
    v_mfma_f32_16x16x32_bf16 v[208:211], v[168:171], v[80:83], v[208:211]
    ds_read_b128 v[164:167], v3 offset:41984
    v_mfma_f32_16x16x32_bf16 v[212:215], v[168:171], v[84:87], v[212:215]
    s_add_u32 m0, s20, 32768
    s_add_u32 s17, s21, 196608
    buffer_load_dwordx4 v1, s[8:11], s17 offen lds
    s_waitcnt lgkmcnt(2)
    v_mfma_f32_16x16x32_bf16 v[216:219], v[172:175], v[80:83], v[216:219]
    ds_read_b128 v[168:171], v3 offset:43008
    v_mfma_f32_16x16x32_bf16 v[220:223], v[172:175], v[84:87], v[220:223]
    s_waitcnt lgkmcnt(2)
    v_mfma_f32_16x16x32_bf16 v[224:227], v[160:163], v[80:83], v[224:227]
    ds_read_b128 v[172:175], v3 offset:44032
    v_mfma_f32_16x16x32_bf16 v[228:231], v[160:163], v[84:87], v[228:231]
    s_waitcnt lgkmcnt(2)
    v_mfma_f32_16x16x32_bf16 v[232:235], v[164:167], v[80:83], v[232:235]
    ds_read_b128 v[160:163], v3 offset:45056
    v_mfma_f32_16x16x32_bf16 v[236:239], v[164:167], v[84:87], v[236:239]
    s_waitcnt lgkmcnt(2)
    v_mfma_f32_16x16x32_bf16 v[240:243], v[168:171], v[80:83], v[240:243]
    ds_read_b128 v[164:167], v3 offset:46080
    v_mfma_f32_16x16x32_bf16 v[244:247], v[168:171], v[84:87], v[244:247]
    s_waitcnt lgkmcnt(2)
    v_mfma_f32_16x16x32_bf16 v[248:251], v[172:175], v[80:83], v[248:251]
    ds_read_b128 v[168:171], v3 offset:47104
    v_mfma_f32_16x16x32_bf16 v[252:255], v[172:175], v[84:87], v[252:255]
    s_waitcnt vmcnt(26) lgkmcnt(2)
    v_mfma_f32_16x16x32_bf16 v[176:179], v[160:163], v[88:91], v[176:179]
    ds_read_b128 v[172:175], v3 offset:48128
    v_mfma_f32_16x16x32_bf16 v[180:183], v[160:163], v[92:95], v[180:183]
    s_waitcnt lgkmcnt(2)
    v_mfma_f32_16x16x32_bf16 v[184:187], v[164:167], v[88:91], v[184:187]
    ds_read_b128 v[160:163], v3 offset:49152
    v_mfma_f32_16x16x32_bf16 v[188:191], v[164:167], v[92:95], v[188:191]
    s_waitcnt lgkmcnt(2)
    v_mfma_f32_16x16x32_bf16 v[192:195], v[168:171], v[88:91], v[192:195]
    ds_read_b128 v[164:167], v3 offset:50176
    v_mfma_f32_16x16x32_bf16 v[196:199], v[168:171], v[92:95], v[196:199]
    s_waitcnt lgkmcnt(2)
    v_mfma_f32_16x16x32_bf16 v[200:203], v[172:175], v[88:91], v[200:203]
    ds_read_b128 v[168:171], v3 offset:51200
    v_mfma_f32_16x16x32_bf16 v[204:207], v[172:175], v[92:95], v[204:207]
    s_waitcnt lgkmcnt(2)
    v_mfma_f32_16x16x32_bf16 v[208:211], v[160:163], v[88:91], v[208:211]
    ds_read_b128 v[172:175], v3 offset:52224
    v_mfma_f32_16x16x32_bf16 v[212:215], v[160:163], v[92:95], v[212:215]
    s_waitcnt lgkmcnt(2)
    v_mfma_f32_16x16x32_bf16 v[216:219], v[164:167], v[88:91], v[216:219]
    ds_read_b128 v[160:163], v3 offset:53248
    v_mfma_f32_16x16x32_bf16 v[220:223], v[164:167], v[92:95], v[220:223]
    s_waitcnt lgkmcnt(2)
    v_mfma_f32_16x16x32_bf16 v[224:227], v[168:171], v[88:91], v[224:227]
    ds_read_b128 v[164:167], v3 offset:54272
    v_mfma_f32_16x16x32_bf16 v[228:231], v[168:171], v[92:95], v[228:231]
    s_waitcnt lgkmcnt(2)
    v_mfma_f32_16x16x32_bf16 v[232:235], v[172:175], v[88:91], v[232:235]
    ds_read_b128 v[168:171], v3 offset:55296
    v_mfma_f32_16x16x32_bf16 v[236:239], v[172:175], v[92:95], v[236:239]
    s_waitcnt lgkmcnt(2)
    v_mfma_f32_16x16x32_bf16 v[240:243], v[160:163], v[88:91], v[240:243]
    ds_read_b128 v[172:175], v3 offset:56320
    v_mfma_f32_16x16x32_bf16 v[244:247], v[160:163], v[92:95], v[244:247]
    s_waitcnt lgkmcnt(2)
    v_mfma_f32_16x16x32_bf16 v[248:251], v[164:167], v[88:91], v[248:251]
    ds_read_b128 v[160:163], v4 offset:0
    v_mfma_f32_16x16x32_bf16 v[252:255], v[164:167], v[92:95], v[252:255]
    s_waitcnt vmcnt(24) lgkmcnt(2)
    v_mfma_f32_16x16x32_bf16 v[176:179], v[168:171], v[96:99], v[176:179]
    ds_read_b128 v[164:167], v4 offset:1024
    v_mfma_f32_16x16x32_bf16 v[180:183], v[168:171], v[100:103], v[180:183]
    s_waitcnt lgkmcnt(2)
    v_mfma_f32_16x16x32_bf16 v[184:187], v[172:175], v[96:99], v[184:187]
    ds_read_b128 v[168:171], v4 offset:2048
    v_mfma_f32_16x16x32_bf16 v[188:191], v[172:175], v[100:103], v[188:191]
    s_waitcnt lgkmcnt(2)
    v_mfma_f32_16x16x32_bf16 v[192:195], v[160:163], v[96:99], v[192:195]
    ds_read_b128 v[172:175], v4 offset:3072
    v_mfma_f32_16x16x32_bf16 v[196:199], v[160:163], v[100:103], v[196:199]
    s_waitcnt lgkmcnt(2)
    v_mfma_f32_16x16x32_bf16 v[200:203], v[164:167], v[96:99], v[200:203]
    ds_read_b128 v[160:163], v4 offset:4096
    v_mfma_f32_16x16x32_bf16 v[204:207], v[164:167], v[100:103], v[204:207]
    s_waitcnt lgkmcnt(2)
    v_mfma_f32_16x16x32_bf16 v[208:211], v[168:171], v[96:99], v[208:211]
    ds_read_b128 v[164:167], v4 offset:5120
    v_mfma_f32_16x16x32_bf16 v[212:215], v[168:171], v[100:103], v[212:215]
    s_waitcnt lgkmcnt(2)
    v_mfma_f32_16x16x32_bf16 v[216:219], v[172:175], v[96:99], v[216:219]
    ds_read_b128 v[168:171], v4 offset:6144
    v_mfma_f32_16x16x32_bf16 v[220:223], v[172:175], v[100:103], v[220:223]
    s_waitcnt lgkmcnt(2)
    v_mfma_f32_16x16x32_bf16 v[224:227], v[160:163], v[96:99], v[224:227]
    ds_read_b128 v[172:175], v4 offset:7168
    v_mfma_f32_16x16x32_bf16 v[228:231], v[160:163], v[100:103], v[228:231]
    s_waitcnt lgkmcnt(2)
    v_mfma_f32_16x16x32_bf16 v[232:235], v[164:167], v[96:99], v[232:235]
    s_waitcnt vmcnt(11)
    s_barrier
    ds_read_b128 v[160:163], v4 offset:8192
    v_mfma_f32_16x16x32_bf16 v[236:239], v[164:167], v[100:103], v[236:239]
    s_waitcnt lgkmcnt(2)
    v_mfma_f32_16x16x32_bf16 v[240:243], v[168:171], v[96:99], v[240:243]
    ds_read_b128 v[164:167], v4 offset:9216
    v_mfma_f32_16x16x32_bf16 v[244:247], v[168:171], v[100:103], v[244:247]
    s_add_u32 m0, s20, 40960
    s_add_u32 s17, s21, 204800
    buffer_load_dwordx4 v1, s[8:11], s17 offen lds
    s_waitcnt lgkmcnt(2)
    v_mfma_f32_16x16x32_bf16 v[248:251], v[172:175], v[96:99], v[248:251]
    ds_read_b128 v[168:171], v4 offset:10240
    v_mfma_f32_16x16x32_bf16 v[252:255], v[172:175], v[100:103], v[252:255]
    s_waitcnt lgkmcnt(2)
    v_mfma_f32_16x16x32_bf16 v[176:179], v[160:163], v[104:107], v[176:179]
    ds_read_b128 v[172:175], v4 offset:11264
    v_mfma_f32_16x16x32_bf16 v[180:183], v[160:163], v[108:111], v[180:183]
    s_waitcnt lgkmcnt(2)
    v_mfma_f32_16x16x32_bf16 v[184:187], v[164:167], v[104:107], v[184:187]
    ds_read_b128 v[160:163], v4 offset:12288
    v_mfma_f32_16x16x32_bf16 v[188:191], v[164:167], v[108:111], v[188:191]
    s_waitcnt lgkmcnt(2)
    v_mfma_f32_16x16x32_bf16 v[192:195], v[168:171], v[104:107], v[192:195]
    ds_read_b128 v[164:167], v4 offset:13312
    v_mfma_f32_16x16x32_bf16 v[196:199], v[168:171], v[108:111], v[196:199]
    s_add_u32 m0, s20, 49152
    s_add_u32 s17, s21, 212992
    buffer_load_dwordx4 v1, s[8:11], s17 offen lds
    s_waitcnt lgkmcnt(2)
    v_mfma_f32_16x16x32_bf16 v[200:203], v[172:175], v[104:107], v[200:203]
    ds_read_b128 v[168:171], v4 offset:14336
    v_mfma_f32_16x16x32_bf16 v[204:207], v[172:175], v[108:111], v[204:207]
    s_waitcnt lgkmcnt(2)
    v_mfma_f32_16x16x32_bf16 v[208:211], v[160:163], v[104:107], v[208:211]
    ds_read_b128 v[172:175], v4 offset:15360
    v_mfma_f32_16x16x32_bf16 v[212:215], v[160:163], v[108:111], v[212:215]
    s_waitcnt lgkmcnt(2)
    v_mfma_f32_16x16x32_bf16 v[216:219], v[164:167], v[104:107], v[216:219]
    ds_read_b128 v[160:163], v4 offset:16384
    v_mfma_f32_16x16x32_bf16 v[220:223], v[164:167], v[108:111], v[220:223]
    s_waitcnt lgkmcnt(2)
    v_mfma_f32_16x16x32_bf16 v[224:227], v[168:171], v[104:107], v[224:227]
    ds_read_b128 v[164:167], v4 offset:17408
    v_mfma_f32_16x16x32_bf16 v[228:231], v[168:171], v[108:111], v[228:231]
    s_add_u32 m0, s20, 57344
    s_add_u32 s17, s21, 221184
    buffer_load_dwordx4 v1, s[8:11], s17 offen lds
    s_waitcnt lgkmcnt(2)
    v_mfma_f32_16x16x32_bf16 v[232:235], v[172:175], v[104:107], v[232:235]
    ds_read_b128 v[168:171], v4 offset:18432
    v_mfma_f32_16x16x32_bf16 v[236:239], v[172:175], v[108:111], v[236:239]
    s_waitcnt lgkmcnt(2)
    v_mfma_f32_16x16x32_bf16 v[240:243], v[160:163], v[104:107], v[240:243]
    ds_read_b128 v[172:175], v4 offset:19456
    v_mfma_f32_16x16x32_bf16 v[244:247], v[160:163], v[108:111], v[244:247]
    s_waitcnt lgkmcnt(2)
    v_mfma_f32_16x16x32_bf16 v[248:251], v[164:167], v[104:107], v[248:251]
    ds_read_b128 v[160:163], v4 offset:20480
    v_mfma_f32_16x16x32_bf16 v[252:255], v[164:167], v[108:111], v[252:255]
    s_waitcnt lgkmcnt(2)
    v_mfma_f32_16x16x32_bf16 v[176:179], v[168:171], v[112:115], v[176:179]
    ds_read_b128 v[164:167], v4 offset:21504
    v_mfma_f32_16x16x32_bf16 v[180:183], v[168:171], v[116:119], v[180:183]
    s_add_u32 m0, s20, 65536
    s_add_u32 s17, s21, 229376
    buffer_load_dwordx4 v1, s[8:11], s17 offen lds
    s_waitcnt lgkmcnt(2)
    v_mfma_f32_16x16x32_bf16 v[184:187], v[172:175], v[112:115], v[184:187]
    ds_read_b128 v[168:171], v4 offset:22528
    v_mfma_f32_16x16x32_bf16 v[188:191], v[172:175], v[116:119], v[188:191]
    s_waitcnt lgkmcnt(2)
    v_mfma_f32_16x16x32_bf16 v[192:195], v[160:163], v[112:115], v[192:195]
    ds_read_b128 v[172:175], v4 offset:23552
    v_mfma_f32_16x16x32_bf16 v[196:199], v[160:163], v[116:119], v[196:199]
    s_waitcnt lgkmcnt(2)
    v_mfma_f32_16x16x32_bf16 v[200:203], v[164:167], v[112:115], v[200:203]
    ds_read_b128 v[160:163], v4 offset:24576
    v_mfma_f32_16x16x32_bf16 v[204:207], v[164:167], v[116:119], v[204:207]
    s_waitcnt lgkmcnt(2)
    v_mfma_f32_16x16x32_bf16 v[208:211], v[168:171], v[112:115], v[208:211]
    ds_read_b128 v[164:167], v4 offset:25600
    v_mfma_f32_16x16x32_bf16 v[212:215], v[168:171], v[116:119], v[212:215]
    s_add_u32 m0, s20, 73728
    s_add_u32 s17, s21, 237568
    buffer_load_dwordx4 v1, s[8:11], s17 offen lds
    s_waitcnt lgkmcnt(2)
    v_mfma_f32_16x16x32_bf16 v[216:219], v[172:175], v[112:115], v[216:219]
    ds_read_b128 v[168:171], v4 offset:26624
    v_mfma_f32_16x16x32_bf16 v[220:223], v[172:175], v[116:119], v[220:223]
    s_waitcnt lgkmcnt(2)
    v_mfma_f32_16x16x32_bf16 v[224:227], v[160:163], v[112:115], v[224:227]
    ds_read_b128 v[172:175], v4 offset:27648
    v_mfma_f32_16x16x32_bf16 v[228:231], v[160:163], v[116:119], v[228:231]
    s_waitcnt lgkmcnt(2)
    v_mfma_f32_16x16x32_bf16 v[232:235], v[164:167], v[112:115], v[232:235]
    ds_read_b128 v[160:163], v4 offset:28672
    v_mfma_f32_16x16x32_bf16 v[236:239], v[164:167], v[116:119], v[236:239]
    s_waitcnt lgkmcnt(2)
    v_mfma_f32_16x16x32_bf16 v[240:243], v[168:171], v[112:115], v[240:243]
    ds_read_b128 v[164:167], v4 offset:29696
    v_mfma_f32_16x16x32_bf16 v[244:247], v[168:171], v[116:119], v[244:247]
    s_waitcnt lgkmcnt(2)
    v_mfma_f32_16x16x32_bf16 v[248:251], v[172:175], v[112:115], v[248:251]
    ds_read_b128 v[168:171], v4 offset:30720
    v_mfma_f32_16x16x32_bf16 v[252:255], v[172:175], v[116:119], v[252:255]
    s_waitcnt lgkmcnt(2)
    v_mfma_f32_16x16x32_bf16 v[176:179], v[160:163], v[120:123], v[176:179]
    ds_read_b128 v[172:175], v4 offset:31744
    v_mfma_f32_16x16x32_bf16 v[180:183], v[160:163], v[124:127], v[180:183]
    s_waitcnt lgkmcnt(2)
    v_mfma_f32_16x16x32_bf16 v[184:187], v[164:167], v[120:123], v[184:187]
    ds_read_b128 v[160:163], v4 offset:32768
    v_mfma_f32_16x16x32_bf16 v[188:191], v[164:167], v[124:127], v[188:191]
    s_waitcnt lgkmcnt(2)
    v_mfma_f32_16x16x32_bf16 v[192:195], v[168:171], v[120:123], v[192:195]
    ds_read_b128 v[164:167], v4 offset:33792
    v_mfma_f32_16x16x32_bf16 v[196:199], v[168:171], v[124:127], v[196:199]
    s_waitcnt lgkmcnt(2)
    v_mfma_f32_16x16x32_bf16 v[200:203], v[172:175], v[120:123], v[200:203]
    ds_read_b128 v[168:171], v4 offset:34816
    v_mfma_f32_16x16x32_bf16 v[204:207], v[172:175], v[124:127], v[204:207]
    s_waitcnt lgkmcnt(2)
    v_mfma_f32_16x16x32_bf16 v[208:211], v[160:163], v[120:123], v[208:211]
    ds_read_b128 v[172:175], v4 offset:35840
    v_mfma_f32_16x16x32_bf16 v[212:215], v[160:163], v[124:127], v[212:215]
    s_waitcnt lgkmcnt(2)
    v_mfma_f32_16x16x32_bf16 v[216:219], v[164:167], v[120:123], v[216:219]
    ds_read_b128 v[160:163], v4 offset:36864
    v_mfma_f32_16x16x32_bf16 v[220:223], v[164:167], v[124:127], v[220:223]
    s_waitcnt lgkmcnt(2)
    v_mfma_f32_16x16x32_bf16 v[224:227], v[168:171], v[120:123], v[224:227]
    ds_read_b128 v[164:167], v4 offset:37888
    v_mfma_f32_16x16x32_bf16 v[228:231], v[168:171], v[124:127], v[228:231]
    s_waitcnt lgkmcnt(2)
    v_mfma_f32_16x16x32_bf16 v[232:235], v[172:175], v[120:123], v[232:235]
    ds_read_b128 v[168:171], v4 offset:38912
    v_mfma_f32_16x16x32_bf16 v[236:239], v[172:175], v[124:127], v[236:239]
    s_waitcnt lgkmcnt(2)
    v_mfma_f32_16x16x32_bf16 v[240:243], v[160:163], v[120:123], v[240:243]
    ds_read_b128 v[172:175], v4 offset:39936
    v_mfma_f32_16x16x32_bf16 v[244:247], v[160:163], v[124:127], v[244:247]
    s_waitcnt lgkmcnt(2)
    v_mfma_f32_16x16x32_bf16 v[248:251], v[164:167], v[120:123], v[248:251]
    ds_read_b128 v[160:163], v4 offset:40960
    v_mfma_f32_16x16x32_bf16 v[252:255], v[164:167], v[124:127], v[252:255]
    s_waitcnt lgkmcnt(2)
    v_mfma_f32_16x16x32_bf16 v[176:179], v[168:171], v[128:131], v[176:179]
    ds_read_b128 v[164:167], v4 offset:41984
    v_mfma_f32_16x16x32_bf16 v[180:183], v[168:171], v[132:135], v[180:183]
    s_waitcnt lgkmcnt(2)
    v_mfma_f32_16x16x32_bf16 v[184:187], v[172:175], v[128:131], v[184:187]
    ds_read_b128 v[168:171], v4 offset:43008
    v_mfma_f32_16x16x32_bf16 v[188:191], v[172:175], v[132:135], v[188:191]
    s_waitcnt lgkmcnt(2)
    v_mfma_f32_16x16x32_bf16 v[192:195], v[160:163], v[128:131], v[192:195]
    ds_read_b128 v[172:175], v4 offset:44032
    v_mfma_f32_16x16x32_bf16 v[196:199], v[160:163], v[132:135], v[196:199]
    s_waitcnt lgkmcnt(2)
    v_mfma_f32_16x16x32_bf16 v[200:203], v[164:167], v[128:131], v[200:203]
    ds_read_b128 v[160:163], v4 offset:45056
    v_mfma_f32_16x16x32_bf16 v[204:207], v[164:167], v[132:135], v[204:207]
    s_waitcnt lgkmcnt(2)
    v_mfma_f32_16x16x32_bf16 v[208:211], v[168:171], v[128:131], v[208:211]
    ds_read_b128 v[164:167], v4 offset:46080
    v_mfma_f32_16x16x32_bf16 v[212:215], v[168:171], v[132:135], v[212:215]
    s_waitcnt lgkmcnt(2)
    v_mfma_f32_16x16x32_bf16 v[216:219], v[172:175], v[128:131], v[216:219]
    ds_read_b128 v[168:171], v4 offset:47104
    v_mfma_f32_16x16x32_bf16 v[220:223], v[172:175], v[132:135], v[220:223]
    s_waitcnt lgkmcnt(2)
    v_mfma_f32_16x16x32_bf16 v[224:227], v[160:163], v[128:131], v[224:227]
    ds_read_b128 v[172:175], v4 offset:48128
    v_mfma_f32_16x16x32_bf16 v[228:231], v[160:163], v[132:135], v[228:231]
    s_waitcnt lgkmcnt(2)
    v_mfma_f32_16x16x32_bf16 v[232:235], v[164:167], v[128:131], v[232:235]
    s_waitcnt vmcnt(5)
    s_barrier
    ds_read_b128 v[160:163], v1 offset:0
    v_mfma_f32_16x16x32_bf16 v[236:239], v[164:167], v[132:135], v[236:239]
    s_waitcnt lgkmcnt(2)
    v_mfma_f32_16x16x32_bf16 v[240:243], v[168:171], v[128:131], v[240:243]
    ds_read_b128 v[164:167], v1 offset:1024
    v_mfma_f32_16x16x32_bf16 v[244:247], v[168:171], v[132:135], v[244:247]
    s_add_u32 m0, s20, 81920
    s_add_u32 s17, s21, 245760
    buffer_load_dwordx4 v1, s[8:11], s17 offen lds
    s_waitcnt lgkmcnt(2)
    v_mfma_f32_16x16x32_bf16 v[248:251], v[172:175], v[128:131], v[248:251]
    ds_read_b128 v[168:171], v1 offset:2048
    v_mfma_f32_16x16x32_bf16 v[252:255], v[172:175], v[132:135], v[252:255]
    s_waitcnt lgkmcnt(2)
    v_mfma_f32_16x16x32_bf16 v[176:179], v[160:163], v[136:139], v[176:179]
    ds_read_b128 v[172:175], v1 offset:3072
    v_mfma_f32_16x16x32_bf16 v[180:183], v[160:163], v[140:143], v[180:183]
    s_waitcnt lgkmcnt(2)
    v_mfma_f32_16x16x32_bf16 v[184:187], v[164:167], v[136:139], v[184:187]
    ds_read_b128 v[160:163], v1 offset:4096
    v_mfma_f32_16x16x32_bf16 v[188:191], v[164:167], v[140:143], v[188:191]
    s_waitcnt lgkmcnt(2)
    v_mfma_f32_16x16x32_bf16 v[192:195], v[168:171], v[136:139], v[192:195]
    ds_read_b128 v[164:167], v1 offset:5120
    v_mfma_f32_16x16x32_bf16 v[196:199], v[168:171], v[140:143], v[196:199]
    s_add_u32 m0, s20, 90112
    s_add_u32 s17, s21, 253952
    buffer_load_dwordx4 v1, s[8:11], s17 offen lds
    s_waitcnt lgkmcnt(2)
    v_mfma_f32_16x16x32_bf16 v[200:203], v[172:175], v[136:139], v[200:203]
    ds_read_b128 v[168:171], v1 offset:6144
    v_mfma_f32_16x16x32_bf16 v[204:207], v[172:175], v[140:143], v[204:207]
    s_waitcnt lgkmcnt(2)
    v_mfma_f32_16x16x32_bf16 v[208:211], v[160:163], v[136:139], v[208:211]
    ds_read_b128 v[172:175], v1 offset:7168
    v_mfma_f32_16x16x32_bf16 v[212:215], v[160:163], v[140:143], v[212:215]
    s_waitcnt lgkmcnt(2)
    v_mfma_f32_16x16x32_bf16 v[216:219], v[164:167], v[136:139], v[216:219]
    ds_read_b128 v[160:163], v1 offset:8192
    v_mfma_f32_16x16x32_bf16 v[220:223], v[164:167], v[140:143], v[220:223]
    s_waitcnt lgkmcnt(2)
    v_mfma_f32_16x16x32_bf16 v[224:227], v[168:171], v[136:139], v[224:227]
    ds_read_b128 v[164:167], v1 offset:9216
    v_mfma_f32_16x16x32_bf16 v[228:231], v[168:171], v[140:143], v[228:231]
    s_add_u32 m0, s20, 98304
    s_add_u32 s17, s21, 262144
    buffer_load_dwordx4 v1, s[8:11], s17 offen lds
    s_waitcnt lgkmcnt(2)
    v_mfma_f32_16x16x32_bf16 v[232:235], v[172:175], v[136:139], v[232:235]
    ds_read_b128 v[168:171], v1 offset:10240
    v_mfma_f32_16x16x32_bf16 v[236:239], v[172:175], v[140:143], v[236:239]
    s_waitcnt lgkmcnt(2)
    v_mfma_f32_16x16x32_bf16 v[240:243], v[160:163], v[136:139], v[240:243]
    ds_read_b128 v[172:175], v1 offset:11264
    v_mfma_f32_16x16x32_bf16 v[244:247], v[160:163], v[140:143], v[244:247]
    s_waitcnt lgkmcnt(2)
    v_mfma_f32_16x16x32_bf16 v[248:251], v[164:167], v[136:139], v[248:251]
    ds_read_b128 v[160:163], v1 offset:12288
    v_mfma_f32_16x16x32_bf16 v[252:255], v[164:167], v[140:143], v[252:255]
    s_waitcnt lgkmcnt(2)
    v_mfma_f32_16x16x32_bf16 v[176:179], v[168:171], v[144:147], v[176:179]
    ds_read_b128 v[164:167], v1 offset:13312
    v_mfma_f32_16x16x32_bf16 v[180:183], v[168:171], v[148:151], v[180:183]
    s_add_u32 m0, s20, 106496
    s_add_u32 s17, s21, 270336
    buffer_load_dwordx4 v1, s[8:11], s17 offen lds
    s_waitcnt lgkmcnt(2)
    v_mfma_f32_16x16x32_bf16 v[184:187], v[172:175], v[144:147], v[184:187]
    ds_read_b128 v[168:171], v1 offset:14336
    v_mfma_f32_16x16x32_bf16 v[188:191], v[172:175], v[148:151], v[188:191]
    s_waitcnt lgkmcnt(2)
    v_mfma_f32_16x16x32_bf16 v[192:195], v[160:163], v[144:147], v[192:195]
    ds_read_b128 v[172:175], v1 offset:15360
    v_mfma_f32_16x16x32_bf16 v[196:199], v[160:163], v[148:151], v[196:199]
    s_waitcnt lgkmcnt(2)
    v_mfma_f32_16x16x32_bf16 v[200:203], v[164:167], v[144:147], v[200:203]
    ds_read_b128 v[160:163], v1 offset:16384
    v_mfma_f32_16x16x32_bf16 v[204:207], v[164:167], v[148:151], v[204:207]
    s_waitcnt lgkmcnt(2)
    v_mfma_f32_16x16x32_bf16 v[208:211], v[168:171], v[144:147], v[208:211]
    ds_read_b128 v[164:167], v1 offset:17408
    v_mfma_f32_16x16x32_bf16 v[212:215], v[168:171], v[148:151], v[212:215]
    s_add_u32 m0, s20, 114688
    s_add_u32 s17, s21, 278528
    buffer_load_dwordx4 v1, s[8:11], s17 offen lds
    s_waitcnt lgkmcnt(2)
    v_mfma_f32_16x16x32_bf16 v[216:219], v[172:175], v[144:147], v[216:219]
    ds_read_b128 v[168:171], v1 offset:18432
    v_mfma_f32_16x16x32_bf16 v[220:223], v[172:175], v[148:151], v[220:223]
    s_waitcnt lgkmcnt(2)
    v_mfma_f32_16x16x32_bf16 v[224:227], v[160:163], v[144:147], v[224:227]
    ds_read_b128 v[172:175], v1 offset:19456
    v_mfma_f32_16x16x32_bf16 v[228:231], v[160:163], v[148:151], v[228:231]
    s_waitcnt lgkmcnt(2)
    v_mfma_f32_16x16x32_bf16 v[232:235], v[164:167], v[144:147], v[232:235]
    ds_read_b128 v[160:163], v1 offset:20480
    v_mfma_f32_16x16x32_bf16 v[236:239], v[164:167], v[148:151], v[236:239]
    s_waitcnt lgkmcnt(2)
    v_mfma_f32_16x16x32_bf16 v[240:243], v[168:171], v[144:147], v[240:243]
    ds_read_b128 v[164:167], v1 offset:21504
    v_mfma_f32_16x16x32_bf16 v[244:247], v[168:171], v[148:151], v[244:247]
    s_waitcnt lgkmcnt(2)
    v_mfma_f32_16x16x32_bf16 v[248:251], v[172:175], v[144:147], v[248:251]
    ds_read_b128 v[168:171], v1 offset:22528
    v_mfma_f32_16x16x32_bf16 v[252:255], v[172:175], v[148:151], v[252:255]
    s_waitcnt lgkmcnt(2)
    v_mfma_f32_16x16x32_bf16 v[176:179], v[160:163], v[152:155], v[176:179]
    ds_read_b128 v[172:175], v1 offset:23552
    v_mfma_f32_16x16x32_bf16 v[180:183], v[160:163], v[156:159], v[180:183]
    s_waitcnt lgkmcnt(2)
    v_mfma_f32_16x16x32_bf16 v[184:187], v[164:167], v[152:155], v[184:187]
    ds_read_b128 v[160:163], v1 offset:24576
    v_mfma_f32_16x16x32_bf16 v[188:191], v[164:167], v[156:159], v[188:191]
    s_waitcnt lgkmcnt(2)
    v_mfma_f32_16x16x32_bf16 v[192:195], v[168:171], v[152:155], v[192:195]
    ds_read_b128 v[164:167], v1 offset:25600
    v_mfma_f32_16x16x32_bf16 v[196:199], v[168:171], v[156:159], v[196:199]
    s_waitcnt lgkmcnt(2)
    v_mfma_f32_16x16x32_bf16 v[200:203], v[172:175], v[152:155], v[200:203]
    ds_read_b128 v[168:171], v1 offset:26624
    v_mfma_f32_16x16x32_bf16 v[204:207], v[172:175], v[156:159], v[204:207]
    s_waitcnt lgkmcnt(2)
    v_mfma_f32_16x16x32_bf16 v[208:211], v[160:163], v[152:155], v[208:211]
    ds_read_b128 v[172:175], v1 offset:27648
    v_mfma_f32_16x16x32_bf16 v[212:215], v[160:163], v[156:159], v[212:215]
    s_waitcnt lgkmcnt(2)
    v_mfma_f32_16x16x32_bf16 v[216:219], v[164:167], v[152:155], v[216:219]
    ds_read_b128 v[160:163], v1 offset:28672
    v_mfma_f32_16x16x32_bf16 v[220:223], v[164:167], v[156:159], v[220:223]
    s_waitcnt lgkmcnt(2)
    v_mfma_f32_16x16x32_bf16 v[224:227], v[168:171], v[152:155], v[224:227]
    ds_read_b128 v[164:167], v1 offset:29696
    v_mfma_f32_16x16x32_bf16 v[228:231], v[168:171], v[156:159], v[228:231]
    s_waitcnt lgkmcnt(2)
    v_mfma_f32_16x16x32_bf16 v[232:235], v[172:175], v[152:155], v[232:235]
    ds_read_b128 v[168:171], v1 offset:30720
    v_mfma_f32_16x16x32_bf16 v[236:239], v[172:175], v[156:159], v[236:239]
    s_waitcnt lgkmcnt(2)
    v_mfma_f32_16x16x32_bf16 v[240:243], v[160:163], v[152:155], v[240:243]
    ds_read_b128 v[172:175], v1 offset:31744
    v_mfma_f32_16x16x32_bf16 v[244:247], v[160:163], v[156:159], v[244:247]
    s_waitcnt lgkmcnt(2)
    v_mfma_f32_16x16x32_bf16 v[248:251], v[164:167], v[152:155], v[248:251]
    ds_read_b128 v[160:163], v1 offset:32768
    v_mfma_f32_16x16x32_bf16 v[252:255], v[164:167], v[156:159], v[252:255]
    v_max_f32 v208, 0, v208
    v_max_f32 v209, 0, v209
    v_max_f32 v210, 0, v210
    v_max_f32 v211, 0, v211
    v_mul_f32 v208, v208, v216
    v_mul_f32 v209, v209, v217
    v_mul_f32 v210, v210, v218
    v_mul_f32 v211, v211, v219
    v_cvt_pk_bf16_f32 v216, v208, v209
    v_cvt_pk_bf16_f32 v217, v210, v211
    v_max_f32 v212, 0, v212
    v_max_f32 v213, 0, v213
    v_max_f32 v214, 0, v214
    v_max_f32 v215, 0, v215
    v_mul_f32 v212, v212, v220
    v_mul_f32 v213, v213, v221
    v_mul_f32 v214, v214, v222
    v_mul_f32 v215, v215, v223
    v_cvt_pk_bf16_f32 v220, v212, v213
    v_cvt_pk_bf16_f32 v221, v214, v215
    v_max_f32 v224, 0, v224
    v_max_f32 v225, 0, v225
    v_max_f32 v226, 0, v226
    v_max_f32 v227, 0, v227
    v_mul_f32 v224, v224, v232
    v_mul_f32 v225, v225, v233
    v_mul_f32 v226, v226, v234
    v_mul_f32 v227, v227, v235
    v_cvt_pk_bf16_f32 v218, v224, v225
    v_cvt_pk_bf16_f32 v219, v226, v227
    buffer_store_dwordx4 v[216:219], v1, s[8:11], s36 offen offset:1024 sc1
    v_max_f32 v228, 0, v228
    v_max_f32 v229, 0, v229
    v_max_f32 v230, 0, v230
    v_max_f32 v231, 0, v231
    v_mul_f32 v228, v228, v236
    v_mul_f32 v229, v229, v237
    v_mul_f32 v230, v230, v238
    v_mul_f32 v231, v231, v239
    v_cvt_pk_bf16_f32 v222, v228, v229
    v_cvt_pk_bf16_f32 v223, v230, v231
    buffer_store_dwordx4 v[220:223], v1, s[8:11], s37 offen offset:1024 sc1
    s_waitcnt lgkmcnt(2)
    v_mfma_f32_16x16x32_bf16 v[208:211], v[168:171], v[8:11], 0
    ds_read_b128 v[164:167], v1 offset:33792
    v_mfma_f32_16x16x32_bf16 v[212:215], v[168:171], v[12:15], 0
    v_max_f32 v176, 0, v176
    s_waitcnt lgkmcnt(2)
    v_mfma_f32_16x16x32_bf16 v[216:219], v[172:175], v[8:11], 0
    ds_read_b128 v[168:171], v1 offset:34816
    v_mfma_f32_16x16x32_bf16 v[220:223], v[172:175], v[12:15], 0
    v_max_f32 v177, 0, v177
    s_waitcnt lgkmcnt(2)
    v_mfma_f32_16x16x32_bf16 v[224:227], v[160:163], v[8:11], 0
    ds_read_b128 v[172:175], v1 offset:35840
    v_mfma_f32_16x16x32_bf16 v[228:231], v[160:163], v[12:15], 0
    v_max_f32 v178, 0, v178
    s_waitcnt lgkmcnt(2)
    v_mfma_f32_16x16x32_bf16 v[232:235], v[164:167], v[8:11], 0
    ds_read_b128 v[160:163], v1 offset:36864
    v_mfma_f32_16x16x32_bf16 v[236:239], v[164:167], v[12:15], 0
    v_max_f32 v179, 0, v179
    s_waitcnt lgkmcnt(2)
    v_mfma_f32_16x16x32_bf16 v[208:211], v[168:171], v[16:19], v[208:211]
    ds_read_b128 v[164:167], v1 offset:37888
    v_mfma_f32_16x16x32_bf16 v[212:215], v[168:171], v[20:23], v[212:215]
    v_mul_f32 v176, v176, v184
    s_waitcnt lgkmcnt(2)
    v_mfma_f32_16x16x32_bf16 v[216:219], v[172:175], v[16:19], v[216:219]
    ds_read_b128 v[168:171], v1 offset:38912
    v_mfma_f32_16x16x32_bf16 v[220:223], v[172:175], v[20:23], v[220:223]
    v_mul_f32 v177, v177, v185
    s_waitcnt lgkmcnt(2)
    v_mfma_f32_16x16x32_bf16 v[224:227], v[160:163], v[16:19], v[224:227]
    ds_read_b128 v[172:175], v1 offset:39936
    v_mfma_f32_16x16x32_bf16 v[228:231], v[160:163], v[20:23], v[228:231]
    v_mul_f32 v178, v178, v186
    s_waitcnt lgkmcnt(2)
    v_mfma_f32_16x16x32_bf16 v[232:235], v[164:167], v[16:19], v[232:235]
    s_waitcnt vmcnt(7)
    s_barrier
    ds_read_b128 v[160:163], v1 offset:40960
    v_mfma_f32_16x16x32_bf16 v[236:239], v[164:167], v[20:23], v[236:239]
    v_mul_f32 v179, v179, v187
    s_waitcnt lgkmcnt(2)
    v_mfma_f32_16x16x32_bf16 v[208:211], v[168:171], v[24:27], v[208:211]
    ds_read_b128 v[164:167], v1 offset:41984
    v_mfma_f32_16x16x32_bf16 v[212:215], v[168:171], v[28:31], v[212:215]
    s_add_u32 m0, s20, 122880
    s_add_u32 s17, s21, 286720
    buffer_load_dwordx4 v1, s[8:11], s17 offen lds
    v_cvt_pk_bf16_f32 v184, v176, v177
    s_waitcnt lgkmcnt(2)
    v_mfma_f32_16x16x32_bf16 v[216:219], v[172:175], v[24:27], v[216:219]
    ds_read_b128 v[168:171], v1 offset:43008
    v_mfma_f32_16x16x32_bf16 v[220:223], v[172:175], v[28:31], v[220:223]
    v_cvt_pk_bf16_f32 v185, v178, v179
    s_waitcnt lgkmcnt(2)
    v_mfma_f32_16x16x32_bf16 v[224:227], v[160:163], v[24:27], v[224:227]
    ds_read_b128 v[172:175], v1 offset:44032
    v_mfma_f32_16x16x32_bf16 v[228:231], v[160:163], v[28:31], v[228:231]
    v_max_f32 v180, 0, v180
    s_waitcnt lgkmcnt(2)
    v_mfma_f32_16x16x32_bf16 v[232:235], v[164:167], v[24:27], v[232:235]
    ds_read_b128 v[160:163], v1 offset:45056
    v_mfma_f32_16x16x32_bf16 v[236:239], v[164:167], v[28:31], v[236:239]
    v_max_f32 v181, 0, v181
    s_waitcnt lgkmcnt(2)
    v_mfma_f32_16x16x32_bf16 v[208:211], v[168:171], v[32:35], v[208:211]
    ds_read_b128 v[164:167], v1 offset:46080
    v_mfma_f32_16x16x32_bf16 v[212:215], v[168:171], v[36:39], v[212:215]
    s_add_u32 m0, s20, 131072
    s_add_u32 s17, s21, 294912
    buffer_load_dwordx4 v1, s[8:11], s17 offen lds
    v_max_f32 v182, 0, v182
    s_waitcnt lgkmcnt(2)
    v_mfma_f32_16x16x32_bf16 v[216:219], v[172:175], v[32:35], v[216:219]
    ds_read_b128 v[168:171], v1 offset:47104
    v_mfma_f32_16x16x32_bf16 v[220:223], v[172:175], v[36:39], v[220:223]
    v_max_f32 v183, 0, v183
    s_waitcnt lgkmcnt(2)
    v_mfma_f32_16x16x32_bf16 v[224:227], v[160:163], v[32:35], v[224:227]
    ds_read_b128 v[172:175], v1 offset:48128
    v_mfma_f32_16x16x32_bf16 v[228:231], v[160:163], v[36:39], v[228:231]
    v_mul_f32 v180, v180, v188
    s_waitcnt lgkmcnt(2)
    v_mfma_f32_16x16x32_bf16 v[232:235], v[164:167], v[32:35], v[232:235]
    ds_read_b128 v[160:163], v1 offset:49152
    v_mfma_f32_16x16x32_bf16 v[236:239], v[164:167], v[36:39], v[236:239]
    v_mul_f32 v181, v181, v189
    s_waitcnt lgkmcnt(2)
    v_mfma_f32_16x16x32_bf16 v[208:211], v[168:171], v[40:43], v[208:211]
    ds_read_b128 v[164:167], v1 offset:50176
    v_mfma_f32_16x16x32_bf16 v[212:215], v[168:171], v[44:47], v[212:215]
    s_add_u32 m0, s20, 139264
    s_add_u32 s17, s21, 303104
    buffer_load_dwordx4 v1, s[8:11], s17 offen lds
    v_mul_f32 v182, v182, v190
    s_waitcnt lgkmcnt(2)
    v_mfma_f32_16x16x32_bf16 v[216:219], v[172:175], v[40:43], v[216:219]
    ds_read_b128 v[168:171], v1 offset:51200
    v_mfma_f32_16x16x32_bf16 v[220:223], v[172:175], v[44:47], v[220:223]
    v_mul_f32 v183, v183, v191
    s_waitcnt lgkmcnt(2)
    v_mfma_f32_16x16x32_bf16 v[224:227], v[160:163], v[40:43], v[224:227]
    ds_read_b128 v[172:175], v1 offset:52224
    v_mfma_f32_16x16x32_bf16 v[228:231], v[160:163], v[44:47], v[228:231]
    v_cvt_pk_bf16_f32 v188, v180, v181
    s_waitcnt lgkmcnt(2)
    v_mfma_f32_16x16x32_bf16 v[232:235], v[164:167], v[40:43], v[232:235]
    ds_read_b128 v[160:163], v1 offset:53248
    v_mfma_f32_16x16x32_bf16 v[236:239], v[164:167], v[44:47], v[236:239]
    v_cvt_pk_bf16_f32 v189, v182, v183
    s_waitcnt lgkmcnt(2)
    v_mfma_f32_16x16x32_bf16 v[208:211], v[168:171], v[48:51], v[208:211]
    ds_read_b128 v[164:167], v1 offset:54272
    v_mfma_f32_16x16x32_bf16 v[212:215], v[168:171], v[52:55], v[212:215]
    s_add_u32 m0, s20, 147456
    s_add_u32 s17, s21, 311296
    buffer_load_dwordx4 v1, s[8:11], s17 offen lds
    v_max_f32 v192, 0, v192
    s_waitcnt lgkmcnt(2)
    v_mfma_f32_16x16x32_bf16 v[216:219], v[172:175], v[48:51], v[216:219]
    ds_read_b128 v[168:171], v1 offset:55296
    v_mfma_f32_16x16x32_bf16 v[220:223], v[172:175], v[52:55], v[220:223]
    v_max_f32 v193, 0, v193
    s_waitcnt lgkmcnt(2)
    v_mfma_f32_16x16x32_bf16 v[224:227], v[160:163], v[48:51], v[224:227]
    ds_read_b128 v[172:175], v1 offset:56320
    v_mfma_f32_16x16x32_bf16 v[228:231], v[160:163], v[52:55], v[228:231]
    v_max_f32 v194, 0, v194
    s_waitcnt lgkmcnt(2)
    v_mfma_f32_16x16x32_bf16 v[232:235], v[164:167], v[48:51], v[232:235]
    ds_read_b128 v[160:163], v3 offset:0
    v_mfma_f32_16x16x32_bf16 v[236:239], v[164:167], v[52:55], v[236:239]
    v_max_f32 v195, 0, v195
    s_waitcnt lgkmcnt(2)
    v_mfma_f32_16x16x32_bf16 v[208:211], v[168:171], v[56:59], v[208:211]
    ds_read_b128 v[164:167], v3 offset:1024
    v_mfma_f32_16x16x32_bf16 v[212:215], v[168:171], v[60:63], v[212:215]
    s_add_u32 m0, s20, 155648
    s_add_u32 s17, s21, 319488
    buffer_load_dwordx4 v1, s[8:11], s17 offen lds
    v_mul_f32 v192, v192, v200
    s_waitcnt lgkmcnt(2)
    v_mfma_f32_16x16x32_bf16 v[216:219], v[172:175], v[56:59], v[216:219]
    ds_read_b128 v[168:171], v3 offset:2048
    v_mfma_f32_16x16x32_bf16 v[220:223], v[172:175], v[60:63], v[220:223]
    v_mul_f32 v193, v193, v201
    s_waitcnt lgkmcnt(2)
    v_mfma_f32_16x16x32_bf16 v[224:227], v[160:163], v[56:59], v[224:227]
    ds_read_b128 v[172:175], v3 offset:3072
    v_mfma_f32_16x16x32_bf16 v[228:231], v[160:163], v[60:63], v[228:231]
    v_mul_f32 v194, v194, v202
    s_waitcnt lgkmcnt(2)
    v_mfma_f32_16x16x32_bf16 v[232:235], v[164:167], v[56:59], v[232:235]
    ds_read_b128 v[160:163], v3 offset:4096
    v_mfma_f32_16x16x32_bf16 v[236:239], v[164:167], v[60:63], v[236:239]
    v_mul_f32 v195, v195, v203
    s_waitcnt lgkmcnt(2)
    v_mfma_f32_16x16x32_bf16 v[208:211], v[168:171], v[64:67], v[208:211]
    ds_read_b128 v[164:167], v3 offset:5120
    v_mfma_f32_16x16x32_bf16 v[212:215], v[168:171], v[68:71], v[212:215]
    v_cvt_pk_bf16_f32 v186, v192, v193
    s_waitcnt lgkmcnt(2)
    v_mfma_f32_16x16x32_bf16 v[216:219], v[172:175], v[64:67], v[216:219]
    ds_read_b128 v[168:171], v3 offset:6144
    v_mfma_f32_16x16x32_bf16 v[220:223], v[172:175], v[68:71], v[220:223]
    v_cvt_pk_bf16_f32 v187, v194, v195
    s_waitcnt lgkmcnt(2)
    v_mfma_f32_16x16x32_bf16 v[224:227], v[160:163], v[64:67], v[224:227]
    ds_read_b128 v[172:175], v3 offset:7168
    v_mfma_f32_16x16x32_bf16 v[228:231], v[160:163], v[68:71], v[228:231]
    buffer_store_dwordx4 v[184:187], v1, s[8:11], s36 offen offset:0 sc1
    s_waitcnt lgkmcnt(2)
    v_mfma_f32_16x16x32_bf16 v[232:235], v[164:167], v[64:67], v[232:235]
    ds_read_b128 v[160:163], v3 offset:8192
    v_mfma_f32_16x16x32_bf16 v[236:239], v[164:167], v[68:71], v[236:239]
    v_max_f32 v196, 0, v196
    s_waitcnt lgkmcnt(2)
    v_mfma_f32_16x16x32_bf16 v[208:211], v[168:171], v[72:75], v[208:211]
    ds_read_b128 v[164:167], v3 offset:9216
    v_mfma_f32_16x16x32_bf16 v[212:215], v[168:171], v[76:79], v[212:215]
    v_max_f32 v197, 0, v197
    s_waitcnt lgkmcnt(2)
    v_mfma_f32_16x16x32_bf16 v[216:219], v[172:175], v[72:75], v[216:219]
    ds_read_b128 v[168:171], v3 offset:10240
    v_mfma_f32_16x16x32_bf16 v[220:223], v[172:175], v[76:79], v[220:223]
    v_max_f32 v198, 0, v198
    s_waitcnt lgkmcnt(2)
    v_mfma_f32_16x16x32_bf16 v[224:227], v[160:163], v[72:75], v[224:227]
    ds_read_b128 v[172:175], v3 offset:11264
    v_mfma_f32_16x16x32_bf16 v[228:231], v[160:163], v[76:79], v[228:231]
    v_max_f32 v199, 0, v199
    s_waitcnt lgkmcnt(2)
    v_mfma_f32_16x16x32_bf16 v[232:235], v[164:167], v[72:75], v[232:235]
    ds_read_b128 v[160:163], v3 offset:12288
    v_mfma_f32_16x16x32_bf16 v[236:239], v[164:167], v[76:79], v[236:239]
    v_mul_f32 v196, v196, v204
    s_waitcnt lgkmcnt(2)
    v_mfma_f32_16x16x32_bf16 v[208:211], v[168:171], v[80:83], v[208:211]
    ds_read_b128 v[164:167], v3 offset:13312
    v_mfma_f32_16x16x32_bf16 v[212:215], v[168:171], v[84:87], v[212:215]
    v_mul_f32 v197, v197, v205
    s_waitcnt lgkmcnt(2)
    v_mfma_f32_16x16x32_bf16 v[216:219], v[172:175], v[80:83], v[216:219]
    ds_read_b128 v[168:171], v3 offset:14336
    v_mfma_f32_16x16x32_bf16 v[220:223], v[172:175], v[84:87], v[220:223]
    v_mul_f32 v198, v198, v206
    s_waitcnt lgkmcnt(2)
    v_mfma_f32_16x16x32_bf16 v[224:227], v[160:163], v[80:83], v[224:227]
    ds_read_b128 v[172:175], v3 offset:15360
    v_mfma_f32_16x16x32_bf16 v[228:231], v[160:163], v[84:87], v[228:231]
    v_mul_f32 v199, v199, v207
    s_waitcnt lgkmcnt(2)
    v_mfma_f32_16x16x32_bf16 v[232:235], v[164:167], v[80:83], v[232:235]
    ds_read_b128 v[160:163], v3 offset:16384
    v_mfma_f32_16x16x32_bf16 v[236:239], v[164:167], v[84:87], v[236:239]
    v_cvt_pk_bf16_f32 v190, v196, v197
    s_waitcnt lgkmcnt(2)
    v_mfma_f32_16x16x32_bf16 v[208:211], v[168:171], v[88:91], v[208:211]
    ds_read_b128 v[164:167], v3 offset:17408
    v_mfma_f32_16x16x32_bf16 v[212:215], v[168:171], v[92:95], v[212:215]
    v_cvt_pk_bf16_f32 v191, v198, v199
    s_waitcnt lgkmcnt(2)
    v_mfma_f32_16x16x32_bf16 v[216:219], v[172:175], v[88:91], v[216:219]
    ds_read_b128 v[168:171], v3 offset:18432
    v_mfma_f32_16x16x32_bf16 v[220:223], v[172:175], v[92:95], v[220:223]
    buffer_store_dwordx4 v[188:191], v1, s[8:11], s37 offen offset:0 sc1
    s_waitcnt lgkmcnt(2)
    v_mfma_f32_16x16x32_bf16 v[224:227], v[160:163], v[88:91], v[224:227]
    ds_read_b128 v[172:175], v3 offset:19456
    v_mfma_f32_16x16x32_bf16 v[228:231], v[160:163], v[92:95], v[228:231]
    v_max_f32 v240, 0, v240
    s_waitcnt lgkmcnt(2)
    v_mfma_f32_16x16x32_bf16 v[232:235], v[164:167], v[88:91], v[232:235]
    ds_read_b128 v[160:163], v3 offset:20480
    v_mfma_f32_16x16x32_bf16 v[236:239], v[164:167], v[92:95], v[236:239]
    v_max_f32 v241, 0, v241
    s_waitcnt lgkmcnt(2)
    v_mfma_f32_16x16x32_bf16 v[208:211], v[168:171], v[96:99], v[208:211]
    ds_read_b128 v[164:167], v3 offset:21504
    v_mfma_f32_16x16x32_bf16 v[212:215], v[168:171], v[100:103], v[212:215]
    v_max_f32 v242, 0, v242
    s_waitcnt lgkmcnt(2)
    v_mfma_f32_16x16x32_bf16 v[216:219], v[172:175], v[96:99], v[216:219]
    ds_read_b128 v[168:171], v3 offset:22528
    v_mfma_f32_16x16x32_bf16 v[220:223], v[172:175], v[100:103], v[220:223]
    v_max_f32 v243, 0, v243
    s_waitcnt lgkmcnt(2)
    v_mfma_f32_16x16x32_bf16 v[224:227], v[160:163], v[96:99], v[224:227]
    ds_read_b128 v[172:175], v3 offset:23552
    v_mfma_f32_16x16x32_bf16 v[228:231], v[160:163], v[100:103], v[228:231]
    v_mul_f32 v240, v240, v248
    s_waitcnt lgkmcnt(2)
    v_mfma_f32_16x16x32_bf16 v[232:235], v[164:167], v[96:99], v[232:235]
    s_waitcnt vmcnt(9)
    s_barrier
    ds_read_b128 v[160:163], v3 offset:24576
    v_mfma_f32_16x16x32_bf16 v[236:239], v[164:167], v[100:103], v[236:239]
    v_mul_f32 v241, v241, v249
    s_waitcnt lgkmcnt(2)
    v_mfma_f32_16x16x32_bf16 v[208:211], v[168:171], v[104:107], v[208:211]
    ds_read_b128 v[164:167], v3 offset:25600
    v_mfma_f32_16x16x32_bf16 v[212:215], v[168:171], v[108:111], v[212:215]
    s_add_u32 m0, s20, 0
    s_add_u32 s17, s21, 327680
    buffer_load_dwordx4 v1, s[8:11], s17 offen lds
    v_mul_f32 v242, v242, v250
    s_waitcnt lgkmcnt(2)
    v_mfma_f32_16x16x32_bf16 v[216:219], v[172:175], v[104:107], v[216:219]
    ds_read_b128 v[168:171], v3 offset:26624
    v_mfma_f32_16x16x32_bf16 v[220:223], v[172:175], v[108:111], v[220:223]
    v_mul_f32 v243, v243, v251
    s_waitcnt lgkmcnt(2)
    v_mfma_f32_16x16x32_bf16 v[224:227], v[160:163], v[104:107], v[224:227]
    ds_read_b128 v[172:175], v3 offset:27648
    v_mfma_f32_16x16x32_bf16 v[228:231], v[160:163], v[108:111], v[228:231]
    v_cvt_pk_bf16_f32 v248, v240, v241
    s_waitcnt lgkmcnt(2)
    v_mfma_f32_16x16x32_bf16 v[232:235], v[164:167], v[104:107], v[232:235]
    ds_read_b128 v[160:163], v3 offset:28672
    v_mfma_f32_16x16x32_bf16 v[236:239], v[164:167], v[108:111], v[236:239]
    v_cvt_pk_bf16_f32 v249, v242, v243
    s_waitcnt lgkmcnt(2)
    v_mfma_f32_16x16x32_bf16 v[208:211], v[168:171], v[112:115], v[208:211]
    ds_read_b128 v[164:167], v3 offset:29696
    v_mfma_f32_16x16x32_bf16 v[212:215], v[168:171], v[116:119], v[212:215]
    s_add_u32 m0, s20, 8192
    s_add_u32 s17, s21, 335872
    buffer_load_dwordx4 v1, s[8:11], s17 offen lds
    buffer_store_dwordx2 v[248:249], v5, s[8:11], s40 offen sc1
    s_waitcnt lgkmcnt(2)
    v_mfma_f32_16x16x32_bf16 v[216:219], v[172:175], v[112:115], v[216:219]
    ds_read_b128 v[168:171], v3 offset:30720
    v_mfma_f32_16x16x32_bf16 v[220:223], v[172:175], v[116:119], v[220:223]
    v_max_f32 v244, 0, v244
    s_waitcnt lgkmcnt(2)
    v_mfma_f32_16x16x32_bf16 v[224:227], v[160:163], v[112:115], v[224:227]
    ds_read_b128 v[172:175], v3 offset:31744
    v_mfma_f32_16x16x32_bf16 v[228:231], v[160:163], v[116:119], v[228:231]
    v_max_f32 v245, 0, v245
    s_waitcnt lgkmcnt(2)
    v_mfma_f32_16x16x32_bf16 v[232:235], v[164:167], v[112:115], v[232:235]
    ds_read_b128 v[160:163], v3 offset:32768
    v_mfma_f32_16x16x32_bf16 v[236:239], v[164:167], v[116:119], v[236:239]
    v_max_f32 v246, 0, v246
    s_waitcnt lgkmcnt(2)
    v_mfma_f32_16x16x32_bf16 v[208:211], v[168:171], v[120:123], v[208:211]
    ds_read_b128 v[164:167], v3 offset:33792
    v_mfma_f32_16x16x32_bf16 v[212:215], v[168:171], v[124:127], v[212:215]
    s_add_u32 m0, s20, 16384
    s_add_u32 s17, s21, 344064
    buffer_load_dwordx4 v1, s[8:11], s17 offen lds
    v_max_f32 v247, 0, v247
    s_waitcnt lgkmcnt(2)
    v_mfma_f32_16x16x32_bf16 v[216:219], v[172:175], v[120:123], v[216:219]
    ds_read_b128 v[168:171], v3 offset:34816
    v_mfma_f32_16x16x32_bf16 v[220:223], v[172:175], v[124:127], v[220:223]
    v_mul_f32 v244, v244, v252
    s_waitcnt lgkmcnt(2)
    v_mfma_f32_16x16x32_bf16 v[224:227], v[160:163], v[120:123], v[224:227]
    ds_read_b128 v[172:175], v3 offset:35840
    v_mfma_f32_16x16x32_bf16 v[228:231], v[160:163], v[124:127], v[228:231]
    v_mul_f32 v245, v245, v253
    s_waitcnt lgkmcnt(2)
    v_mfma_f32_16x16x32_bf16 v[232:235], v[164:167], v[120:123], v[232:235]
    ds_read_b128 v[160:163], v3 offset:36864
    v_mfma_f32_16x16x32_bf16 v[236:239], v[164:167], v[124:127], v[236:239]
    v_mul_f32 v246, v246, v254
    s_waitcnt lgkmcnt(2)
    v_mfma_f32_16x16x32_bf16 v[208:211], v[168:171], v[128:131], v[208:211]
    ds_read_b128 v[164:167], v3 offset:37888
    v_mfma_f32_16x16x32_bf16 v[212:215], v[168:171], v[132:135], v[212:215]
    v_mul_f32 v247, v247, v255
    s_waitcnt lgkmcnt(2)
    v_mfma_f32_16x16x32_bf16 v[216:219], v[172:175], v[128:131], v[216:219]
    ds_read_b128 v[168:171], v3 offset:38912
    v_mfma_f32_16x16x32_bf16 v[220:223], v[172:175], v[132:135], v[220:223]
    v_cvt_pk_bf16_f32 v252, v244, v245
    s_waitcnt lgkmcnt(2)
    v_mfma_f32_16x16x32_bf16 v[224:227], v[160:163], v[128:131], v[224:227]
    ds_read_b128 v[172:175], v3 offset:39936
    v_mfma_f32_16x16x32_bf16 v[228:231], v[160:163], v[132:135], v[228:231]
    v_cvt_pk_bf16_f32 v253, v246, v247
    s_waitcnt lgkmcnt(2)
    v_mfma_f32_16x16x32_bf16 v[232:235], v[164:167], v[128:131], v[232:235]
    ds_read_b128 v[160:163], v3 offset:40960
    v_mfma_f32_16x16x32_bf16 v[236:239], v[164:167], v[132:135], v[236:239]
    buffer_store_dwordx2 v[252:253], v5, s[8:11], s41 offen sc1
    s_waitcnt lgkmcnt(2)
    v_mfma_f32_16x16x32_bf16 v[208:211], v[168:171], v[136:139], v[208:211]
    ds_read_b128 v[164:167], v3 offset:41984
    v_mfma_f32_16x16x32_bf16 v[212:215], v[168:171], v[140:143], v[212:215]
    s_waitcnt lgkmcnt(2)
    v_mfma_f32_16x16x32_bf16 v[216:219], v[172:175], v[136:139], v[216:219]
    ds_read_b128 v[168:171], v3 offset:43008
    v_mfma_f32_16x16x32_bf16 v[220:223], v[172:175], v[140:143], v[220:223]
    s_waitcnt lgkmcnt(2)
    v_mfma_f32_16x16x32_bf16 v[224:227], v[160:163], v[136:139], v[224:227]
    ds_read_b128 v[172:175], v3 offset:44032
    v_mfma_f32_16x16x32_bf16 v[228:231], v[160:163], v[140:143], v[228:231]
    s_waitcnt lgkmcnt(2)
    v_mfma_f32_16x16x32_bf16 v[232:235], v[164:167], v[136:139], v[232:235]
    ds_read_b128 v[160:163], v3 offset:45056
    v_mfma_f32_16x16x32_bf16 v[236:239], v[164:167], v[140:143], v[236:239]
    s_waitcnt lgkmcnt(2)
    v_mfma_f32_16x16x32_bf16 v[208:211], v[168:171], v[144:147], v[208:211]
    ds_read_b128 v[164:167], v3 offset:46080
    v_mfma_f32_16x16x32_bf16 v[212:215], v[168:171], v[148:151], v[212:215]
    s_waitcnt lgkmcnt(2)
    v_mfma_f32_16x16x32_bf16 v[216:219], v[172:175], v[144:147], v[216:219]
    ds_read_b128 v[168:171], v3 offset:47104
    v_mfma_f32_16x16x32_bf16 v[220:223], v[172:175], v[148:151], v[220:223]
    s_waitcnt lgkmcnt(2)
    v_mfma_f32_16x16x32_bf16 v[224:227], v[160:163], v[144:147], v[224:227]
    ds_read_b128 v[172:175], v3 offset:48128
    v_mfma_f32_16x16x32_bf16 v[228:231], v[160:163], v[148:151], v[228:231]
    s_waitcnt lgkmcnt(2)
    v_mfma_f32_16x16x32_bf16 v[232:235], v[164:167], v[144:147], v[232:235]
    ds_read_b128 v[160:163], v3 offset:49152
    v_mfma_f32_16x16x32_bf16 v[236:239], v[164:167], v[148:151], v[236:239]
    s_waitcnt lgkmcnt(2)
    v_mfma_f32_16x16x32_bf16 v[208:211], v[168:171], v[152:155], v[208:211]
    ds_read_b128 v[164:167], v3 offset:50176
    v_mfma_f32_16x16x32_bf16 v[212:215], v[168:171], v[156:159], v[212:215]
    s_waitcnt lgkmcnt(2)
    v_mfma_f32_16x16x32_bf16 v[216:219], v[172:175], v[152:155], v[216:219]
    ds_read_b128 v[168:171], v3 offset:51200
    v_mfma_f32_16x16x32_bf16 v[220:223], v[172:175], v[156:159], v[220:223]
    s_waitcnt lgkmcnt(2)
    v_mfma_f32_16x16x32_bf16 v[224:227], v[160:163], v[152:155], v[224:227]
    ds_read_b128 v[172:175], v3 offset:52224
    v_mfma_f32_16x16x32_bf16 v[228:231], v[160:163], v[156:159], v[228:231]
    s_waitcnt lgkmcnt(2)
    v_mfma_f32_16x16x32_bf16 v[232:235], v[164:167], v[152:155], v[232:235]
    ds_read_b128 v[160:163], v3 offset:53248
    v_mfma_f32_16x16x32_bf16 v[236:239], v[164:167], v[156:159], v[236:239]
    s_waitcnt lgkmcnt(2)
    v_mfma_f32_16x16x32_bf16 v[176:179], v[168:171], v[8:11], 0
    ds_read_b128 v[164:167], v3 offset:54272
    v_mfma_f32_16x16x32_bf16 v[180:183], v[168:171], v[12:15], 0
    v_max_f32 v208, 0, v208
    v_max_f32 v209, 0, v209
    s_waitcnt lgkmcnt(2)
    v_mfma_f32_16x16x32_bf16 v[184:187], v[172:175], v[8:11], 0
    ds_read_b128 v[168:171], v3 offset:55296
    v_mfma_f32_16x16x32_bf16 v[188:191], v[172:175], v[12:15], 0
    v_max_f32 v210, 0, v210
    v_max_f32 v211, 0, v211
    s_waitcnt lgkmcnt(2)
    v_mfma_f32_16x16x32_bf16 v[192:195], v[160:163], v[8:11], 0
    ds_read_b128 v[172:175], v3 offset:56320
    v_mfma_f32_16x16x32_bf16 v[196:199], v[160:163], v[12:15], 0
    v_mul_f32 v208, v208, v216
    v_mul_f32 v209, v209, v217
    s_waitcnt lgkmcnt(2)
    v_mfma_f32_16x16x32_bf16 v[200:203], v[164:167], v[8:11], 0
    ds_read_b128 v[160:163], v4 offset:0
    v_mfma_f32_16x16x32_bf16 v[204:207], v[164:167], v[12:15], 0
    v_mul_f32 v210, v210, v218
    v_mul_f32 v211, v211, v219
    s_waitcnt lgkmcnt(2)
    v_mfma_f32_16x16x32_bf16 v[176:179], v[168:171], v[16:19], v[176:179]
    ds_read_b128 v[164:167], v4 offset:1024
    v_mfma_f32_16x16x32_bf16 v[180:183], v[168:171], v[20:23], v[180:183]
    v_cvt_pk_bf16_f32 v216, v208, v209
    v_cvt_pk_bf16_f32 v217, v210, v211
    s_waitcnt lgkmcnt(2)
    v_mfma_f32_16x16x32_bf16 v[184:187], v[172:175], v[16:19], v[184:187]
    ds_read_b128 v[168:171], v4 offset:2048
    v_mfma_f32_16x16x32_bf16 v[188:191], v[172:175], v[20:23], v[188:191]
    v_max_f32 v212, 0, v212
    v_max_f32 v213, 0, v213
    s_waitcnt lgkmcnt(2)
    v_mfma_f32_16x16x32_bf16 v[192:195], v[160:163], v[16:19], v[192:195]
    ds_read_b128 v[172:175], v4 offset:3072
    v_mfma_f32_16x16x32_bf16 v[196:199], v[160:163], v[20:23], v[196:199]
    v_max_f32 v214, 0, v214
    v_max_f32 v215, 0, v215
    s_waitcnt lgkmcnt(2)
    v_mfma_f32_16x16x32_bf16 v[200:203], v[164:167], v[16:19], v[200:203]
    ds_read_b128 v[160:163], v4 offset:4096
    v_mfma_f32_16x16x32_bf16 v[204:207], v[164:167], v[20:23], v[204:207]
    v_mul_f32 v212, v212, v220
    v_mul_f32 v213, v213, v221
    s_waitcnt lgkmcnt(2)
    v_mfma_f32_16x16x32_bf16 v[176:179], v[168:171], v[24:27], v[176:179]
    ds_read_b128 v[164:167], v4 offset:5120
    v_mfma_f32_16x16x32_bf16 v[180:183], v[168:171], v[28:31], v[180:183]
    v_mul_f32 v214, v214, v222
    v_mul_f32 v215, v215, v223
    s_waitcnt lgkmcnt(2)
    v_mfma_f32_16x16x32_bf16 v[184:187], v[172:175], v[24:27], v[184:187]
    ds_read_b128 v[168:171], v4 offset:6144
    v_mfma_f32_16x16x32_bf16 v[188:191], v[172:175], v[28:31], v[188:191]
    v_cvt_pk_bf16_f32 v220, v212, v213
    v_cvt_pk_bf16_f32 v221, v214, v215
    s_waitcnt lgkmcnt(2)
    v_mfma_f32_16x16x32_bf16 v[192:195], v[160:163], v[24:27], v[192:195]
    ds_read_b128 v[172:175], v4 offset:7168
    v_mfma_f32_16x16x32_bf16 v[196:199], v[160:163], v[28:31], v[196:199]
    v_max_f32 v224, 0, v224
    v_max_f32 v225, 0, v225
    s_waitcnt lgkmcnt(2)
    v_mfma_f32_16x16x32_bf16 v[200:203], v[164:167], v[24:27], v[200:203]
    s_waitcnt vmcnt(7)
    s_barrier
    ds_read_b128 v[160:163], v4 offset:8192
    v_mfma_f32_16x16x32_bf16 v[204:207], v[164:167], v[28:31], v[204:207]
    v_max_f32 v226, 0, v226
    v_max_f32 v227, 0, v227
    s_waitcnt lgkmcnt(2)
    v_mfma_f32_16x16x32_bf16 v[176:179], v[168:171], v[32:35], v[176:179]
    ds_read_b128 v[164:167], v4 offset:9216
    v_mfma_f32_16x16x32_bf16 v[180:183], v[168:171], v[36:39], v[180:183]
    s_add_u32 m0, s20, 40960
    s_add_u32 s17, s64, 0
    buffer_load_dwordx4 v1, s[8:11], s17 offen lds
    v_mul_f32 v224, v224, v232
    v_mul_f32 v225, v225, v233
    s_waitcnt lgkmcnt(2)
    v_mfma_f32_16x16x32_bf16 v[184:187], v[172:175], v[32:35], v[184:187]
    ds_read_b128 v[168:171], v4 offset:10240
    v_mfma_f32_16x16x32_bf16 v[188:191], v[172:175], v[36:39], v[188:191]
    v_mul_f32 v226, v226, v234
    v_mul_f32 v227, v227, v235
    s_waitcnt lgkmcnt(2)
    v_mfma_f32_16x16x32_bf16 v[192:195], v[160:163], v[32:35], v[192:195]
    ds_read_b128 v[172:175], v4 offset:11264
    v_mfma_f32_16x16x32_bf16 v[196:199], v[160:163], v[36:39], v[196:199]
    v_cvt_pk_bf16_f32 v218, v224, v225
    v_cvt_pk_bf16_f32 v219, v226, v227
    s_waitcnt lgkmcnt(2)
    v_mfma_f32_16x16x32_bf16 v[200:203], v[164:167], v[32:35], v[200:203]
    ds_read_b128 v[160:163], v4 offset:12288
    v_mfma_f32_16x16x32_bf16 v[204:207], v[164:167], v[36:39], v[204:207]
    buffer_store_dwordx4 v[216:219], v1, s[8:11], s36 offen offset:2048 sc1
    v_max_f32 v228, 0, v228
    s_waitcnt lgkmcnt(2)
    v_mfma_f32_16x16x32_bf16 v[176:179], v[168:171], v[40:43], v[176:179]
    ds_read_b128 v[164:167], v4 offset:13312
    v_mfma_f32_16x16x32_bf16 v[180:183], v[168:171], v[44:47], v[180:183]
    s_add_u32 m0, s20, 49152
    s_add_u32 s17, s64, 8192
    buffer_load_dwordx4 v1, s[8:11], s17 offen lds
    v_max_f32 v229, 0, v229
    v_max_f32 v230, 0, v230
    s_waitcnt lgkmcnt(2)
    v_mfma_f32_16x16x32_bf16 v[184:187], v[172:175], v[40:43], v[184:187]
    ds_read_b128 v[168:171], v4 offset:14336
    v_mfma_f32_16x16x32_bf16 v[188:191], v[172:175], v[44:47], v[188:191]
    v_max_f32 v231, 0, v231
    v_mul_f32 v228, v228, v236
    s_waitcnt lgkmcnt(2)
    v_mfma_f32_16x16x32_bf16 v[192:195], v[160:163], v[40:43], v[192:195]
    ds_read_b128 v[172:175], v4 offset:15360
    v_mfma_f32_16x16x32_bf16 v[196:199], v[160:163], v[44:47], v[196:199]
    v_mul_f32 v229, v229, v237
    v_mul_f32 v230, v230, v238
    s_waitcnt lgkmcnt(2)
    v_mfma_f32_16x16x32_bf16 v[200:203], v[164:167], v[40:43], v[200:203]
    ds_read_b128 v[160:163], v4 offset:16384
    v_mfma_f32_16x16x32_bf16 v[204:207], v[164:167], v[44:47], v[204:207]
    v_mul_f32 v231, v231, v239
    v_cvt_pk_bf16_f32 v222, v228, v229
    s_waitcnt lgkmcnt(2)
    v_mfma_f32_16x16x32_bf16 v[176:179], v[168:171], v[48:51], v[176:179]
    ds_read_b128 v[164:167], v4 offset:17408
    v_mfma_f32_16x16x32_bf16 v[180:183], v[168:171], v[52:55], v[180:183]
    s_add_u32 m0, s20, 57344
    s_add_u32 s17, s64, 16384
    buffer_load_dwordx4 v1, s[8:11], s17 offen lds
    v_cvt_pk_bf16_f32 v223, v230, v231
    buffer_store_dwordx4 v[220:223], v1, s[8:11], s37 offen offset:2048 sc1
    s_waitcnt lgkmcnt(2)
    v_mfma_f32_16x16x32_bf16 v[184:187], v[172:175], v[48:51], v[184:187]
    ds_read_b128 v[168:171], v4 offset:18432
    v_mfma_f32_16x16x32_bf16 v[188:191], v[172:175], v[52:55], v[188:191]
    s_waitcnt lgkmcnt(2)
    v_mfma_f32_16x16x32_bf16 v[192:195], v[160:163], v[48:51], v[192:195]
    ds_read_b128 v[172:175], v4 offset:19456
    v_mfma_f32_16x16x32_bf16 v[196:199], v[160:163], v[52:55], v[196:199]
    s_waitcnt lgkmcnt(2)
    v_mfma_f32_16x16x32_bf16 v[200:203], v[164:167], v[48:51], v[200:203]
    ds_read_b128 v[160:163], v4 offset:20480
    v_mfma_f32_16x16x32_bf16 v[204:207], v[164:167], v[52:55], v[204:207]
    s_waitcnt lgkmcnt(2)
    v_mfma_f32_16x16x32_bf16 v[176:179], v[168:171], v[56:59], v[176:179]
    ds_read_b128 v[164:167], v4 offset:21504
    v_mfma_f32_16x16x32_bf16 v[180:183], v[168:171], v[60:63], v[180:183]
    s_add_u32 m0, s20, 65536
    s_add_u32 s17, s64, 24576
    buffer_load_dwordx4 v1, s[8:11], s17 offen lds
    s_waitcnt lgkmcnt(2)
    v_mfma_f32_16x16x32_bf16 v[184:187], v[172:175], v[56:59], v[184:187]
    ds_read_b128 v[168:171], v4 offset:22528
    v_mfma_f32_16x16x32_bf16 v[188:191], v[172:175], v[60:63], v[188:191]
    s_waitcnt lgkmcnt(2)
    v_mfma_f32_16x16x32_bf16 v[192:195], v[160:163], v[56:59], v[192:195]
    ds_read_b128 v[172:175], v4 offset:23552
    v_mfma_f32_16x16x32_bf16 v[196:199], v[160:163], v[60:63], v[196:199]
    s_waitcnt lgkmcnt(2)
    v_mfma_f32_16x16x32_bf16 v[200:203], v[164:167], v[56:59], v[200:203]
    ds_read_b128 v[160:163], v4 offset:24576
    v_mfma_f32_16x16x32_bf16 v[204:207], v[164:167], v[60:63], v[204:207]
    s_waitcnt lgkmcnt(2)
    v_mfma_f32_16x16x32_bf16 v[176:179], v[168:171], v[64:67], v[176:179]
    ds_read_b128 v[164:167], v4 offset:25600
    v_mfma_f32_16x16x32_bf16 v[180:183], v[168:171], v[68:71], v[180:183]
    s_add_u32 m0, s65, 73728
    s_add_u32 s17, s66, 32768
    buffer_load_dwordx4 v1, s[8:11], s17 offen lds
    s_waitcnt lgkmcnt(2)
    v_mfma_f32_16x16x32_bf16 v[184:187], v[172:175], v[64:67], v[184:187]
    ds_read_b128 v[168:171], v4 offset:26624
    v_mfma_f32_16x16x32_bf16 v[188:191], v[172:175], v[68:71], v[188:191]
    s_waitcnt lgkmcnt(2)
    v_mfma_f32_16x16x32_bf16 v[192:195], v[160:163], v[64:67], v[192:195]
    ds_read_b128 v[172:175], v4 offset:27648
    v_mfma_f32_16x16x32_bf16 v[196:199], v[160:163], v[68:71], v[196:199]
    s_waitcnt lgkmcnt(2)
    v_mfma_f32_16x16x32_bf16 v[200:203], v[164:167], v[64:67], v[200:203]
    ds_read_b128 v[160:163], v4 offset:28672
    v_mfma_f32_16x16x32_bf16 v[204:207], v[164:167], v[68:71], v[204:207]
    s_waitcnt lgkmcnt(2)
    v_mfma_f32_16x16x32_bf16 v[176:179], v[168:171], v[72:75], v[176:179]
    ds_read_b128 v[164:167], v4 offset:29696
    v_mfma_f32_16x16x32_bf16 v[180:183], v[168:171], v[76:79], v[180:183]
    s_waitcnt lgkmcnt(2)
    v_mfma_f32_16x16x32_bf16 v[184:187], v[172:175], v[72:75], v[184:187]
    ds_read_b128 v[168:171], v4 offset:30720
    v_mfma_f32_16x16x32_bf16 v[188:191], v[172:175], v[76:79], v[188:191]
    s_waitcnt lgkmcnt(2)
    v_mfma_f32_16x16x32_bf16 v[192:195], v[160:163], v[72:75], v[192:195]
    ds_read_b128 v[172:175], v4 offset:31744
    v_mfma_f32_16x16x32_bf16 v[196:199], v[160:163], v[76:79], v[196:199]
    s_waitcnt lgkmcnt(2)
    v_mfma_f32_16x16x32_bf16 v[200:203], v[164:167], v[72:75], v[200:203]
    ds_read_b128 v[160:163], v4 offset:32768
    v_mfma_f32_16x16x32_bf16 v[204:207], v[164:167], v[76:79], v[204:207]
    s_waitcnt lgkmcnt(2)
    v_mfma_f32_16x16x32_bf16 v[176:179], v[168:171], v[80:83], v[176:179]
    ds_read_b128 v[164:167], v4 offset:33792
    v_mfma_f32_16x16x32_bf16 v[180:183], v[168:171], v[84:87], v[180:183]
    s_waitcnt lgkmcnt(2)
    v_mfma_f32_16x16x32_bf16 v[184:187], v[172:175], v[80:83], v[184:187]
    ds_read_b128 v[168:171], v4 offset:34816
    v_mfma_f32_16x16x32_bf16 v[188:191], v[172:175], v[84:87], v[188:191]
    s_waitcnt lgkmcnt(2)
    v_mfma_f32_16x16x32_bf16 v[192:195], v[160:163], v[80:83], v[192:195]
    ds_read_b128 v[172:175], v4 offset:35840
    v_mfma_f32_16x16x32_bf16 v[196:199], v[160:163], v[84:87], v[196:199]
    s_waitcnt lgkmcnt(2)
    v_mfma_f32_16x16x32_bf16 v[200:203], v[164:167], v[80:83], v[200:203]
    ds_read_b128 v[160:163], v4 offset:36864
    v_mfma_f32_16x16x32_bf16 v[204:207], v[164:167], v[84:87], v[204:207]
    s_waitcnt lgkmcnt(2)
    v_mfma_f32_16x16x32_bf16 v[176:179], v[168:171], v[88:91], v[176:179]
    ds_read_b128 v[164:167], v4 offset:37888
    v_mfma_f32_16x16x32_bf16 v[180:183], v[168:171], v[92:95], v[180:183]
    s_waitcnt lgkmcnt(2)
    v_mfma_f32_16x16x32_bf16 v[184:187], v[172:175], v[88:91], v[184:187]
    ds_read_b128 v[168:171], v4 offset:38912
    v_mfma_f32_16x16x32_bf16 v[188:191], v[172:175], v[92:95], v[188:191]
    s_waitcnt lgkmcnt(2)
    v_mfma_f32_16x16x32_bf16 v[192:195], v[160:163], v[88:91], v[192:195]
    ds_read_b128 v[172:175], v4 offset:39936
    v_mfma_f32_16x16x32_bf16 v[196:199], v[160:163], v[92:95], v[196:199]
    s_waitcnt lgkmcnt(2)
    v_mfma_f32_16x16x32_bf16 v[200:203], v[164:167], v[88:91], v[200:203]
    ds_read_b128 v[160:163], v4 offset:40960
    v_mfma_f32_16x16x32_bf16 v[204:207], v[164:167], v[92:95], v[204:207]
    s_waitcnt lgkmcnt(2)
    v_mfma_f32_16x16x32_bf16 v[176:179], v[168:171], v[96:99], v[176:179]
    ds_read_b128 v[164:167], v4 offset:41984
    v_mfma_f32_16x16x32_bf16 v[180:183], v[168:171], v[100:103], v[180:183]
    s_waitcnt lgkmcnt(2)
    v_mfma_f32_16x16x32_bf16 v[184:187], v[172:175], v[96:99], v[184:187]
    ds_read_b128 v[168:171], v4 offset:43008
    v_mfma_f32_16x16x32_bf16 v[188:191], v[172:175], v[100:103], v[188:191]
    s_waitcnt lgkmcnt(2)
    v_mfma_f32_16x16x32_bf16 v[192:195], v[160:163], v[96:99], v[192:195]
    ds_read_b128 v[172:175], v4 offset:44032
    v_mfma_f32_16x16x32_bf16 v[196:199], v[160:163], v[100:103], v[196:199]
    s_waitcnt lgkmcnt(2)
    v_mfma_f32_16x16x32_bf16 v[200:203], v[164:167], v[96:99], v[200:203]
    ds_read_b128 v[160:163], v4 offset:45056
    v_mfma_f32_16x16x32_bf16 v[204:207], v[164:167], v[100:103], v[204:207]
    s_waitcnt lgkmcnt(2)
    v_mfma_f32_16x16x32_bf16 v[176:179], v[168:171], v[104:107], v[176:179]
    ds_read_b128 v[164:167], v4 offset:46080
    v_mfma_f32_16x16x32_bf16 v[180:183], v[168:171], v[108:111], v[180:183]
    s_waitcnt lgkmcnt(2)
    v_mfma_f32_16x16x32_bf16 v[184:187], v[172:175], v[104:107], v[184:187]
    ds_read_b128 v[168:171], v4 offset:47104
    v_mfma_f32_16x16x32_bf16 v[188:191], v[172:175], v[108:111], v[188:191]
    s_waitcnt lgkmcnt(2)
    v_mfma_f32_16x16x32_bf16 v[192:195], v[160:163], v[104:107], v[192:195]
    ds_read_b128 v[172:175], v4 offset:48128
    v_mfma_f32_16x16x32_bf16 v[196:199], v[160:163], v[108:111], v[196:199]
    s_waitcnt lgkmcnt(2)
    v_mfma_f32_16x16x32_bf16 v[200:203], v[164:167], v[104:107], v[200:203]
    s_waitcnt vmcnt(8)
    s_waitcnt vmcnt(2)
    s_barrier
    s_cmp_lg_u32 s12, 0
    s_cbranch_scc1 K5_SIGA
    v_mov_b32 v2, 0
    v_mov_b32 v240, 1
    s_mov_b64 exec, 1
    buffer_store_dword v240, v2, s[8:11], s67 offen sc1
    s_mov_b64 exec, -1
K5_SIGA:
    ds_read_b128 v[160:163], v1 offset:0
    v_mfma_f32_16x16x32_bf16 v[204:207], v[164:167], v[108:111], v[204:207]
    s_waitcnt lgkmcnt(2)
    v_mfma_f32_16x16x32_bf16 v[176:179], v[168:171], v[112:115], v[176:179]
    ds_read_b128 v[164:167], v1 offset:1024
    v_mfma_f32_16x16x32_bf16 v[180:183], v[168:171], v[116:119], v[180:183]
    s_add_u32 m0, s20, 77824
    s_add_u32 s17, s64, 36864
    buffer_load_dwordx4 v1, s[8:11], s17 offen lds
    s_waitcnt lgkmcnt(2)
    v_mfma_f32_16x16x32_bf16 v[184:187], v[172:175], v[112:115], v[184:187]
    ds_read_b128 v[168:171], v1 offset:2048
    v_mfma_f32_16x16x32_bf16 v[188:191], v[172:175], v[116:119], v[188:191]
    s_waitcnt lgkmcnt(2)
    v_mfma_f32_16x16x32_bf16 v[192:195], v[160:163], v[112:115], v[192:195]
    ds_read_b128 v[172:175], v1 offset:3072
    v_mfma_f32_16x16x32_bf16 v[196:199], v[160:163], v[116:119], v[196:199]
    s_add_u32 m0, s20, 86016
    s_add_u32 s17, s64, 45056
    buffer_load_dwordx4 v1, s[8:11], s17 offen lds
    s_waitcnt lgkmcnt(2)
    v_mfma_f32_16x16x32_bf16 v[200:203], v[164:167], v[112:115], v[200:203]
    ds_read_b128 v[160:163], v1 offset:4096
    v_mfma_f32_16x16x32_bf16 v[204:207], v[164:167], v[116:119], v[204:207]
    s_add_u32 m0, s20, 94208
    s_add_u32 s17, s64, 53248
    buffer_load_dwordx4 v1, s[8:11], s17 offen lds
    s_waitcnt lgkmcnt(2)
    v_mfma_f32_16x16x32_bf16 v[176:179], v[168:171], v[120:123], v[176:179]
    ds_read_b128 v[164:167], v1 offset:5120
    v_mfma_f32_16x16x32_bf16 v[180:183], v[168:171], v[124:127], v[180:183]
    s_add_u32 m0, s20, 102400
    s_add_u32 s17, s64, 61440
    buffer_load_dwordx4 v1, s[8:11], s17 offen lds
    s_waitcnt lgkmcnt(2)
    v_mfma_f32_16x16x32_bf16 v[184:187], v[172:175], v[120:123], v[184:187]
    ds_read_b128 v[168:171], v1 offset:6144
    v_mfma_f32_16x16x32_bf16 v[188:191], v[172:175], v[124:127], v[188:191]
    s_add_u32 m0, s65, 110592
    s_add_u32 s17, s66, 69632
    buffer_load_dwordx4 v1, s[8:11], s17 offen lds
    s_waitcnt lgkmcnt(2)
    v_mfma_f32_16x16x32_bf16 v[192:195], v[160:163], v[120:123], v[192:195]
    ds_read_b128 v[172:175], v1 offset:7168
    v_mfma_f32_16x16x32_bf16 v[196:199], v[160:163], v[124:127], v[196:199]
    s_waitcnt lgkmcnt(2)
    v_mfma_f32_16x16x32_bf16 v[200:203], v[164:167], v[120:123], v[200:203]
    ds_read_b128 v[160:163], v1 offset:8192
    v_mfma_f32_16x16x32_bf16 v[204:207], v[164:167], v[124:127], v[204:207]
    s_waitcnt lgkmcnt(2)
    v_mfma_f32_16x16x32_bf16 v[176:179], v[168:171], v[128:131], v[176:179]
    ds_read_b128 v[164:167], v1 offset:9216
    v_mfma_f32_16x16x32_bf16 v[180:183], v[168:171], v[132:135], v[180:183]
    s_waitcnt lgkmcnt(2)
    v_mfma_f32_16x16x32_bf16 v[184:187], v[172:175], v[128:131], v[184:187]
    ds_read_b128 v[168:171], v1 offset:10240
    v_mfma_f32_16x16x32_bf16 v[188:191], v[172:175], v[132:135], v[188:191]
    s_waitcnt lgkmcnt(2)
    v_mfma_f32_16x16x32_bf16 v[192:195], v[160:163], v[128:131], v[192:195]
    ds_read_b128 v[172:175], v1 offset:11264
    v_mfma_f32_16x16x32_bf16 v[196:199], v[160:163], v[132:135], v[196:199]
    s_waitcnt lgkmcnt(2)
    v_mfma_f32_16x16x32_bf16 v[200:203], v[164:167], v[128:131], v[200:203]
    ds_read_b128 v[160:163], v1 offset:12288
    v_mfma_f32_16x16x32_bf16 v[204:207], v[164:167], v[132:135], v[204:207]
    s_waitcnt lgkmcnt(2)
    v_mfma_f32_16x16x32_bf16 v[176:179], v[168:171], v[136:139], v[176:179]
    ds_read_b128 v[164:167], v1 offset:13312
    v_mfma_f32_16x16x32_bf16 v[180:183], v[168:171], v[140:143], v[180:183]
    s_waitcnt lgkmcnt(2)
    v_mfma_f32_16x16x32_bf16 v[184:187], v[172:175], v[136:139], v[184:187]
    ds_read_b128 v[168:171], v1 offset:14336
    v_mfma_f32_16x16x32_bf16 v[188:191], v[172:175], v[140:143], v[188:191]
    s_waitcnt lgkmcnt(2)
    v_mfma_f32_16x16x32_bf16 v[192:195], v[160:163], v[136:139], v[192:195]
    ds_read_b128 v[172:175], v1 offset:15360
    v_mfma_f32_16x16x32_bf16 v[196:199], v[160:163], v[140:143], v[196:199]
    s_waitcnt lgkmcnt(2)
    v_mfma_f32_16x16x32_bf16 v[200:203], v[164:167], v[136:139], v[200:203]
    ds_read_b128 v[160:163], v1 offset:16384
    v_mfma_f32_16x16x32_bf16 v[204:207], v[164:167], v[140:143], v[204:207]
    s_waitcnt lgkmcnt(2)
    v_mfma_f32_16x16x32_bf16 v[176:179], v[168:171], v[144:147], v[176:179]
    ds_read_b128 v[164:167], v1 offset:17408
    v_mfma_f32_16x16x32_bf16 v[180:183], v[168:171], v[148:151], v[180:183]
    s_waitcnt lgkmcnt(2)
    v_mfma_f32_16x16x32_bf16 v[184:187], v[172:175], v[144:147], v[184:187]
    ds_read_b128 v[168:171], v1 offset:18432
    v_mfma_f32_16x16x32_bf16 v[188:191], v[172:175], v[148:151], v[188:191]
    s_waitcnt lgkmcnt(2)
    v_mfma_f32_16x16x32_bf16 v[192:195], v[160:163], v[144:147], v[192:195]
    ds_read_b128 v[172:175], v1 offset:19456
    v_mfma_f32_16x16x32_bf16 v[196:199], v[160:163], v[148:151], v[196:199]
    v_lshrrev_b32 v243, 1, v5
    v_and_b32 v243, 28, v243
    buffer_load_dword v242, v243, s[8:11], s70 offen sc1
    s_waitcnt lgkmcnt(2)
    v_mfma_f32_16x16x32_bf16 v[200:203], v[164:167], v[144:147], v[200:203]
    ds_read_b128 v[160:163], v1 offset:20480
    v_mfma_f32_16x16x32_bf16 v[204:207], v[164:167], v[148:151], v[204:207]
    s_waitcnt lgkmcnt(2)
    v_mfma_f32_16x16x32_bf16 v[176:179], v[168:171], v[152:155], v[176:179]
    ds_read_b128 v[164:167], v1 offset:21504
    v_mfma_f32_16x16x32_bf16 v[180:183], v[168:171], v[156:159], v[180:183]
    s_waitcnt lgkmcnt(2)
    v_mfma_f32_16x16x32_bf16 v[184:187], v[172:175], v[152:155], v[184:187]
    v_mfma_f32_16x16x32_bf16 v[188:191], v[172:175], v[156:159], v[188:191]
    s_waitcnt lgkmcnt(1)
    v_mfma_f32_16x16x32_bf16 v[192:195], v[160:163], v[152:155], v[192:195]
    v_mfma_f32_16x16x32_bf16 v[196:199], v[160:163], v[156:159], v[196:199]
    s_waitcnt lgkmcnt(0)
    v_mfma_f32_16x16x32_bf16 v[200:203], v[164:167], v[152:155], v[200:203]
    v_mfma_f32_16x16x32_bf16 v[204:207], v[164:167], v[156:159], v[204:207]
    v_max_f32 v176, 0, v176
    v_max_f32 v177, 0, v177
    v_max_f32 v178, 0, v178
    v_max_f32 v179, 0, v179
    v_mul_f32 v176, v176, v184
    v_mul_f32 v177, v177, v185
    v_mul_f32 v178, v178, v186
    v_mul_f32 v179, v179, v187
    v_cvt_pk_bf16_f32 v184, v176, v177
    v_cvt_pk_bf16_f32 v185, v178, v179
    v_max_f32 v180, 0, v180
    v_max_f32 v181, 0, v181
    v_max_f32 v182, 0, v182
    v_max_f32 v183, 0, v183
    v_mul_f32 v180, v180, v188
    v_mul_f32 v181, v181, v189
    v_mul_f32 v182, v182, v190
    v_mul_f32 v183, v183, v191
    v_cvt_pk_bf16_f32 v188, v180, v181
    v_cvt_pk_bf16_f32 v189, v182, v183
    v_max_f32 v192, 0, v192
    v_max_f32 v193, 0, v193
    v_max_f32 v194, 0, v194
    v_max_f32 v195, 0, v195
    v_mul_f32 v192, v192, v200
    v_mul_f32 v193, v193, v201
    v_mul_f32 v194, v194, v202
    v_mul_f32 v195, v195, v203
    v_cvt_pk_bf16_f32 v186, v192, v193
    v_cvt_pk_bf16_f32 v187, v194, v195
    buffer_store_dwordx4 v[184:187], v1, s[8:11], s36 offen offset:3072 sc1
    v_max_f32 v196, 0, v196
    v_max_f32 v197, 0, v197
    v_max_f32 v198, 0, v198
    v_max_f32 v199, 0, v199
    v_mul_f32 v196, v196, v204
    v_mul_f32 v197, v197, v205
    v_mul_f32 v198, v198, v206
    v_mul_f32 v199, v199, v207
    v_cvt_pk_bf16_f32 v190, v196, v197
    v_cvt_pk_bf16_f32 v191, v198, v199
    buffer_store_dwordx4 v[188:191], v1, s[8:11], s37 offen offset:3072 sc1
    s_and_b32 s13, s2, 7
    s_lshr_b32 s14, s2, 3
    s_lshr_b32 s15, s13, 1
    s_and_b32 s13, s13, 1
    s_lshl_b32 s13, s13, 3
    s_lshr_b32 s19, s14, 2
    s_add_u32 s13, s13, s19
    s_and_b32 s14, s14, 3
    s_lshl_b32 s13, s13, 3
    s_and_b32 s19, s12, 3
    s_lshl_b32 s19, s19, 1
    s_add_u32 s13, s13, s19
    s_lshr_b32 s18, s12, 2
    s_mul_i32 s22, s13, 147456
    s_mul_i32 s23, s15, 36864
    s_add_u32 s22, s22, s23
    s_add_u32 s22, s22, 41943040
    s_add_u32 s23, s22, 147456
    s_lshl_b32 s27, s15, 7
    s_add_u32 s27, s27, s13
    s_add_u32 s27, s27, s18
    s_mul_i32 s27, s27, 18
    s_lshr_b32 s28, s14, 1
    s_mul_i32 s28, s28, 9
    s_add_u32 s27, s27, s28
    s_lshl_b32 s27, s27, 10
    s_add_u32 s27, s27, 67108864
    s_and_b32 s28, s14, 1
    s_lshl_b32 s29, s28, 9
    s_add_u32 s36, s27, s29
    s_add_u32 s36, s36, 8192
    s_lshl_b32 s29, s28, 12
    s_add_u32 s27, s27, s29
    s_add_u32 s29, s15, 1
    s_and_b32 s29, s29, 3
    s_mul_i32 s38, s29, 2359296
    s_lshl_b32 s29, s29, 10
    s_add_u32 s30, s27, s29
    s_add_u32 s29, s15, 2
    s_and_b32 s29, s29, 3
    s_mul_i32 s39, s29, 2359296
    s_lshl_b32 s29, s29, 10
    s_add_u32 s31, s27, s29
    s_add_u32 s29, s15, 3
    s_and_b32 s29, s29, 3
    s_mul_i32 s40, s29, 2359296
    s_lshl_b32 s29, s29, 10
    s_add_u32 s32, s27, s29
    s_mov_b32 s60, s6
    s_mov_b32 s61, s7
    s_mov_b32 s62, 2359296
    s_mov_b32 s63, 0x00020000
    s_lshr_b32 s68, s13, 4
    s_lshl_b32 s68, s68, 2
    s_add_u32 s68, s68, s15
    s_lshl_b32 s68, s68, 7
    s_add_u32 s68, s68, 20717568
    s_add_u32 s69, s68, 5120
    s_add_u32 s67, s67, 5120
    s_waitcnt vmcnt(2) lgkmcnt(0)
    s_barrier
    s_mul_i32 s35, s12, 9216
    s_add_u32 s35, s35, 77824
    v_add_u32 v152, s35, v1
    s_xor_b32 s35, s12, 4
    s_mul_i32 s35, s35, 9216
    s_add_u32 s35, s35, 77824
    v_add_u32 v153, s35, v1
    v_cmp_ne_u32 vcc, 1, v242
    s_nop 4
    s_cbranch_vccz K5_WAITED
    s_mov_b32 exec_lo, 0xff
    s_mov_b32 exec_hi, 0
    v_lshlrev_b32 v2, 2, v0
    s_mov_b32 s56, 0
K5_POLL:
    buffer_load_dword v6, v2, s[8:11], s68 offen sc1
    s_add_u32 s56, s56, 1
    s_waitcnt vmcnt(0)
    v_cmp_ne_u32 vcc, 1, v6
    s_nop 4
    s_cbranch_vccz K5_POLLED
    s_cmp_lt_u32 s56, 0x40000
    s_cbranch_scc1 K5_POLL
K5_POLLED:
    s_mov_b64 exec, -1
K5_WAITED:
    s_cmp_eq_u32 s18, 1
    s_cbranch_scc1 K6_P1
    s_add_u32 s24, s22, 0
    buffer_load_dwordx4 v[96:99], v1, s[8:11], s24 offen sc1
    s_add_u32 s24, s23, 0
    buffer_load_dwordx4 v[100:103], v1, s[8:11], s24 offen sc1
    s_add_u32 s24, s22, 2048
    buffer_load_dwordx4 v[104:107], v1, s[8:11], s24 offen sc1
    s_add_u32 s24, s23, 2048
    buffer_load_dwordx4 v[108:111], v1, s[8:11], s24 offen sc1
    s_add_u32 s24, s22, 5120
    buffer_load_dwordx4 v[112:115], v1, s[8:11], s24 offen sc1
    s_add_u32 s24, s23, 5120
    buffer_load_dwordx4 v[116:119], v1, s[8:11], s24 offen sc1
    ds_read_b128 v[80:83], v1 offset:40960
    ds_read_b128 v[84:87], v1 offset:41984
    ds_read_b128 v[88:91], v1 offset:43008
    s_waitcnt vmcnt(4) lgkmcnt(2)
    v_mfma_f32_16x16x32_bf16 v[8:11], v[80:83], v[96:99], 0
    ds_read_b128 v[92:95], v1 offset:44032
    v_mfma_f32_16x16x32_bf16 v[12:15], v[80:83], v[100:103], 0
    s_add_u32 s24, s22, 8192
    buffer_load_dwordx2 v[120:121], v5, s[8:11], s24 offen offset:0 sc1
    buffer_load_dwordx2 v[122:123], v5, s[8:11], s24 offen offset:512 sc1
    s_add_u32 s24, s23, 8192
    buffer_load_dwordx2 v[124:125], v5, s[8:11], s24 offen offset:0 sc1
    buffer_load_dwordx2 v[126:127], v5, s[8:11], s24 offen offset:512 sc1
    s_waitcnt lgkmcnt(2)
    v_mfma_f32_16x16x32_bf16 v[16:19], v[84:87], v[96:99], 0
    ds_read_b128 v[80:83], v1 offset:45056
    v_mfma_f32_16x16x32_bf16 v[20:23], v[84:87], v[100:103], 0
    s_add_u32 m0, s20, 114688
    s_add_u32 s17, s64, 73728
    buffer_load_dwordx4 v1, s[8:11], s17 offen lds
    s_waitcnt lgkmcnt(2)
    v_mfma_f32_16x16x32_bf16 v[24:27], v[88:91], v[96:99], 0
    ds_read_b128 v[84:87], v1 offset:46080
    v_mfma_f32_16x16x32_bf16 v[28:31], v[88:91], v[100:103], 0
    s_add_u32 m0, s20, 122880
    s_add_u32 s17, s64, 81920
    buffer_load_dwordx4 v1, s[8:11], s17 offen lds
    s_waitcnt lgkmcnt(2)
    v_mfma_f32_16x16x32_bf16 v[32:35], v[92:95], v[96:99], 0
    ds_read_b128 v[88:91], v1 offset:47104
    v_mfma_f32_16x16x32_bf16 v[36:39], v[92:95], v[100:103], 0
    s_add_u32 m0, s20, 131072
    s_add_u32 s17, s64, 90112
    buffer_load_dwordx4 v1, s[8:11], s17 offen lds
    s_waitcnt lgkmcnt(2)
    v_mfma_f32_16x16x32_bf16 v[40:43], v[80:83], v[96:99], 0
    ds_read_b128 v[92:95], v1 offset:48128
    v_mfma_f32_16x16x32_bf16 v[44:47], v[80:83], v[100:103], 0
    s_add_u32 m0, s20, 139264
    s_add_u32 s17, s64, 98304
    buffer_load_dwordx4 v1, s[8:11], s17 offen lds
    s_waitcnt lgkmcnt(2)
    v_mfma_f32_16x16x32_bf16 v[48:51], v[84:87], v[96:99], 0
    ds_read_b128 v[80:83], v1 offset:49152
    v_mfma_f32_16x16x32_bf16 v[52:55], v[84:87], v[100:103], 0
    s_add_u32 m0, s20, 147456
    s_add_u32 s17, s64, 106496
    buffer_load_dwordx4 v1, s[8:11], s17 offen lds
    s_waitcnt lgkmcnt(2)
    v_mfma_f32_16x16x32_bf16 v[56:59], v[88:91], v[96:99], 0
    ds_read_b128 v[84:87], v3 offset:2048
    v_mfma_f32_16x16x32_bf16 v[60:63], v[88:91], v[100:103], 0
    s_add_u32 s24, s22, 10240
    buffer_load_dwordx4 v[128:131], v1, s[8:11], s24 offen sc1
    s_add_u32 s24, s23, 10240
    buffer_load_dwordx4 v[132:135], v1, s[8:11], s24 offen sc1
    s_waitcnt lgkmcnt(2)
    v_mfma_f32_16x16x32_bf16 v[64:67], v[92:95], v[96:99], 0
    ds_read_b128 v[88:91], v3 offset:3072
    v_mfma_f32_16x16x32_bf16 v[68:71], v[92:95], v[100:103], 0
    s_add_u32 s24, s22, 13312
    buffer_load_dwordx4 v[136:139], v1, s[8:11], s24 offen sc1
    s_add_u32 s24, s23, 13312
    buffer_load_dwordx4 v[140:143], v1, s[8:11], s24 offen sc1
    s_waitcnt lgkmcnt(2)
    v_mfma_f32_16x16x32_bf16 v[72:75], v[80:83], v[96:99], 0
    ds_read_b128 v[92:95], v3 offset:4096
    v_mfma_f32_16x16x32_bf16 v[76:79], v[80:83], v[100:103], 0
    s_add_u32 m0, s20, 0
    s_add_u32 s17, s64, 110592
    buffer_load_dwordx4 v1, s[8:11], s17 offen lds
    s_waitcnt vmcnt(16) lgkmcnt(2)
    v_mfma_f32_16x16x32_bf16 v[8:11], v[84:87], v[104:107], v[8:11]
    ds_read_b128 v[80:83], v3 offset:5120
    v_mfma_f32_16x16x32_bf16 v[12:15], v[84:87], v[108:111], v[12:15]
    s_add_u32 m0, s20, 8192
    s_add_u32 s17, s64, 118784
    buffer_load_dwordx4 v1, s[8:11], s17 offen lds
    s_waitcnt lgkmcnt(2)
    v_mfma_f32_16x16x32_bf16 v[16:19], v[88:91], v[104:107], v[16:19]
    ds_read_b128 v[84:87], v3 offset:6144
    v_mfma_f32_16x16x32_bf16 v[20:23], v[88:91], v[108:111], v[20:23]
    s_add_u32 m0, s20, 16384
    s_add_u32 s17, s64, 126976
    buffer_load_dwordx4 v1, s[8:11], s17 offen lds
    s_waitcnt lgkmcnt(2)
    v_mfma_f32_16x16x32_bf16 v[24:27], v[92:95], v[104:107], v[24:27]
    ds_read_b128 v[88:91], v3 offset:7168
    v_mfma_f32_16x16x32_bf16 v[28:31], v[92:95], v[108:111], v[28:31]
    s_add_u32 m0, s20, 24576
    s_add_u32 s17, s64, 135168
    buffer_load_dwordx4 v1, s[8:11], s17 offen lds
    s_waitcnt lgkmcnt(2)
    v_mfma_f32_16x16x32_bf16 v[32:35], v[80:83], v[104:107], v[32:35]
    ds_read_b128 v[92:95], v3 offset:8192
    v_mfma_f32_16x16x32_bf16 v[36:39], v[80:83], v[108:111], v[36:39]
    s_add_u32 m0, s20, 32768
    s_add_u32 s17, s64, 143360
    buffer_load_dwordx4 v1, s[8:11], s17 offen lds
    s_waitcnt lgkmcnt(2)
    v_mfma_f32_16x16x32_bf16 v[40:43], v[84:87], v[104:107], v[40:43]
    ds_read_b128 v[80:83], v3 offset:9216
    v_mfma_f32_16x16x32_bf16 v[44:47], v[84:87], v[108:111], v[44:47]
    s_waitcnt lgkmcnt(2)
    v_mfma_f32_16x16x32_bf16 v[48:51], v[88:91], v[104:107], v[48:51]
    ds_read_b128 v[84:87], v3 offset:10240
    v_mfma_f32_16x16x32_bf16 v[52:55], v[88:91], v[108:111], v[52:55]
    s_waitcnt lgkmcnt(2)
    v_mfma_f32_16x16x32_bf16 v[56:59], v[92:95], v[104:107], v[56:59]
    s_barrier
    s_cmp_lg_u32 s12, 0
    s_cbranch_scc1 K5_SIGB
    v_mov_b32 v2, 0
    v_mov_b32 v6, 1
    s_mov_b64 exec, 1
    buffer_store_dword v6, v2, s[8:11], s67 offen sc1
    s_mov_b64 exec, -1
K5_SIGB:
    ds_read_b128 v[88:91], v3 offset:20480
    v_mfma_f32_16x16x32_bf16 v[60:63], v[92:95], v[108:111], v[60:63]
    s_add_u32 s24, s22, 15360
    buffer_load_dwordx4 v[144:147], v1, s[8:11], s24 offen sc1
    s_add_u32 s24, s23, 15360
    buffer_load_dwordx4 v[148:151], v1, s[8:11], s24 offen sc1
    s_waitcnt lgkmcnt(2)
    v_mfma_f32_16x16x32_bf16 v[64:67], v[80:83], v[104:107], v[64:67]
    ds_read_b128 v[92:95], v3 offset:21504
    v_mfma_f32_16x16x32_bf16 v[68:71], v[80:83], v[108:111], v[68:71]
    s_waitcnt lgkmcnt(2)
    v_mfma_f32_16x16x32_bf16 v[72:75], v[84:87], v[104:107], v[72:75]
    ds_read_b128 v[80:83], v3 offset:22528
    v_mfma_f32_16x16x32_bf16 v[76:79], v[84:87], v[108:111], v[76:79]
    s_waitcnt vmcnt(20) lgkmcnt(2)
    v_mfma_f32_16x16x32_bf16 v[8:11], v[88:91], v[112:115], v[8:11]
    ds_read_b128 v[84:87], v3 offset:23552
    v_mfma_f32_16x16x32_bf16 v[12:15], v[88:91], v[116:119], v[12:15]
    s_waitcnt lgkmcnt(2)
    v_mfma_f32_16x16x32_bf16 v[16:19], v[92:95], v[112:115], v[16:19]
    ds_read_b128 v[88:91], v3 offset:24576
    v_mfma_f32_16x16x32_bf16 v[20:23], v[92:95], v[116:119], v[20:23]
    s_waitcnt lgkmcnt(2)
    v_mfma_f32_16x16x32_bf16 v[24:27], v[80:83], v[112:115], v[24:27]
    ds_read_b128 v[92:95], v3 offset:25600
    v_mfma_f32_16x16x32_bf16 v[28:31], v[80:83], v[116:119], v[28:31]
    s_waitcnt lgkmcnt(2)
    v_mfma_f32_16x16x32_bf16 v[32:35], v[84:87], v[112:115], v[32:35]
    ds_read_b128 v[80:83], v3 offset:26624
    v_mfma_f32_16x16x32_bf16 v[36:39], v[84:87], v[116:119], v[36:39]
    s_waitcnt lgkmcnt(2)
    v_mfma_f32_16x16x32_bf16 v[40:43], v[88:91], v[112:115], v[40:43]
    ds_read_b128 v[84:87], v3 offset:27648
    v_mfma_f32_16x16x32_bf16 v[44:47], v[88:91], v[116:119], v[44:47]
    s_waitcnt lgkmcnt(2)
    v_mfma_f32_16x16x32_bf16 v[48:51], v[92:95], v[112:115], v[48:51]
    ds_read_b128 v[88:91], v3 offset:28672
    v_mfma_f32_16x16x32_bf16 v[52:55], v[92:95], v[116:119], v[52:55]
    s_waitcnt lgkmcnt(2)
    v_mfma_f32_16x16x32_bf16 v[56:59], v[80:83], v[112:115], v[56:59]
    ds_read_b128 v[92:95], v3 offset:38912
    v_mfma_f32_16x16x32_bf16 v[60:63], v[80:83], v[116:119], v[60:63]
    s_add_u32 s24, s22, 18432
    buffer_load_dwordx4 v[96:99], v1, s[8:11], s24 offen sc1
    s_add_u32 s24, s23, 18432
    buffer_load_dwordx4 v[100:103], v1, s[8:11], s24 offen sc1
    s_waitcnt lgkmcnt(2)
    v_mfma_f32_16x16x32_bf16 v[64:67], v[84:87], v[112:115], v[64:67]
    ds_read_b128 v[80:83], v3 offset:39936
    v_mfma_f32_16x16x32_bf16 v[68:71], v[84:87], v[116:119], v[68:71]
    s_waitcnt lgkmcnt(2)
    v_mfma_f32_16x16x32_bf16 v[72:75], v[88:91], v[112:115], v[72:75]
    ds_read_b128 v[84:87], v3 offset:40960
    v_mfma_f32_16x16x32_bf16 v[76:79], v[88:91], v[116:119], v[76:79]
    s_waitcnt vmcnt(18) lgkmcnt(2)
    v_mfma_f32_16x16x32_bf16 v[8:11], v[92:95], v[120:123], v[8:11]
    ds_read_b128 v[88:91], v3 offset:41984
    v_mfma_f32_16x16x32_bf16 v[12:15], v[92:95], v[124:127], v[12:15]
    s_waitcnt lgkmcnt(2)
    v_mfma_f32_16x16x32_bf16 v[16:19], v[80:83], v[120:123], v[16:19]
    ds_read_b128 v[92:95], v3 offset:43008
    v_mfma_f32_16x16x32_bf16 v[20:23], v[80:83], v[124:127], v[20:23]
    s_waitcnt lgkmcnt(2)
    v_mfma_f32_16x16x32_bf16 v[24:27], v[84:87], v[120:123], v[24:27]
    ds_read_b128 v[80:83], v3 offset:44032
    v_mfma_f32_16x16x32_bf16 v[28:31], v[84:87], v[124:127], v[28:31]
    s_waitcnt lgkmcnt(2)
    v_mfma_f32_16x16x32_bf16 v[32:35], v[88:91], v[120:123], v[32:35]
    ds_read_b128 v[84:87], v3 offset:45056
    v_mfma_f32_16x16x32_bf16 v[36:39], v[88:91], v[124:127], v[36:39]
    s_waitcnt lgkmcnt(2)
    v_mfma_f32_16x16x32_bf16 v[40:43], v[92:95], v[120:123], v[40:43]
    ds_read_b128 v[88:91], v3 offset:46080
    v_mfma_f32_16x16x32_bf16 v[44:47], v[92:95], v[124:127], v[44:47]
    s_waitcnt lgkmcnt(2)
    v_mfma_f32_16x16x32_bf16 v[48:51], v[80:83], v[120:123], v[48:51]
    ds_read_b128 v[92:95], v3 offset:47104
    v_mfma_f32_16x16x32_bf16 v[52:55], v[80:83], v[124:127], v[52:55]
    s_waitcnt lgkmcnt(2)
    v_mfma_f32_16x16x32_bf16 v[56:59], v[84:87], v[120:123], v[56:59]
    s_waitcnt vmcnt(13)
    s_barrier
    ds_read_b128 v[80:83], v4 offset:0
    v_mfma_f32_16x16x32_bf16 v[60:63], v[84:87], v[124:127], v[60:63]
    s_add_u32 s24, s22, 20480
    buffer_load_dwordx4 v[104:107], v1, s[8:11], s24 offen sc1
    s_add_u32 s24, s23, 20480
    buffer_load_dwordx4 v[108:111], v1, s[8:11], s24 offen sc1
    s_waitcnt lgkmcnt(2)
    v_mfma_f32_16x16x32_bf16 v[64:67], v[88:91], v[120:123], v[64:67]
    ds_read_b128 v[84:87], v4 offset:1024
    v_mfma_f32_16x16x32_bf16 v[68:71], v[88:91], v[124:127], v[68:71]
    s_add_u32 m0, s20, 40960
    s_add_u32 s17, s64, 147456
    buffer_load_dwordx4 v1, s[8:11], s17 offen lds
    s_waitcnt lgkmcnt(2)
    v_mfma_f32_16x16x32_bf16 v[72:75], v[92:95], v[120:123], v[72:75]
    ds_read_b128 v[88:91], v4 offset:2048
    v_mfma_f32_16x16x32_bf16 v[76:79], v[92:95], v[124:127], v[76:79]
    s_waitcnt vmcnt(14) lgkmcnt(2)
    v_mfma_f32_16x16x32_bf16 v[8:11], v[80:83], v[128:131], v[8:11]
    ds_read_b128 v[92:95], v4 offset:3072
    v_mfma_f32_16x16x32_bf16 v[12:15], v[80:83], v[132:135], v[12:15]
    s_add_u32 m0, s20, 49152
    s_add_u32 s17, s64, 155648
    buffer_load_dwordx4 v1, s[8:11], s17 offen lds
    s_waitcnt lgkmcnt(2)
    v_mfma_f32_16x16x32_bf16 v[16:19], v[84:87], v[128:131], v[16:19]
    ds_read_b128 v[80:83], v4 offset:4096
    v_mfma_f32_16x16x32_bf16 v[20:23], v[84:87], v[132:135], v[20:23]
    s_waitcnt lgkmcnt(2)
    v_mfma_f32_16x16x32_bf16 v[24:27], v[88:91], v[128:131], v[24:27]
    ds_read_b128 v[84:87], v4 offset:5120
    v_mfma_f32_16x16x32_bf16 v[28:31], v[88:91], v[132:135], v[28:31]
    s_add_u32 m0, s20, 57344
    s_add_u32 s17, s64, 163840
    buffer_load_dwordx4 v1, s[8:11], s17 offen lds
    s_waitcnt lgkmcnt(2)
    v_mfma_f32_16x16x32_bf16 v[32:35], v[92:95], v[128:131], v[32:35]
    ds_read_b128 v[88:91], v4 offset:6144
    v_mfma_f32_16x16x32_bf16 v[36:39], v[92:95], v[132:135], v[36:39]
    s_waitcnt lgkmcnt(2)
    v_mfma_f32_16x16x32_bf16 v[40:43], v[80:83], v[128:131], v[40:43]
    ds_read_b128 v[92:95], v4 offset:7168
    v_mfma_f32_16x16x32_bf16 v[44:47], v[80:83], v[132:135], v[44:47]
    s_add_u32 m0, s20, 65536
    s_add_u32 s17, s64, 172032
    buffer_load_dwordx4 v1, s[8:11], s17 offen lds
    s_waitcnt lgkmcnt(2)
    v_mfma_f32_16x16x32_bf16 v[48:51], v[84:87], v[128:131], v[48:51]
    ds_read_b128 v[80:83], v4 offset:8192
    v_mfma_f32_16x16x32_bf16 v[52:55], v[84:87], v[132:135], v[52:55]
    s_waitcnt lgkmcnt(2)
    v_mfma_f32_16x16x32_bf16 v[56:59], v[88:91], v[128:131], v[56:59]
    ds_read_b128 v[84:87], v4 offset:18432
    v_mfma_f32_16x16x32_bf16 v[60:63], v[88:91], v[132:135], v[60:63]
    s_add_u32 m0, s20, 73728
    s_add_u32 s17, s64, 180224
    buffer_load_dwordx4 v1, s[8:11], s17 offen lds
    s_add_u32 s24, s22, 23552
    buffer_load_dwordx4 v[112:115], v1, s[8:11], s24 offen sc1
    s_add_u32 s24, s23, 23552
    buffer_load_dwordx4 v[116:119], v1, s[8:11], s24 offen sc1
    s_waitcnt lgkmcnt(2)
    v_mfma_f32_16x16x32_bf16 v[64:67], v[92:95], v[128:131], v[64:67]
    ds_read_b128 v[88:91], v4 offset:19456
    v_mfma_f32_16x16x32_bf16 v[68:71], v[92:95], v[132:135], v[68:71]
    s_waitcnt lgkmcnt(2)
    v_mfma_f32_16x16x32_bf16 v[72:75], v[80:83], v[128:131], v[72:75]
    ds_read_b128 v[92:95], v4 offset:20480
    v_mfma_f32_16x16x32_bf16 v[76:79], v[80:83], v[132:135], v[76:79]
    s_waitcnt vmcnt(18) lgkmcnt(2)
    v_mfma_f32_16x16x32_bf16 v[8:11], v[84:87], v[136:139], v[8:11]
    ds_read_b128 v[80:83], v4 offset:21504
    v_mfma_f32_16x16x32_bf16 v[12:15], v[84:87], v[140:143], v[12:15]
    s_waitcnt lgkmcnt(2)
    v_mfma_f32_16x16x32_bf16 v[16:19], v[88:91], v[136:139], v[16:19]
    ds_read_b128 v[84:87], v4 offset:22528
    v_mfma_f32_16x16x32_bf16 v[20:23], v[88:91], v[140:143], v[20:23]
    s_waitcnt lgkmcnt(2)
    v_mfma_f32_16x16x32_bf16 v[24:27], v[92:95], v[136:139], v[24:27]
    ds_read_b128 v[88:91], v4 offset:23552
    v_mfma_f32_16x16x32_bf16 v[28:31], v[92:95], v[140:143], v[28:31]
    s_waitcnt lgkmcnt(2)
    v_mfma_f32_16x16x32_bf16 v[32:35], v[80:83], v[136:139], v[32:35]
    ds_read_b128 v[92:95], v4 offset:24576
    v_mfma_f32_16x16x32_bf16 v[36:39], v[80:83], v[140:143], v[36:39]
    s_waitcnt lgkmcnt(2)
    v_mfma_f32_16x16x32_bf16 v[40:43], v[84:87], v[136:139], v[40:43]
    ds_read_b128 v[80:83], v4 offset:25600
    v_mfma_f32_16x16x32_bf16 v[44:47], v[84:87], v[140:143], v[44:47]
    s_waitcnt lgkmcnt(2)
    v_mfma_f32_16x16x32_bf16 v[48:51], v[88:91], v[136:139], v[48:51]
    ds_read_b128 v[84:87], v4 offset:26624
    v_mfma_f32_16x16x32_bf16 v[52:55], v[88:91], v[140:143], v[52:55]
    s_waitcnt lgkmcnt(2)
    v_mfma_f32_16x16x32_bf16 v[56:59], v[92:95], v[136:139], v[56:59]
    s_waitcnt vmcnt(13)
    s_barrier
    ds_read_b128 v[88:91], v1 offset:0
    v_mfma_f32_16x16x32_bf16 v[60:63], v[92:95], v[140:143], v[60:63]
    s_add_u32 s24, s22, 26624
    buffer_load_dwordx2 v[120:121], v5, s[8:11], s24 offen offset:0 sc1
    buffer_load_dwordx2 v[122:123], v5, s[8:11], s24 offen offset:512 sc1
    s_add_u32 s24, s23, 26624
    buffer_load_dwordx2 v[124:125], v5, s[8:11], s24 offen offset:0 sc1
    buffer_load_dwordx2 v[126:127], v5, s[8:11], s24 offen offset:512 sc1
    s_waitcnt lgkmcnt(2)
    v_mfma_f32_16x16x32_bf16 v[64:67], v[80:83], v[136:139], v[64:67]
    ds_read_b128 v[92:95], v1 offset:1024
    v_mfma_f32_16x16x32_bf16 v[68:71], v[80:83], v[140:143], v[68:71]
    s_add_u32 m0, s20, 77824
    s_add_u32 s17, s64, 184320
    buffer_load_dwordx4 v1, s[8:11], s17 offen lds
    s_waitcnt lgkmcnt(2)
    v_mfma_f32_16x16x32_bf16 v[72:75], v[84:87], v[136:139], v[72:75]
    ds_read_b128 v[80:83], v1 offset:2048
    v_mfma_f32_16x16x32_bf16 v[76:79], v[84:87], v[140:143], v[76:79]
    s_waitcnt vmcnt(16) lgkmcnt(2)
    v_mfma_f32_16x16x32_bf16 v[8:11], v[88:91], v[144:147], v[8:11]
    ds_read_b128 v[84:87], v1 offset:3072
    v_mfma_f32_16x16x32_bf16 v[12:15], v[88:91], v[148:151], v[12:15]
    s_add_u32 m0, s20, 86016
    s_add_u32 s17, s64, 192512
    buffer_load_dwordx4 v1, s[8:11], s17 offen lds
    s_waitcnt lgkmcnt(2)
    v_mfma_f32_16x16x32_bf16 v[16:19], v[92:95], v[144:147], v[16:19]
    ds_read_b128 v[88:91], v1 offset:4096
    v_mfma_f32_16x16x32_bf16 v[20:23], v[92:95], v[148:151], v[20:23]
    s_waitcnt lgkmcnt(2)
    v_mfma_f32_16x16x32_bf16 v[24:27], v[80:83], v[144:147], v[24:27]
    ds_read_b128 v[92:95], v1 offset:5120
    v_mfma_f32_16x16x32_bf16 v[28:31], v[80:83], v[148:151], v[28:31]
    s_add_u32 m0, s20, 94208
    s_add_u32 s17, s64, 200704
    buffer_load_dwordx4 v1, s[8:11], s17 offen lds
    s_waitcnt lgkmcnt(2)
    v_mfma_f32_16x16x32_bf16 v[32:35], v[84:87], v[144:147], v[32:35]
    ds_read_b128 v[80:83], v1 offset:6144
    v_mfma_f32_16x16x32_bf16 v[36:39], v[84:87], v[148:151], v[36:39]
    s_waitcnt lgkmcnt(2)
    v_mfma_f32_16x16x32_bf16 v[40:43], v[88:91], v[144:147], v[40:43]
    ds_read_b128 v[84:87], v1 offset:7168
    v_mfma_f32_16x16x32_bf16 v[44:47], v[88:91], v[148:151], v[44:47]
    s_add_u32 m0, s20, 102400
    s_add_u32 s17, s64, 208896
    buffer_load_dwordx4 v1, s[8:11], s17 offen lds
    s_waitcnt lgkmcnt(2)
    v_mfma_f32_16x16x32_bf16 v[48:51], v[92:95], v[144:147], v[48:51]
    ds_read_b128 v[88:91], v1 offset:8192
    v_mfma_f32_16x16x32_bf16 v[52:55], v[92:95], v[148:151], v[52:55]
    s_waitcnt lgkmcnt(2)
    v_mfma_f32_16x16x32_bf16 v[56:59], v[80:83], v[144:147], v[56:59]
    ds_read_b128 v[92:95], v1 offset:18432
    v_mfma_f32_16x16x32_bf16 v[60:63], v[80:83], v[148:151], v[60:63]
    s_add_u32 m0, s20, 110592
    s_add_u32 s17, s64, 217088
    buffer_load_dwordx4 v1, s[8:11], s17 offen lds
    s_add_u32 s24, s22, 28672
    buffer_load_dwordx4 v[128:131], v1, s[8:11], s24 offen sc1
    s_add_u32 s24, s23, 28672
    buffer_load_dwordx4 v[132:135], v1, s[8:11], s24 offen sc1
    s_waitcnt lgkmcnt(2)
    v_mfma_f32_16x16x32_bf16 v[64:67], v[84:87], v[144:147], v[64:67]
    ds_read_b128 v[80:83], v1 offset:19456
    v_mfma_f32_16x16x32_bf16 v[68:71], v[84:87], v[148:151], v[68:71]
    s_waitcnt lgkmcnt(2)
    v_mfma_f32_16x16x32_bf16 v[72:75], v[88:91], v[144:147], v[72:75]
    ds_read_b128 v[84:87], v1 offset:20480
    v_mfma_f32_16x16x32_bf16 v[76:79], v[88:91], v[148:151], v[76:79]
    s_waitcnt vmcnt(20) lgkmcnt(2)
    v_mfma_f32_16x16x32_bf16 v[8:11], v[92:95], v[96:99], v[8:11]
    ds_read_b128 v[88:91], v1 offset:21504
    v_mfma_f32_16x16x32_bf16 v[12:15], v[92:95], v[100:103], v[12:15]
    s_waitcnt lgkmcnt(2)
    v_mfma_f32_16x16x32_bf16 v[16:19], v[80:83], v[96:99], v[16:19]
    ds_read_b128 v[92:95], v1 offset:22528
    v_mfma_f32_16x16x32_bf16 v[20:23], v[80:83], v[100:103], v[20:23]
    s_waitcnt lgkmcnt(2)
    v_mfma_f32_16x16x32_bf16 v[24:27], v[84:87], v[96:99], v[24:27]
    ds_read_b128 v[80:83], v1 offset:23552
    v_mfma_f32_16x16x32_bf16 v[28:31], v[84:87], v[100:103], v[28:31]
    s_waitcnt lgkmcnt(2)
    v_mfma_f32_16x16x32_bf16 v[32:35], v[88:91], v[96:99], v[32:35]
    ds_read_b128 v[84:87], v1 offset:24576
    v_mfma_f32_16x16x32_bf16 v[36:39], v[88:91], v[100:103], v[36:39]
    s_waitcnt lgkmcnt(2)
    v_mfma_f32_16x16x32_bf16 v[40:43], v[92:95], v[96:99], v[40:43]
    ds_read_b128 v[88:91], v1 offset:25600
    v_mfma_f32_16x16x32_bf16 v[44:47], v[92:95], v[100:103], v[44:47]
    s_waitcnt lgkmcnt(2)
    v_mfma_f32_16x16x32_bf16 v[48:51], v[80:83], v[96:99], v[48:51]
    ds_read_b128 v[92:95], v1 offset:26624
    v_mfma_f32_16x16x32_bf16 v[52:55], v[80:83], v[100:103], v[52:55]
    s_waitcnt lgkmcnt(2)
    v_mfma_f32_16x16x32_bf16 v[56:59], v[84:87], v[96:99], v[56:59]
    s_waitcnt vmcnt(13)
    s_barrier
    ds_read_b128 v[80:83], v1 offset:40960
    v_mfma_f32_16x16x32_bf16 v[60:63], v[84:87], v[100:103], v[60:63]
    s_add_u32 s24, s22, 31744
    buffer_load_dwordx4 v[136:139], v1, s[8:11], s24 offen sc1
    s_add_u32 s24, s23, 31744
    buffer_load_dwordx4 v[140:143], v1, s[8:11], s24 offen sc1
    s_waitcnt lgkmcnt(2)
    v_mfma_f32_16x16x32_bf16 v[64:67], v[88:91], v[96:99], v[64:67]
    ds_read_b128 v[84:87], v1 offset:41984
    v_mfma_f32_16x16x32_bf16 v[68:71], v[88:91], v[100:103], v[68:71]
    s_add_u32 m0, s20, 114688
    s_add_u32 s17, s64, 221184
    buffer_load_dwordx4 v1, s[8:11], s17 offen lds
    s_waitcnt lgkmcnt(2)
    v_mfma_f32_16x16x32_bf16 v[72:75], v[92:95], v[96:99], v[72:75]
    ds_read_b128 v[88:91], v1 offset:43008
    v_mfma_f32_16x16x32_bf16 v[76:79], v[92:95], v[100:103], v[76:79]
    s_waitcnt lgkmcnt(2)
    v_mfma_f32_16x16x32_bf16 v[8:11], v[80:83], v[104:107], v[8:11]
    ds_read_b128 v[92:95], v1 offset:44032
    v_mfma_f32_16x16x32_bf16 v[12:15], v[80:83], v[108:111], v[12:15]
    s_add_u32 m0, s20, 122880
    s_add_u32 s17, s64, 229376
    buffer_load_dwordx4 v1, s[8:11], s17 offen lds
    s_waitcnt lgkmcnt(2)
    v_mfma_f32_16x16x32_bf16 v[16:19], v[84:87], v[104:107], v[16:19]
    ds_read_b128 v[80:83], v1 offset:45056
    v_mfma_f32_16x16x32_bf16 v[20:23], v[84:87], v[108:111], v[20:23]
    v_and_b32 v228, 28, v5
    v_lshrrev_b32 v229, 1, v5
    v_and_b32 v229, 28, v229
    buffer_load_dword v228, v229, s[8:11], s69 offen sc1
    s_waitcnt lgkmcnt(2)
    v_mfma_f32_16x16x32_bf16 v[24:27], v[88:91], v[104:107], v[24:27]
    ds_read_b128 v[84:87], v1 offset:46080
    v_mfma_f32_16x16x32_bf16 v[28:31], v[88:91], v[108:111], v[28:31]
    s_add_u32 m0, s20, 131072
    s_add_u32 s17, s64, 237568
    buffer_load_dwordx4 v1, s[8:11], s17 offen lds
    s_waitcnt lgkmcnt(2)
    v_mfma_f32_16x16x32_bf16 v[32:35], v[92:95], v[104:107], v[32:35]
    ds_read_b128 v[88:91], v1 offset:47104
    v_mfma_f32_16x16x32_bf16 v[36:39], v[92:95], v[108:111], v[36:39]
    s_waitcnt lgkmcnt(2)
    v_mfma_f32_16x16x32_bf16 v[40:43], v[80:83], v[104:107], v[40:43]
    ds_read_b128 v[92:95], v1 offset:48128
    v_mfma_f32_16x16x32_bf16 v[44:47], v[80:83], v[108:111], v[44:47]
    s_add_u32 m0, s20, 139264
    s_add_u32 s17, s64, 245760
    buffer_load_dwordx4 v1, s[8:11], s17 offen lds
    s_waitcnt lgkmcnt(2)
    v_mfma_f32_16x16x32_bf16 v[48:51], v[84:87], v[104:107], v[48:51]
    ds_read_b128 v[80:83], v1 offset:49152
    v_mfma_f32_16x16x32_bf16 v[52:55], v[84:87], v[108:111], v[52:55]
    s_waitcnt lgkmcnt(2)
    v_mfma_f32_16x16x32_bf16 v[56:59], v[88:91], v[104:107], v[56:59]
    ds_read_b128 v[84:87], v3 offset:2048
    v_mfma_f32_16x16x32_bf16 v[60:63], v[88:91], v[108:111], v[60:63]
    s_add_u32 m0, s20, 147456
    s_add_u32 s17, s64, 253952
    buffer_load_dwordx4 v1, s[8:11], s17 offen lds
    s_add_u32 s24, s22, 33792
    buffer_load_dwordx4 v[144:147], v1, s[8:11], s24 offen sc1
    s_add_u32 s24, s23, 33792
    buffer_load_dwordx4 v[148:151], v1, s[8:11], s24 offen sc1
    s_waitcnt lgkmcnt(2)
    v_mfma_f32_16x16x32_bf16 v[64:67], v[92:95], v[104:107], v[64:67]
    ds_read_b128 v[88:91], v3 offset:3072
    v_mfma_f32_16x16x32_bf16 v[68:71], v[92:95], v[108:111], v[68:71]
    s_waitcnt lgkmcnt(2)
    v_mfma_f32_16x16x32_bf16 v[72:75], v[80:83], v[104:107], v[72:75]
    ds_read_b128 v[92:95], v3 offset:4096
    v_mfma_f32_16x16x32_bf16 v[76:79], v[80:83], v[108:111], v[76:79]
    s_waitcnt vmcnt(21) lgkmcnt(2)
    v_mfma_f32_16x16x32_bf16 v[8:11], v[84:87], v[112:115], v[8:11]
    ds_read_b128 v[80:83], v3 offset:5120
    v_mfma_f32_16x16x32_bf16 v[12:15], v[84:87], v[116:119], v[12:15]
    s_waitcnt lgkmcnt(2)
    v_mfma_f32_16x16x32_bf16 v[16:19], v[88:91], v[112:115], v[16:19]
    ds_read_b128 v[84:87], v3 offset:6144
    v_mfma_f32_16x16x32_bf16 v[20:23], v[88:91], v[116:119], v[20:23]
    s_waitcnt lgkmcnt(2)
    v_mfma_f32_16x16x32_bf16 v[24:27], v[92:95], v[112:115], v[24:27]
    ds_read_b128 v[88:91], v3 offset:7168
    v_mfma_f32_16x16x32_bf16 v[28:31], v[92:95], v[116:119], v[28:31]
    s_waitcnt lgkmcnt(2)
    v_mfma_f32_16x16x32_bf16 v[32:35], v[80:83], v[112:115], v[32:35]
    ds_read_b128 v[92:95], v3 offset:8192
    v_mfma_f32_16x16x32_bf16 v[36:39], v[80:83], v[116:119], v[36:39]
    s_waitcnt lgkmcnt(2)
    v_mfma_f32_16x16x32_bf16 v[40:43], v[84:87], v[112:115], v[40:43]
    ds_read_b128 v[80:83], v3 offset:9216
    v_mfma_f32_16x16x32_bf16 v[44:47], v[84:87], v[116:119], v[44:47]
    s_waitcnt lgkmcnt(2)
    v_mfma_f32_16x16x32_bf16 v[48:51], v[88:91], v[112:115], v[48:51]
    ds_read_b128 v[84:87], v3 offset:10240
    v_mfma_f32_16x16x32_bf16 v[52:55], v[88:91], v[116:119], v[52:55]
    s_waitcnt lgkmcnt(2)
    v_mfma_f32_16x16x32_bf16 v[56:59], v[92:95], v[112:115], v[56:59]
    s_waitcnt vmcnt(12)
    s_waitcnt vmcnt(5)
    v_cmp_ne_u32 vcc, 1, v228
    s_nop 4
    s_cbranch_vccz K5_POLLB
    s_mov_b32 exec_lo, 0xff
    s_mov_b32 exec_hi, 0
    v_lshlrev_b32 v2, 2, v0
    s_mov_b32 s56, 0
K5B_POLL:
    buffer_load_dword v6, v2, s[8:11], s69 offen sc1
    s_add_u32 s56, s56, 1
    s_waitcnt vmcnt(0)
    v_cmp_ne_u32 vcc, 1, v6
    s_nop 4
    s_cbranch_vccz K5B_POLLED
    s_cmp_lt_u32 s56, 0x40000
    s_cbranch_scc1 K5B_POLL
K5B_POLLED:
    s_mov_b64 exec, -1
K5_POLLB:
    s_barrier
    ds_read_b128 v[88:91], v3 offset:20480
    v_mfma_f32_16x16x32_bf16 v[60:63], v[92:95], v[116:119], v[60:63]
    s_waitcnt lgkmcnt(2)
    v_mfma_f32_16x16x32_bf16 v[64:67], v[80:83], v[112:115], v[64:67]
    ds_read_b128 v[92:95], v3 offset:21504
    v_mfma_f32_16x16x32_bf16 v[68:71], v[80:83], v[116:119], v[68:71]
    s_add_u32 m0, s20, 0
    s_add_u32 s17, s64, 258048
    buffer_load_dwordx4 v1, s[8:11], s17 offen lds
    s_waitcnt lgkmcnt(2)
    v_mfma_f32_16x16x32_bf16 v[72:75], v[84:87], v[112:115], v[72:75]
    ds_read_b128 v[80:83], v3 offset:22528
    v_mfma_f32_16x16x32_bf16 v[76:79], v[84:87], v[116:119], v[76:79]
    s_waitcnt lgkmcnt(2)
    v_mfma_f32_16x16x32_bf16 v[8:11], v[88:91], v[120:123], v[8:11]
    ds_read_b128 v[84:87], v3 offset:23552
    v_mfma_f32_16x16x32_bf16 v[12:15], v[88:91], v[124:127], v[12:15]
    s_add_u32 m0, s20, 8192
    s_add_u32 s17, s64, 266240
    buffer_load_dwordx4 v1, s[8:11], s17 offen lds
    s_waitcnt lgkmcnt(2)
    v_mfma_f32_16x16x32_bf16 v[16:19], v[92:95], v[120:123], v[16:19]
    ds_read_b128 v[88:91], v3 offset:24576
    v_mfma_f32_16x16x32_bf16 v[20:23], v[92:95], v[124:127], v[20:23]
    s_waitcnt lgkmcnt(2)
    v_mfma_f32_16x16x32_bf16 v[24:27], v[80:83], v[120:123], v[24:27]
    ds_read_b128 v[92:95], v3 offset:25600
    v_mfma_f32_16x16x32_bf16 v[28:31], v[80:83], v[124:127], v[28:31]
    s_add_u32 m0, s20, 16384
    s_add_u32 s17, s64, 274432
    buffer_load_dwordx4 v1, s[8:11], s17 offen lds
    s_add_u32 s24, s22, 3072
    buffer_load_dwordx4 v[96:99], v1, s[8:11], s24 offen sc1
    s_add_u32 s24, s23, 3072
    buffer_load_dwordx4 v[100:103], v1, s[8:11], s24 offen sc1
    s_waitcnt lgkmcnt(2)
    v_mfma_f32_16x16x32_bf16 v[32:35], v[84:87], v[120:123], v[32:35]
    ds_read_b128 v[80:83], v3 offset:26624
    v_mfma_f32_16x16x32_bf16 v[36:39], v[84:87], v[124:127], v[36:39]
    s_waitcnt lgkmcnt(2)
    v_mfma_f32_16x16x32_bf16 v[40:43], v[88:91], v[120:123], v[40:43]
    ds_read_b128 v[84:87], v3 offset:27648
    v_mfma_f32_16x16x32_bf16 v[44:47], v[88:91], v[124:127], v[44:47]
    s_add_u32 m0, s20, 24576
    s_add_u32 s17, s64, 282624
    buffer_load_dwordx4 v1, s[8:11], s17 offen lds
    s_waitcnt lgkmcnt(2)
    v_mfma_f32_16x16x32_bf16 v[48:51], v[92:95], v[120:123], v[48:51]
    ds_read_b128 v[88:91], v3 offset:28672
    v_mfma_f32_16x16x32_bf16 v[52:55], v[92:95], v[124:127], v[52:55]
    s_waitcnt lgkmcnt(2)
    v_mfma_f32_16x16x32_bf16 v[56:59], v[80:83], v[120:123], v[56:59]
    ds_read_b128 v[92:95], v3 offset:38912
    v_mfma_f32_16x16x32_bf16 v[60:63], v[80:83], v[124:127], v[60:63]
    s_add_u32 m0, s20, 32768
    s_add_u32 s17, s64, 290816
    buffer_load_dwordx4 v1, s[8:11], s17 offen lds
    s_waitcnt lgkmcnt(2)
    v_mfma_f32_16x16x32_bf16 v[64:67], v[84:87], v[120:123], v[64:67]
    ds_read_b128 v[80:83], v3 offset:39936
    v_mfma_f32_16x16x32_bf16 v[68:71], v[84:87], v[124:127], v[68:71]
    s_waitcnt lgkmcnt(2)
    v_mfma_f32_16x16x32_bf16 v[72:75], v[88:91], v[120:123], v[72:75]
    ds_read_b128 v[84:87], v3 offset:40960
    v_mfma_f32_16x16x32_bf16 v[76:79], v[88:91], v[124:127], v[76:79]
    s_waitcnt lgkmcnt(2)
    v_mfma_f32_16x16x32_bf16 v[8:11], v[92:95], v[128:131], v[8:11]
    ds_read_b128 v[88:91], v3 offset:41984
    v_mfma_f32_16x16x32_bf16 v[12:15], v[92:95], v[132:135], v[12:15]
    s_waitcnt lgkmcnt(2)
    v_mfma_f32_16x16x32_bf16 v[16:19], v[80:83], v[128:131], v[16:19]
    ds_read_b128 v[92:95], v3 offset:43008
    v_mfma_f32_16x16x32_bf16 v[20:23], v[80:83], v[132:135], v[20:23]
    s_waitcnt lgkmcnt(2)
    v_mfma_f32_16x16x32_bf16 v[24:27], v[84:87], v[128:131], v[24:27]
    ds_read_b128 v[80:83], v3 offset:44032
    v_mfma_f32_16x16x32_bf16 v[28:31], v[84:87], v[132:135], v[28:31]
    s_add_u32 s24, s22, 12288
    buffer_load_dwordx4 v[104:107], v1, s[8:11], s24 offen sc1
    s_add_u32 s24, s23, 12288
    buffer_load_dwordx4 v[108:111], v1, s[8:11], s24 offen sc1
    s_waitcnt lgkmcnt(2)
    v_mfma_f32_16x16x32_bf16 v[32:35], v[88:91], v[128:131], v[32:35]
    ds_read_b128 v[84:87], v3 offset:45056
    v_mfma_f32_16x16x32_bf16 v[36:39], v[88:91], v[132:135], v[36:39]
    s_waitcnt lgkmcnt(2)
    v_mfma_f32_16x16x32_bf16 v[40:43], v[92:95], v[128:131], v[40:43]
    ds_read_b128 v[88:91], v3 offset:46080
    v_mfma_f32_16x16x32_bf16 v[44:47], v[92:95], v[132:135], v[44:47]
    s_waitcnt lgkmcnt(2)
    v_mfma_f32_16x16x32_bf16 v[48:51], v[80:83], v[128:131], v[48:51]
    ds_read_b128 v[92:95], v3 offset:47104
    v_mfma_f32_16x16x32_bf16 v[52:55], v[80:83], v[132:135], v[52:55]
    s_waitcnt lgkmcnt(2)
    v_mfma_f32_16x16x32_bf16 v[56:59], v[84:87], v[128:131], v[56:59]
    s_waitcnt vmcnt(11)
    s_barrier
    ds_read_b128 v[80:83], v4 offset:0
    v_mfma_f32_16x16x32_bf16 v[60:63], v[84:87], v[132:135], v[60:63]
    s_waitcnt lgkmcnt(2)
    v_mfma_f32_16x16x32_bf16 v[64:67], v[88:91], v[128:131], v[64:67]
    ds_read_b128 v[84:87], v4 offset:1024
    v_mfma_f32_16x16x32_bf16 v[68:71], v[88:91], v[132:135], v[68:71]
    s_add_u32 m0, s20, 40960
    s_add_u32 s17, s64, 294912
    buffer_load_dwordx4 v1, s[8:11], s17 offen lds
    s_waitcnt lgkmcnt(2)
    v_mfma_f32_16x16x32_bf16 v[72:75], v[92:95], v[128:131], v[72:75]
    ds_read_b128 v[88:91], v4 offset:2048
    v_mfma_f32_16x16x32_bf16 v[76:79], v[92:95], v[132:135], v[76:79]
    s_waitcnt lgkmcnt(2)
    v_mfma_f32_16x16x32_bf16 v[8:11], v[80:83], v[136:139], v[8:11]
    ds_read_b128 v[92:95], v4 offset:3072
    v_mfma_f32_16x16x32_bf16 v[12:15], v[80:83], v[140:143], v[12:15]
    s_add_u32 m0, s20, 49152
    s_add_u32 s17, s64, 303104
    buffer_load_dwordx4 v1, s[8:11], s17 offen lds
    s_waitcnt lgkmcnt(2)
    v_mfma_f32_16x16x32_bf16 v[16:19], v[84:87], v[136:139], v[16:19]
    ds_read_b128 v[80:83], v4 offset:4096
    v_mfma_f32_16x16x32_bf16 v[20:23], v[84:87], v[140:143], v[20:23]
    s_waitcnt lgkmcnt(2)
    v_mfma_f32_16x16x32_bf16 v[24:27], v[88:91], v[136:139], v[24:27]
    ds_read_b128 v[84:87], v4 offset:5120
    v_mfma_f32_16x16x32_bf16 v[28:31], v[88:91], v[140:143], v[28:31]
    s_add_u32 m0, s20, 57344
    s_add_u32 s17, s64, 311296
    buffer_load_dwordx4 v1, s[8:11], s17 offen lds
    s_add_u32 s24, s22, 21504
    buffer_load_dwordx4 v[112:115], v1, s[8:11], s24 offen sc1
    s_add_u32 s24, s23, 21504
    buffer_load_dwordx4 v[116:119], v1, s[8:11], s24 offen sc1
    s_waitcnt lgkmcnt(2)
    v_mfma_f32_16x16x32_bf16 v[32:35], v[92:95], v[136:139], v[32:35]
    ds_read_b128 v[88:91], v4 offset:6144
    v_mfma_f32_16x16x32_bf16 v[36:39], v[92:95], v[140:143], v[36:39]
    s_waitcnt lgkmcnt(2)
    v_mfma_f32_16x16x32_bf16 v[40:43], v[80:83], v[136:139], v[40:43]
    ds_read_b128 v[92:95], v4 offset:7168
    v_mfma_f32_16x16x32_bf16 v[44:47], v[80:83], v[140:143], v[44:47]
    s_add_u32 m0, s20, 65536
    s_add_u32 s17, s64, 319488
    buffer_load_dwordx4 v1, s[8:11], s17 offen lds
    s_waitcnt lgkmcnt(2)
    v_mfma_f32_16x16x32_bf16 v[48:51], v[84:87], v[136:139], v[48:51]
    ds_read_b128 v[80:83], v4 offset:8192
    v_mfma_f32_16x16x32_bf16 v[52:55], v[84:87], v[140:143], v[52:55]
    s_waitcnt lgkmcnt(2)
    v_mfma_f32_16x16x32_bf16 v[56:59], v[88:91], v[136:139], v[56:59]
    ds_read_b128 v[84:87], v4 offset:18432
    v_mfma_f32_16x16x32_bf16 v[60:63], v[88:91], v[140:143], v[60:63]
    s_add_u32 m0, s20, 73728
    s_add_u32 s17, s64, 327680
    buffer_load_dwordx4 v1, s[8:11], s17 offen lds
    s_waitcnt lgkmcnt(2)
    v_mfma_f32_16x16x32_bf16 v[64:67], v[92:95], v[136:139], v[64:67]
    ds_read_b128 v[88:91], v4 offset:19456
    v_mfma_f32_16x16x32_bf16 v[68:71], v[92:95], v[140:143], v[68:71]
    s_waitcnt lgkmcnt(2)
    v_mfma_f32_16x16x32_bf16 v[72:75], v[80:83], v[136:139], v[72:75]
    ds_read_b128 v[92:95], v4 offset:20480
    v_mfma_f32_16x16x32_bf16 v[76:79], v[80:83], v[140:143], v[76:79]
    s_add_u32 s44, s13, s18
    s_mul_i32 s45, s44, 18
    s_lshr_b32 s46, s14, 1
    s_mul_i32 s46, s46, 9
    s_add_u32 s45, s45, s46
    s_lshl_b32 s45, s45, 10
    s_and_b32 s46, s14, 1
    s_lshl_b32 s47, s46, 2
    s_add_u32 s47, s47, s15
    s_lshl_b32 s47, s47, 10
    s_add_u32 s47, s47, s45
    s_lshl_b32 s46, s46, 9
    s_add_u32 s46, s46, s45
    s_add_u32 s46, s46, 8192
    s_mul_i32 s48, s14, 9
    s_lshl_b32 s49, s15, 1
    s_add_u32 s49, s49, s48
    s_add_u32 s48, s48, 8
    s_mul_i32 s50, s44, 18432
    s_lshl_b32 s51, s49, 5
    s_add_u32 s51, s51, s50
    s_lshl_b32 s52, s48, 5
    s_add_u32 s52, s52, s50
    s_and_b32 s53, s12, 3
    s_cmp_lg_u32 s53, s15
    s_cselect_b32 s46, 1073741824, s46
    s_cselect_b32 s52, 1073741824, s52
    v_lshrrev_b32 v6, 4, v0
    v_lshlrev_b32 v184, 4, v6
    v_and_b32 v2, 15, v0
    v_mul_u32_u24 v185, 1152, v2
    v_lshl_add_u32 v186, v6, 3, v185
    v_lshrrev_b32 v2, 1, v6
    v_lshl_add_u32 v185, v2, 4, v185
    v_and_b32 v2, 1, v6
    v_lshl_add_u32 v185, v2, 5, v185
    s_add_u32 s53, s47, 13631488
    buffer_load_dwordx4 v[156:159], v1, s[8:11], s53 offen sc1
    s_add_u32 s53, s46, 13631488
    buffer_load_dwordx2 v[160:161], v5, s[8:11], s53 offen sc1
    s_lshl_b32 s53, s49, 6
    s_add_u32 s53, s53, 11520
    buffer_load_dwordx4 v[164:167], v184, s[8:11], s53 offen
    buffer_load_dwordx4 v[168:171], v184, s[8:11], s53 offen offset:64
    s_lshl_b32 s53, s48, 6
    s_add_u32 s53, s53, 11520
    buffer_load_dwordx4 v[172:175], v184, s[8:11], s53 offen
    s_lshl_b32 s53, s44, 10
    s_add_u32 s53, s53, 19922944
    v_and_b32 v182, 0x300, v1
    v_and_b32 v183, 0x78, v5
    v_add_u32 v182, v182, v183
    buffer_load_dwordx2 v[176:177], v182, s[8:11], s53 offen offset:0 sc1
    buffer_load_dwordx2 v[178:179], v182, s[8:11], s53 offen offset:128 sc1
    s_lshr_b32 s54, s13, 3
    s_lshl_b32 s54, s54, 2
    s_add_u32 s54, s54, s14
    s_lshl_b32 s54, s54, 7
    s_add_u32 s54, s54, 20709376
    s_waitcnt vmcnt(23) lgkmcnt(2)
    v_mfma_f32_16x16x32_bf16 v[8:11], v[84:87], v[144:147], v[8:11]
    ds_read_b128 v[80:83], v4 offset:21504
    v_mfma_f32_16x16x32_bf16 v[12:15], v[84:87], v[148:151], v[12:15]
    s_waitcnt lgkmcnt(2)
    v_mfma_f32_16x16x32_bf16 v[16:19], v[88:91], v[144:147], v[16:19]
    ds_read_b128 v[84:87], v4 offset:22528
    v_mfma_f32_16x16x32_bf16 v[20:23], v[88:91], v[148:151], v[20:23]
    s_waitcnt lgkmcnt(2)
    v_mfma_f32_16x16x32_bf16 v[24:27], v[92:95], v[144:147], v[24:27]
    ds_read_b128 v[88:91], v4 offset:23552
    v_mfma_f32_16x16x32_bf16 v[28:31], v[92:95], v[148:151], v[28:31]
    s_add_u32 s24, s22, 30720
    buffer_load_dwordx4 v[120:123], v1, s[8:11], s24 offen sc1
    s_add_u32 s24, s23, 30720
    buffer_load_dwordx4 v[124:127], v1, s[8:11], s24 offen sc1
    s_waitcnt lgkmcnt(2)
    v_mfma_f32_16x16x32_bf16 v[32:35], v[80:83], v[144:147], v[32:35]
    ds_read_b128 v[92:95], v4 offset:24576
    v_mfma_f32_16x16x32_bf16 v[36:39], v[80:83], v[148:151], v[36:39]
    s_waitcnt lgkmcnt(2)
    v_mfma_f32_16x16x32_bf16 v[40:43], v[84:87], v[144:147], v[40:43]
    ds_read_b128 v[80:83], v4 offset:25600
    v_mfma_f32_16x16x32_bf16 v[44:47], v[84:87], v[148:151], v[44:47]
    s_waitcnt lgkmcnt(2)
    v_mfma_f32_16x16x32_bf16 v[48:51], v[88:91], v[144:147], v[48:51]
    ds_read_b128 v[84:87], v4 offset:26624
    v_mfma_f32_16x16x32_bf16 v[52:55], v[88:91], v[148:151], v[52:55]
    s_waitcnt lgkmcnt(2)
    v_mfma_f32_16x16x32_bf16 v[56:59], v[92:95], v[144:147], v[56:59]
    s_waitcnt vmcnt(18)
    s_barrier
    ds_read_b128 v[88:91], v1 offset:0
    v_mfma_f32_16x16x32_bf16 v[60:63], v[92:95], v[148:151], v[60:63]
    s_waitcnt lgkmcnt(2)
    v_mfma_f32_16x16x32_bf16 v[64:67], v[80:83], v[144:147], v[64:67]
    ds_read_b128 v[92:95], v1 offset:1024
    v_mfma_f32_16x16x32_bf16 v[68:71], v[80:83], v[148:151], v[68:71]
    s_waitcnt lgkmcnt(2)
    v_mfma_f32_16x16x32_bf16 v[72:75], v[84:87], v[144:147], v[72:75]
    ds_read_b128 v[80:83], v1 offset:2048
    v_mfma_f32_16x16x32_bf16 v[76:79], v[84:87], v[148:151], v[76:79]
    s_waitcnt lgkmcnt(2)
    v_mfma_f32_16x16x32_bf16 v[8:11], v[88:91], v[96:99], v[8:11]
    ds_read_b128 v[84:87], v1 offset:3072
    v_mfma_f32_16x16x32_bf16 v[12:15], v[88:91], v[100:103], v[12:15]
    s_waitcnt lgkmcnt(2)
    v_mfma_f32_16x16x32_bf16 v[16:19], v[92:95], v[96:99], v[16:19]
    ds_read_b128 v[88:91], v1 offset:4096
    v_mfma_f32_16x16x32_bf16 v[20:23], v[92:95], v[100:103], v[20:23]
    s_waitcnt lgkmcnt(2)
    v_mfma_f32_16x16x32_bf16 v[24:27], v[80:83], v[96:99], v[24:27]
    ds_read_b128 v[92:95], v1 offset:5120
    v_mfma_f32_16x16x32_bf16 v[28:31], v[80:83], v[100:103], v[28:31]
    s_waitcnt lgkmcnt(2)
    v_mfma_f32_16x16x32_bf16 v[32:35], v[84:87], v[96:99], v[32:35]
    ds_read_b128 v[80:83], v1 offset:6144
    v_mfma_f32_16x16x32_bf16 v[36:39], v[84:87], v[100:103], v[36:39]
    s_waitcnt lgkmcnt(2)
    v_mfma_f32_16x16x32_bf16 v[40:43], v[88:91], v[96:99], v[40:43]
    ds_read_b128 v[84:87], v1 offset:18432
    v_mfma_f32_16x16x32_bf16 v[44:47], v[88:91], v[100:103], v[44:47]
    s_waitcnt lgkmcnt(2)
    v_mfma_f32_16x16x32_bf16 v[48:51], v[92:95], v[96:99], v[48:51]
    ds_read_b128 v[88:91], v1 offset:19456
    v_mfma_f32_16x16x32_bf16 v[52:55], v[92:95], v[100:103], v[52:55]
    s_waitcnt lgkmcnt(2)
    v_mfma_f32_16x16x32_bf16 v[56:59], v[80:83], v[96:99], v[56:59]
    ds_read_b128 v[92:95], v1 offset:20480
    v_mfma_f32_16x16x32_bf16 v[60:63], v[80:83], v[100:103], v[60:63]
    s_waitcnt vmcnt(16) lgkmcnt(2)
    v_mfma_f32_16x16x32_bf16 v[8:11], v[84:87], v[104:107], v[8:11]
    ds_read_b128 v[80:83], v1 offset:21504
    v_mfma_f32_16x16x32_bf16 v[12:15], v[84:87], v[108:111], v[12:15]
    s_waitcnt lgkmcnt(2)
    v_mfma_f32_16x16x32_bf16 v[16:19], v[88:91], v[104:107], v[16:19]
    ds_read_b128 v[84:87], v1 offset:22528
    v_mfma_f32_16x16x32_bf16 v[20:23], v[88:91], v[108:111], v[20:23]
    s_waitcnt lgkmcnt(2)
    v_mfma_f32_16x16x32_bf16 v[24:27], v[92:95], v[104:107], v[24:27]
    ds_read_b128 v[88:91], v1 offset:23552
    v_mfma_f32_16x16x32_bf16 v[28:31], v[92:95], v[108:111], v[28:31]
    s_waitcnt lgkmcnt(2)
    v_mfma_f32_16x16x32_bf16 v[32:35], v[80:83], v[104:107], v[32:35]
    ds_read_b128 v[92:95], v1 offset:24576
    v_mfma_f32_16x16x32_bf16 v[36:39], v[80:83], v[108:111], v[36:39]
    s_waitcnt lgkmcnt(2)
    v_mfma_f32_16x16x32_bf16 v[40:43], v[84:87], v[104:107], v[40:43]
    s_waitcnt vmcnt(9)
    s_barrier
    ds_read_b128 v[80:83], v1 offset:40960
    v_mfma_f32_16x16x32_bf16 v[44:47], v[84:87], v[108:111], v[44:47]
    s_waitcnt lgkmcnt(2)
    v_mfma_f32_16x16x32_bf16 v[48:51], v[88:91], v[104:107], v[48:51]
    ds_read_b128 v[84:87], v3 offset:2048
    v_mfma_f32_16x16x32_bf16 v[52:55], v[88:91], v[108:111], v[52:55]
    s_waitcnt lgkmcnt(2)
    v_mfma_f32_16x16x32_bf16 v[56:59], v[92:95], v[104:107], v[56:59]
    ds_read_b128 v[88:91], v1 offset:41984
    v_mfma_f32_16x16x32_bf16 v[60:63], v[92:95], v[108:111], v[60:63]
    s_waitcnt lgkmcnt(2)
    v_mfma_f32_16x16x32_bf16 v[8:11], v[80:83], v[112:115], v[8:11]
    ds_read_b128 v[92:95], v3 offset:3072
    v_mfma_f32_16x16x32_bf16 v[12:15], v[80:83], v[116:119], v[12:15]
    s_waitcnt vmcnt(0) lgkmcnt(2)
    v_mfma_f32_16x16x32_bf16 v[8:11], v[84:87], v[120:123], v[8:11]
    ds_read_b128 v[80:83], v1 offset:43008
    v_mfma_f32_16x16x32_bf16 v[12:15], v[84:87], v[124:127], v[12:15]
    s_waitcnt lgkmcnt(2)
    v_mfma_f32_16x16x32_bf16 v[16:19], v[88:91], v[112:115], v[16:19]
    ds_read_b128 v[84:87], v3 offset:4096
    v_mfma_f32_16x16x32_bf16 v[20:23], v[88:91], v[116:119], v[20:23]
    s_waitcnt lgkmcnt(2)
    v_mfma_f32_16x16x32_bf16 v[16:19], v[92:95], v[120:123], v[16:19]
    ds_read_b128 v[88:91], v1 offset:44032
    v_mfma_f32_16x16x32_bf16 v[20:23], v[92:95], v[124:127], v[20:23]
    s_waitcnt lgkmcnt(2)
    v_mfma_f32_16x16x32_bf16 v[24:27], v[80:83], v[112:115], v[24:27]
    ds_read_b128 v[92:95], v3 offset:5120
    v_mfma_f32_16x16x32_bf16 v[28:31], v[80:83], v[116:119], v[28:31]
    s_waitcnt lgkmcnt(2)
    v_mfma_f32_16x16x32_bf16 v[24:27], v[84:87], v[120:123], v[24:27]
    ds_read_b128 v[80:83], v1 offset:45056
    v_mfma_f32_16x16x32_bf16 v[28:31], v[84:87], v[124:127], v[28:31]
    ds_write_b128 v152, v[12:15] offset:0
    s_waitcnt lgkmcnt(3)
    v_mfma_f32_16x16x32_bf16 v[32:35], v[88:91], v[112:115], v[32:35]
    ds_read_b128 v[84:87], v3 offset:6144
    v_mfma_f32_16x16x32_bf16 v[36:39], v[88:91], v[116:119], v[36:39]
    s_waitcnt lgkmcnt(3)
    v_mfma_f32_16x16x32_bf16 v[32:35], v[92:95], v[120:123], v[32:35]
    ds_read_b128 v[88:91], v1 offset:46080
    v_mfma_f32_16x16x32_bf16 v[36:39], v[92:95], v[124:127], v[36:39]
    ds_write_b128 v152, v[20:23] offset:1024
    s_waitcnt lgkmcnt(4)
    v_mfma_f32_16x16x32_bf16 v[40:43], v[80:83], v[112:115], v[40:43]
    ds_read_b128 v[92:95], v3 offset:7168
    v_mfma_f32_16x16x32_bf16 v[44:47], v[80:83], v[116:119], v[44:47]
    s_waitcnt lgkmcnt(3)
    v_mfma_f32_16x16x32_bf16 v[40:43], v[84:87], v[120:123], v[40:43]
    ds_read_b128 v[80:83], v1 offset:47104
    v_mfma_f32_16x16x32_bf16 v[44:47], v[84:87], v[124:127], v[44:47]
    ds_write_b128 v152, v[28:31] offset:2048
    s_waitcnt lgkmcnt(4)
    v_mfma_f32_16x16x32_bf16 v[48:51], v[88:91], v[112:115], v[48:51]
    ds_read_b128 v[84:87], v3 offset:8192
    v_mfma_f32_16x16x32_bf16 v[52:55], v[88:91], v[116:119], v[52:55]
    s_waitcnt lgkmcnt(3)
    v_mfma_f32_16x16x32_bf16 v[48:51], v[92:95], v[120:123], v[48:51]
    ds_read_b128 v[88:91], v1 offset:7168
    v_mfma_f32_16x16x32_bf16 v[52:55], v[92:95], v[124:127], v[52:55]
    ds_write_b128 v152, v[36:39] offset:3072
    s_waitcnt lgkmcnt(4)
    v_mfma_f32_16x16x32_bf16 v[56:59], v[80:83], v[112:115], v[56:59]
    ds_read_b128 v[92:95], v1 offset:8192
    v_mfma_f32_16x16x32_bf16 v[60:63], v[80:83], v[116:119], v[60:63]
    s_waitcnt lgkmcnt(3)
    v_mfma_f32_16x16x32_bf16 v[56:59], v[84:87], v[120:123], v[56:59]
    ds_read_b128 v[80:83], v1 offset:25600
    v_mfma_f32_16x16x32_bf16 v[60:63], v[84:87], v[124:127], v[60:63]
    ds_write_b128 v152, v[44:47] offset:4096
    ds_write_b128 v152, v[52:55] offset:5120
    s_nop 5
    ds_write_b128 v152, v[60:63] offset:6144
    s_waitcnt lgkmcnt(0)
    s_barrier
    ds_read_b128 v[200:203], v153 offset:0
    ds_read_b128 v[204:207], v153 offset:1024
    ds_read_b128 v[208:211], v153 offset:2048
    ds_read_b128 v[212:215], v153 offset:3072
    ds_read_b128 v[216:219], v153 offset:4096
    ds_read_b128 v[220:223], v153 offset:5120
    ds_read_b128 v[224:227], v153 offset:6144
    s_waitcnt lgkmcnt(6)
    v_pk_add_f32 v[8:9], v[8:9], v[200:201]
    v_pk_add_f32 v[10:11], v[10:11], v[202:203]
    v_cvt_pk_bf16_f32 v12, v8, v9
    v_cvt_pk_bf16_f32 v13, v10, v11
    s_waitcnt lgkmcnt(5)
    v_pk_add_f32 v[16:17], v[16:17], v[204:205]
    v_pk_add_f32 v[18:19], v[18:19], v[206:207]
    v_cvt_pk_bf16_f32 v14, v16, v17
    v_cvt_pk_bf16_f32 v15, v18, v19
    buffer_store_dwordx4 v[12:15], v1, s[8:11], s30 offen sc1
    s_waitcnt lgkmcnt(4)
    v_pk_add_f32 v[24:25], v[24:25], v[208:209]
    v_pk_add_f32 v[26:27], v[26:27], v[210:211]
    v_cvt_pk_bf16_f32 v28, v24, v25
    v_cvt_pk_bf16_f32 v29, v26, v27
    s_waitcnt lgkmcnt(3)
    v_pk_add_f32 v[32:33], v[32:33], v[212:213]
    v_pk_add_f32 v[34:35], v[34:35], v[214:215]
    v_cvt_pk_bf16_f32 v30, v32, v33
    v_cvt_pk_bf16_f32 v31, v34, v35
    buffer_store_dwordx4 v[28:31], v1, s[8:11], s31 offen sc1
    s_waitcnt lgkmcnt(2)
    v_pk_add_f32 v[40:41], v[40:41], v[216:217]
    v_pk_add_f32 v[42:43], v[42:43], v[218:219]
    v_cvt_pk_bf16_f32 v44, v40, v41
    v_cvt_pk_bf16_f32 v45, v42, v43
    s_waitcnt lgkmcnt(1)
    v_pk_add_f32 v[48:49], v[48:49], v[220:221]
    v_pk_add_f32 v[50:51], v[50:51], v[222:223]
    v_cvt_pk_bf16_f32 v46, v48, v49
    v_cvt_pk_bf16_f32 v47, v50, v51
    buffer_store_dwordx4 v[44:47], v1, s[8:11], s32 offen sc1
    s_waitcnt lgkmcnt(0)
    v_pk_add_f32 v[56:57], v[56:57], v[224:225]
    v_pk_add_f32 v[58:59], v[58:59], v[226:227]
    v_cvt_pk_bf16_f32 v60, v56, v57
    v_cvt_pk_bf16_f32 v61, v58, v59
    buffer_store_dwordx2 v[60:61], v5, s[8:11], s36 offen sc1
    v_mfma_f32_16x16x32_bf16 v[64:67], v[88:91], v[96:99], v[64:67]
    ds_read_b128 v[84:87], v1 offset:26624
    v_mfma_f32_16x16x32_bf16 v[68:71], v[88:91], v[100:103], v[68:71]
    v_mfma_f32_16x16x32_bf16 v[72:75], v[92:95], v[96:99], v[72:75]
    ds_read_b128 v[88:91], v1 offset:48128
    v_mfma_f32_16x16x32_bf16 v[76:79], v[92:95], v[100:103], v[76:79]
    v_mfma_f32_16x16x32_bf16 v[64:67], v[80:83], v[104:107], v[64:67]
    ds_read_b128 v[92:95], v1 offset:49152
    v_mfma_f32_16x16x32_bf16 v[68:71], v[80:83], v[108:111], v[68:71]
    s_waitcnt lgkmcnt(2)
    v_mfma_f32_16x16x32_bf16 v[72:75], v[84:87], v[104:107], v[72:75]
    ds_read_b128 v[80:83], v3 offset:9216
    v_mfma_f32_16x16x32_bf16 v[76:79], v[84:87], v[108:111], v[76:79]
    s_waitcnt lgkmcnt(2)
    v_mfma_f32_16x16x32_bf16 v[64:67], v[88:91], v[112:115], v[64:67]
    ds_read_b128 v[84:87], v3 offset:10240
    v_mfma_f32_16x16x32_bf16 v[68:71], v[88:91], v[116:119], v[68:71]
    s_waitcnt lgkmcnt(2)
    v_mfma_f32_16x16x32_bf16 v[72:75], v[92:95], v[112:115], v[72:75]
    v_mfma_f32_16x16x32_bf16 v[76:79], v[92:95], v[116:119], v[76:79]
    s_waitcnt lgkmcnt(1)
    v_mfma_f32_16x16x32_bf16 v[64:67], v[80:83], v[120:123], v[64:67]
    v_mfma_f32_16x16x32_bf16 v[68:71], v[80:83], v[124:127], v[68:71]
    s_waitcnt lgkmcnt(0)
    v_mfma_f32_16x16x32_bf16 v[72:75], v[84:87], v[120:123], v[72:75]
    v_mfma_f32_16x16x32_bf16 v[76:79], v[84:87], v[124:127], v[76:79]
    s_nop 4
    ds_write_b128 v152, v[68:71] offset:7168
    s_nop 1
    ds_write_b128 v152, v[76:79] offset:8192
    v_mov_b32 v188, v64
    v_mov_b32 v189, v65
    v_mov_b32 v190, v66
    v_mov_b32 v191, v67
    v_mov_b32 v192, v72
    v_mov_b32 v193, v73
    v_mov_b32 v194, v74
    v_mov_b32 v195, v75
    s_branch K6_TAIL
K6_P1:
    s_add_u32 s24, s22, 1024
    buffer_load_dwordx4 v[96:99], v1, s[8:11], s24 offen sc1
    s_add_u32 s24, s23, 1024
    buffer_load_dwordx4 v[100:103], v1, s[8:11], s24 offen sc1
    s_add_u32 s24, s22, 4096
    buffer_load_dwordx4 v[104:107], v1, s[8:11], s24 offen sc1
    s_add_u32 s24, s23, 4096
    buffer_load_dwordx4 v[108:111], v1, s[8:11], s24 offen sc1
    s_add_u32 s24, s22, 6144
    buffer_load_dwordx4 v[112:115], v1, s[8:11], s24 offen sc1
    s_add_u32 s24, s23, 6144
    buffer_load_dwordx4 v[116:119], v1, s[8:11], s24 offen sc1
    ds_read_b128 v[80:83], v1 offset:50176
    ds_read_b128 v[84:87], v1 offset:51200
    ds_read_b128 v[88:91], v1 offset:52224
    s_waitcnt vmcnt(4) lgkmcnt(2)
    v_mfma_f32_16x16x32_bf16 v[8:11], v[80:83], v[96:99], 0
    ds_read_b128 v[92:95], v1 offset:53248
    v_mfma_f32_16x16x32_bf16 v[12:15], v[80:83], v[100:103], 0
    s_add_u32 s24, s22, 9216
    buffer_load_dwordx4 v[120:123], v1, s[8:11], s24 offen sc1
    s_add_u32 s24, s23, 9216
    buffer_load_dwordx4 v[124:127], v1, s[8:11], s24 offen sc1
    s_waitcnt lgkmcnt(2)
    v_mfma_f32_16x16x32_bf16 v[16:19], v[84:87], v[96:99], 0
    ds_read_b128 v[80:83], v1 offset:54272
    v_mfma_f32_16x16x32_bf16 v[20:23], v[84:87], v[100:103], 0
    s_add_u32 m0, s20, 114688
    s_add_u32 s17, s64, 73728
    buffer_load_dwordx4 v1, s[8:11], s17 offen lds
    s_waitcnt lgkmcnt(2)
    v_mfma_f32_16x16x32_bf16 v[24:27], v[88:91], v[96:99], 0
    ds_read_b128 v[84:87], v1 offset:55296
    v_mfma_f32_16x16x32_bf16 v[28:31], v[88:91], v[100:103], 0
    s_add_u32 m0, s20, 122880
    s_add_u32 s17, s64, 81920
    buffer_load_dwordx4 v1, s[8:11], s17 offen lds
    s_waitcnt lgkmcnt(2)
    v_mfma_f32_16x16x32_bf16 v[32:35], v[92:95], v[96:99], 0
    ds_read_b128 v[88:91], v1 offset:56320
    v_mfma_f32_16x16x32_bf16 v[36:39], v[92:95], v[100:103], 0
    s_add_u32 m0, s20, 131072
    s_add_u32 s17, s64, 90112
    buffer_load_dwordx4 v1, s[8:11], s17 offen lds
    s_waitcnt lgkmcnt(2)
    v_mfma_f32_16x16x32_bf16 v[40:43], v[80:83], v[96:99], 0
    ds_read_b128 v[92:95], v3 offset:0
    v_mfma_f32_16x16x32_bf16 v[44:47], v[80:83], v[100:103], 0
    s_add_u32 m0, s20, 139264
    s_add_u32 s17, s64, 98304
    buffer_load_dwordx4 v1, s[8:11], s17 offen lds
    s_waitcnt lgkmcnt(2)
    v_mfma_f32_16x16x32_bf16 v[48:51], v[84:87], v[96:99], 0
    ds_read_b128 v[80:83], v3 offset:1024
    v_mfma_f32_16x16x32_bf16 v[52:55], v[84:87], v[100:103], 0
    s_add_u32 s24, s22, 11264
    buffer_load_dwordx4 v[128:131], v1, s[8:11], s24 offen sc1
    s_add_u32 s24, s23, 11264
    buffer_load_dwordx4 v[132:135], v1, s[8:11], s24 offen sc1
    s_waitcnt lgkmcnt(2)
    v_mfma_f32_16x16x32_bf16 v[56:59], v[88:91], v[96:99], 0
    ds_read_b128 v[84:87], v3 offset:11264
    v_mfma_f32_16x16x32_bf16 v[60:63], v[88:91], v[100:103], 0
    s_add_u32 s24, s22, 14336
    buffer_load_dwordx4 v[136:139], v1, s[8:11], s24 offen sc1
    s_add_u32 s24, s23, 14336
    buffer_load_dwordx4 v[140:143], v1, s[8:11], s24 offen sc1
    s_waitcnt lgkmcnt(2)
    v_mfma_f32_16x16x32_bf16 v[64:67], v[92:95], v[96:99], 0
    ds_read_b128 v[88:91], v3 offset:12288
    v_mfma_f32_16x16x32_bf16 v[68:71], v[92:95], v[100:103], 0
    s_add_u32 m0, s20, 0
    s_add_u32 s17, s64, 110592
    buffer_load_dwordx4 v1, s[8:11], s17 offen lds
    s_waitcnt lgkmcnt(2)
    v_mfma_f32_16x16x32_bf16 v[72:75], v[80:83], v[96:99], 0
    ds_read_b128 v[92:95], v3 offset:13312
    v_mfma_f32_16x16x32_bf16 v[76:79], v[80:83], v[100:103], 0
    s_add_u32 m0, s20, 8192
    s_add_u32 s17, s64, 118784
    buffer_load_dwordx4 v1, s[8:11], s17 offen lds
    s_waitcnt vmcnt(14) lgkmcnt(2)
    v_mfma_f32_16x16x32_bf16 v[8:11], v[84:87], v[104:107], v[8:11]
    ds_read_b128 v[80:83], v3 offset:14336
    v_mfma_f32_16x16x32_bf16 v[12:15], v[84:87], v[108:111], v[12:15]
    s_add_u32 m0, s20, 16384
    s_add_u32 s17, s64, 126976
    buffer_load_dwordx4 v1, s[8:11], s17 offen lds
    s_waitcnt lgkmcnt(2)
    v_mfma_f32_16x16x32_bf16 v[16:19], v[88:91], v[104:107], v[16:19]
    ds_read_b128 v[84:87], v3 offset:15360
    v_mfma_f32_16x16x32_bf16 v[20:23], v[88:91], v[108:111], v[20:23]
    s_add_u32 m0, s20, 24576
    s_add_u32 s17, s64, 135168
    buffer_load_dwordx4 v1, s[8:11], s17 offen lds
    s_waitcnt lgkmcnt(2)
    v_mfma_f32_16x16x32_bf16 v[24:27], v[92:95], v[104:107], v[24:27]
    ds_read_b128 v[88:91], v3 offset:16384
    v_mfma_f32_16x16x32_bf16 v[28:31], v[92:95], v[108:111], v[28:31]
    s_waitcnt lgkmcnt(2)
    v_mfma_f32_16x16x32_bf16 v[32:35], v[80:83], v[104:107], v[32:35]
    ds_read_b128 v[92:95], v3 offset:17408
    v_mfma_f32_16x16x32_bf16 v[36:39], v[80:83], v[108:111], v[36:39]
    s_waitcnt lgkmcnt(2)
    v_mfma_f32_16x16x32_bf16 v[40:43], v[84:87], v[104:107], v[40:43]
    ds_read_b128 v[80:83], v3 offset:18432
    v_mfma_f32_16x16x32_bf16 v[44:47], v[84:87], v[108:111], v[44:47]
    s_waitcnt lgkmcnt(2)
    v_mfma_f32_16x16x32_bf16 v[48:51], v[88:91], v[104:107], v[48:51]
    ds_read_b128 v[84:87], v3 offset:19456
    v_mfma_f32_16x16x32_bf16 v[52:55], v[88:91], v[108:111], v[52:55]
    s_waitcnt lgkmcnt(2)
    v_mfma_f32_16x16x32_bf16 v[56:59], v[92:95], v[104:107], v[56:59]
    s_barrier
    ds_read_b128 v[88:91], v3 offset:29696
    v_mfma_f32_16x16x32_bf16 v[60:63], v[92:95], v[108:111], v[60:63]
    s_add_u32 s24, s22, 17408
    buffer_load_dwordx2 v[144:145], v5, s[8:11], s24 offen offset:0 sc1
    buffer_load_dwordx2 v[146:147], v5, s[8:11], s24 offen offset:512 sc1
    s_add_u32 s24, s23, 17408
    buffer_load_dwordx2 v[148:149], v5, s[8:11], s24 offen offset:0 sc1
    buffer_load_dwordx2 v[150:151], v5, s[8:11], s24 offen offset:512 sc1
    s_waitcnt lgkmcnt(2)
    v_mfma_f32_16x16x32_bf16 v[64:67], v[80:83], v[104:107], v[64:67]
    ds_read_b128 v[92:95], v3 offset:30720
    v_mfma_f32_16x16x32_bf16 v[68:71], v[80:83], v[108:111], v[68:71]
    s_waitcnt lgkmcnt(2)
    v_mfma_f32_16x16x32_bf16 v[72:75], v[84:87], v[104:107], v[72:75]
    ds_read_b128 v[80:83], v3 offset:31744
    v_mfma_f32_16x16x32_bf16 v[76:79], v[84:87], v[108:111], v[76:79]
    s_waitcnt vmcnt(18) lgkmcnt(2)
    v_mfma_f32_16x16x32_bf16 v[8:11], v[88:91], v[112:115], v[8:11]
    ds_read_b128 v[84:87], v3 offset:32768
    v_mfma_f32_16x16x32_bf16 v[12:15], v[88:91], v[116:119], v[12:15]
    s_waitcnt lgkmcnt(2)
    v_mfma_f32_16x16x32_bf16 v[16:19], v[92:95], v[112:115], v[16:19]
    ds_read_b128 v[88:91], v3 offset:33792
    v_mfma_f32_16x16x32_bf16 v[20:23], v[92:95], v[116:119], v[20:23]
    s_waitcnt lgkmcnt(2)
    v_mfma_f32_16x16x32_bf16 v[24:27], v[80:83], v[112:115], v[24:27]
    ds_read_b128 v[92:95], v3 offset:34816
    v_mfma_f32_16x16x32_bf16 v[28:31], v[80:83], v[116:119], v[28:31]
    s_waitcnt lgkmcnt(2)
    v_mfma_f32_16x16x32_bf16 v[32:35], v[84:87], v[112:115], v[32:35]
    ds_read_b128 v[80:83], v3 offset:35840
    v_mfma_f32_16x16x32_bf16 v[36:39], v[84:87], v[116:119], v[36:39]
    s_waitcnt lgkmcnt(2)
    v_mfma_f32_16x16x32_bf16 v[40:43], v[88:91], v[112:115], v[40:43]
    ds_read_b128 v[84:87], v3 offset:36864
    v_mfma_f32_16x16x32_bf16 v[44:47], v[88:91], v[116:119], v[44:47]
    s_waitcnt lgkmcnt(2)
    v_mfma_f32_16x16x32_bf16 v[48:51], v[92:95], v[112:115], v[48:51]
    ds_read_b128 v[88:91], v3 offset:37888
    v_mfma_f32_16x16x32_bf16 v[52:55], v[92:95], v[116:119], v[52:55]
    s_waitcnt lgkmcnt(2)
    v_mfma_f32_16x16x32_bf16 v[56:59], v[80:83], v[112:115], v[56:59]
    ds_read_b128 v[92:95], v3 offset:48128
    v_mfma_f32_16x16x32_bf16 v[60:63], v[80:83], v[116:119], v[60:63]
    s_add_u32 s24, s22, 19456
    buffer_load_dwordx4 v[96:99], v1, s[8:11], s24 offen sc1
    s_add_u32 s24, s23, 19456
    buffer_load_dwordx4 v[100:103], v1, s[8:11], s24 offen sc1
    s_waitcnt lgkmcnt(2)
    v_mfma_f32_16x16x32_bf16 v[64:67], v[84:87], v[112:115], v[64:67]
    ds_read_b128 v[80:83], v3 offset:49152
    v_mfma_f32_16x16x32_bf16 v[68:71], v[84:87], v[116:119], v[68:71]
    s_waitcnt lgkmcnt(2)
    v_mfma_f32_16x16x32_bf16 v[72:75], v[88:91], v[112:115], v[72:75]
    ds_read_b128 v[84:87], v3 offset:50176
    v_mfma_f32_16x16x32_bf16 v[76:79], v[88:91], v[116:119], v[76:79]
    s_waitcnt vmcnt(18) lgkmcnt(2)
    v_mfma_f32_16x16x32_bf16 v[8:11], v[92:95], v[120:123], v[8:11]
    ds_read_b128 v[88:91], v3 offset:51200
    v_mfma_f32_16x16x32_bf16 v[12:15], v[92:95], v[124:127], v[12:15]
    s_waitcnt lgkmcnt(2)
    v_mfma_f32_16x16x32_bf16 v[16:19], v[80:83], v[120:123], v[16:19]
    ds_read_b128 v[92:95], v3 offset:52224
    v_mfma_f32_16x16x32_bf16 v[20:23], v[80:83], v[124:127], v[20:23]
    s_waitcnt lgkmcnt(2)
    v_mfma_f32_16x16x32_bf16 v[24:27], v[84:87], v[120:123], v[24:27]
    ds_read_b128 v[80:83], v3 offset:53248
    v_mfma_f32_16x16x32_bf16 v[28:31], v[84:87], v[124:127], v[28:31]
    s_waitcnt lgkmcnt(2)
    v_mfma_f32_16x16x32_bf16 v[32:35], v[88:91], v[120:123], v[32:35]
    ds_read_b128 v[84:87], v3 offset:54272
    v_mfma_f32_16x16x32_bf16 v[36:39], v[88:91], v[124:127], v[36:39]
    s_waitcnt lgkmcnt(2)
    v_mfma_f32_16x16x32_bf16 v[40:43], v[92:95], v[120:123], v[40:43]
    ds_read_b128 v[88:91], v3 offset:55296
    v_mfma_f32_16x16x32_bf16 v[44:47], v[92:95], v[124:127], v[44:47]
    s_waitcnt lgkmcnt(2)
    v_mfma_f32_16x16x32_bf16 v[48:51], v[80:83], v[120:123], v[48:51]
    ds_read_b128 v[92:95], v3 offset:56320
    v_mfma_f32_16x16x32_bf16 v[52:55], v[80:83], v[124:127], v[52:55]
    s_waitcnt lgkmcnt(2)
    v_mfma_f32_16x16x32_bf16 v[56:59], v[84:87], v[120:123], v[56:59]
    s_waitcnt vmcnt(14)
    s_barrier
    ds_read_b128 v[80:83], v4 offset:9216
    v_mfma_f32_16x16x32_bf16 v[60:63], v[84:87], v[124:127], v[60:63]
    s_add_u32 s24, s22, 22528
    buffer_load_dwordx4 v[104:107], v1, s[8:11], s24 offen sc1
    s_add_u32 s24, s23, 22528
    buffer_load_dwordx4 v[108:111], v1, s[8:11], s24 offen sc1
    s_waitcnt lgkmcnt(2)
    v_mfma_f32_16x16x32_bf16 v[64:67], v[88:91], v[120:123], v[64:67]
    ds_read_b128 v[84:87], v4 offset:10240
    v_mfma_f32_16x16x32_bf16 v[68:71], v[88:91], v[124:127], v[68:71]
    s_add_u32 m0, s20, 40960
    s_add_u32 s17, s64, 147456
    buffer_load_dwordx4 v1, s[8:11], s17 offen lds
    s_waitcnt lgkmcnt(2)
    v_mfma_f32_16x16x32_bf16 v[72:75], v[92:95], v[120:123], v[72:75]
    ds_read_b128 v[88:91], v4 offset:11264
    v_mfma_f32_16x16x32_bf16 v[76:79], v[92:95], v[124:127], v[76:79]
    s_waitcnt vmcnt(15) lgkmcnt(2)
    v_mfma_f32_16x16x32_bf16 v[8:11], v[80:83], v[128:131], v[8:11]
    ds_read_b128 v[92:95], v4 offset:12288
    v_mfma_f32_16x16x32_bf16 v[12:15], v[80:83], v[132:135], v[12:15]
    s_add_u32 m0, s20, 49152
    s_add_u32 s17, s64, 155648
    buffer_load_dwordx4 v1, s[8:11], s17 offen lds
    s_waitcnt lgkmcnt(2)
    v_mfma_f32_16x16x32_bf16 v[16:19], v[84:87], v[128:131], v[16:19]
    ds_read_b128 v[80:83], v4 offset:13312
    v_mfma_f32_16x16x32_bf16 v[20:23], v[84:87], v[132:135], v[20:23]
    s_waitcnt lgkmcnt(2)
    v_mfma_f32_16x16x32_bf16 v[24:27], v[88:91], v[128:131], v[24:27]
    ds_read_b128 v[84:87], v4 offset:14336
    v_mfma_f32_16x16x32_bf16 v[28:31], v[88:91], v[132:135], v[28:31]
    s_add_u32 m0, s20, 57344
    s_add_u32 s17, s64, 163840
    buffer_load_dwordx4 v1, s[8:11], s17 offen lds
    s_waitcnt lgkmcnt(2)
    v_mfma_f32_16x16x32_bf16 v[32:35], v[92:95], v[128:131], v[32:35]
    ds_read_b128 v[88:91], v4 offset:15360
    v_mfma_f32_16x16x32_bf16 v[36:39], v[92:95], v[132:135], v[36:39]
    s_waitcnt lgkmcnt(2)
    v_mfma_f32_16x16x32_bf16 v[40:43], v[80:83], v[128:131], v[40:43]
    ds_read_b128 v[92:95], v4 offset:16384
    v_mfma_f32_16x16x32_bf16 v[44:47], v[80:83], v[132:135], v[44:47]
    s_add_u32 m0, s20, 65536
    s_add_u32 s17, s64, 172032
    buffer_load_dwordx4 v1, s[8:11], s17 offen lds
    s_waitcnt lgkmcnt(2)
    v_mfma_f32_16x16x32_bf16 v[48:51], v[84:87], v[128:131], v[48:51]
    ds_read_b128 v[80:83], v4 offset:17408
    v_mfma_f32_16x16x32_bf16 v[52:55], v[84:87], v[132:135], v[52:55]
    s_waitcnt lgkmcnt(2)
    v_mfma_f32_16x16x32_bf16 v[56:59], v[88:91], v[128:131], v[56:59]
    ds_read_b128 v[84:87], v4 offset:27648
    v_mfma_f32_16x16x32_bf16 v[60:63], v[88:91], v[132:135], v[60:63]
    s_add_u32 s24, s22, 24576
    buffer_load_dwordx4 v[112:115], v1, s[8:11], s24 offen sc1
    s_add_u32 s24, s23, 24576
    buffer_load_dwordx4 v[116:119], v1, s[8:11], s24 offen sc1
    s_waitcnt lgkmcnt(2)
    v_mfma_f32_16x16x32_bf16 v[64:67], v[92:95], v[128:131], v[64:67]
    ds_read_b128 v[88:91], v4 offset:28672
    v_mfma_f32_16x16x32_bf16 v[68:71], v[92:95], v[132:135], v[68:71]
    s_waitcnt lgkmcnt(2)
    v_mfma_f32_16x16x32_bf16 v[72:75], v[80:83], v[128:131], v[72:75]
    ds_read_b128 v[92:95], v4 offset:29696
    v_mfma_f32_16x16x32_bf16 v[76:79], v[80:83], v[132:135], v[76:79]
    s_waitcnt vmcnt(18) lgkmcnt(2)
    v_mfma_f32_16x16x32_bf16 v[8:11], v[84:87], v[136:139], v[8:11]
    ds_read_b128 v[80:83], v4 offset:30720
    v_mfma_f32_16x16x32_bf16 v[12:15], v[84:87], v[140:143], v[12:15]
    s_waitcnt lgkmcnt(2)
    v_mfma_f32_16x16x32_bf16 v[16:19], v[88:91], v[136:139], v[16:19]
    ds_read_b128 v[84:87], v4 offset:31744
    v_mfma_f32_16x16x32_bf16 v[20:23], v[88:91], v[140:143], v[20:23]
    s_waitcnt lgkmcnt(2)
    v_mfma_f32_16x16x32_bf16 v[24:27], v[92:95], v[136:139], v[24:27]
    ds_read_b128 v[88:91], v4 offset:32768
    v_mfma_f32_16x16x32_bf16 v[28:31], v[92:95], v[140:143], v[28:31]
    s_waitcnt lgkmcnt(2)
    v_mfma_f32_16x16x32_bf16 v[32:35], v[80:83], v[136:139], v[32:35]
    ds_read_b128 v[92:95], v4 offset:33792
    v_mfma_f32_16x16x32_bf16 v[36:39], v[80:83], v[140:143], v[36:39]
    s_waitcnt lgkmcnt(2)
    v_mfma_f32_16x16x32_bf16 v[40:43], v[84:87], v[136:139], v[40:43]
    ds_read_b128 v[80:83], v4 offset:34816
    v_mfma_f32_16x16x32_bf16 v[44:47], v[84:87], v[140:143], v[44:47]
    s_waitcnt lgkmcnt(2)
    v_mfma_f32_16x16x32_bf16 v[48:51], v[88:91], v[136:139], v[48:51]
    ds_read_b128 v[84:87], v4 offset:35840
    v_mfma_f32_16x16x32_bf16 v[52:55], v[88:91], v[140:143], v[52:55]
    s_waitcnt lgkmcnt(2)
    v_mfma_f32_16x16x32_bf16 v[56:59], v[92:95], v[136:139], v[56:59]
    s_waitcnt vmcnt(14)
    s_barrier
    ds_read_b128 v[88:91], v1 offset:9216
    v_mfma_f32_16x16x32_bf16 v[60:63], v[92:95], v[140:143], v[60:63]
    s_add_u32 s24, s22, 27648
    buffer_load_dwordx4 v[120:123], v1, s[8:11], s24 offen sc1
    s_add_u32 s24, s23, 27648
    buffer_load_dwordx4 v[124:127], v1, s[8:11], s24 offen sc1
    s_waitcnt lgkmcnt(2)
    v_mfma_f32_16x16x32_bf16 v[64:67], v[80:83], v[136:139], v[64:67]
    ds_read_b128 v[92:95], v1 offset:10240
    v_mfma_f32_16x16x32_bf16 v[68:71], v[80:83], v[140:143], v[68:71]
    s_add_u32 m0, s20, 77824
    s_add_u32 s17, s64, 184320
    buffer_load_dwordx4 v1, s[8:11], s17 offen lds
    s_waitcnt lgkmcnt(2)
    v_mfma_f32_16x16x32_bf16 v[72:75], v[84:87], v[136:139], v[72:75]
    ds_read_b128 v[80:83], v1 offset:11264
    v_mfma_f32_16x16x32_bf16 v[76:79], v[84:87], v[140:143], v[76:79]
    s_waitcnt vmcnt(13) lgkmcnt(2)
    v_mfma_f32_16x16x32_bf16 v[8:11], v[88:91], v[144:147], v[8:11]
    ds_read_b128 v[84:87], v1 offset:12288
    v_mfma_f32_16x16x32_bf16 v[12:15], v[88:91], v[148:151], v[12:15]
    s_add_u32 m0, s20, 86016
    s_add_u32 s17, s64, 192512
    buffer_load_dwordx4 v1, s[8:11], s17 offen lds
    s_waitcnt lgkmcnt(2)
    v_mfma_f32_16x16x32_bf16 v[16:19], v[92:95], v[144:147], v[16:19]
    ds_read_b128 v[88:91], v1 offset:13312
    v_mfma_f32_16x16x32_bf16 v[20:23], v[92:95], v[148:151], v[20:23]
    s_waitcnt lgkmcnt(2)
    v_mfma_f32_16x16x32_bf16 v[24:27], v[80:83], v[144:147], v[24:27]
    ds_read_b128 v[92:95], v1 offset:14336
    v_mfma_f32_16x16x32_bf16 v[28:31], v[80:83], v[148:151], v[28:31]
    s_add_u32 m0, s20, 94208
    s_add_u32 s17, s64, 200704
    buffer_load_dwordx4 v1, s[8:11], s17 offen lds
    s_waitcnt lgkmcnt(2)
    v_mfma_f32_16x16x32_bf16 v[32:35], v[84:87], v[144:147], v[32:35]
    ds_read_b128 v[80:83], v1 offset:15360
    v_mfma_f32_16x16x32_bf16 v[36:39], v[84:87], v[148:151], v[36:39]
    s_waitcnt lgkmcnt(2)
    v_mfma_f32_16x16x32_bf16 v[40:43], v[88:91], v[144:147], v[40:43]
    ds_read_b128 v[84:87], v1 offset:16384
    v_mfma_f32_16x16x32_bf16 v[44:47], v[88:91], v[148:151], v[44:47]
    s_add_u32 m0, s20, 102400
    s_add_u32 s17, s64, 208896
    buffer_load_dwordx4 v1, s[8:11], s17 offen lds
    s_waitcnt lgkmcnt(2)
    v_mfma_f32_16x16x32_bf16 v[48:51], v[92:95], v[144:147], v[48:51]
    ds_read_b128 v[88:91], v1 offset:17408
    v_mfma_f32_16x16x32_bf16 v[52:55], v[92:95], v[148:151], v[52:55]
    s_waitcnt lgkmcnt(2)
    v_mfma_f32_16x16x32_bf16 v[56:59], v[80:83], v[144:147], v[56:59]
    ds_read_b128 v[92:95], v1 offset:27648
    v_mfma_f32_16x16x32_bf16 v[60:63], v[80:83], v[148:151], v[60:63]
    s_add_u32 s24, s22, 29696
    buffer_load_dwordx4 v[128:131], v1, s[8:11], s24 offen sc1
    s_add_u32 s24, s23, 29696
    buffer_load_dwordx4 v[132:135], v1, s[8:11], s24 offen sc1
    s_waitcnt lgkmcnt(2)
    v_mfma_f32_16x16x32_bf16 v[64:67], v[84:87], v[144:147], v[64:67]
    ds_read_b128 v[80:83], v1 offset:28672
    v_mfma_f32_16x16x32_bf16 v[68:71], v[84:87], v[148:151], v[68:71]
    s_waitcnt lgkmcnt(2)
    v_mfma_f32_16x16x32_bf16 v[72:75], v[88:91], v[144:147], v[72:75]
    ds_read_b128 v[84:87], v1 offset:29696
    v_mfma_f32_16x16x32_bf16 v[76:79], v[88:91], v[148:151], v[76:79]
    s_waitcnt vmcnt(16) lgkmcnt(2)
    v_mfma_f32_16x16x32_bf16 v[8:11], v[92:95], v[96:99], v[8:11]
    ds_read_b128 v[88:91], v1 offset:30720
    v_mfma_f32_16x16x32_bf16 v[12:15], v[92:95], v[100:103], v[12:15]
    s_waitcnt lgkmcnt(2)
    v_mfma_f32_16x16x32_bf16 v[16:19], v[80:83], v[96:99], v[16:19]
    ds_read_b128 v[92:95], v1 offset:31744
    v_mfma_f32_16x16x32_bf16 v[20:23], v[80:83], v[100:103], v[20:23]
    s_waitcnt lgkmcnt(2)
    v_mfma_f32_16x16x32_bf16 v[24:27], v[84:87], v[96:99], v[24:27]
    ds_read_b128 v[80:83], v1 offset:32768
    v_mfma_f32_16x16x32_bf16 v[28:31], v[84:87], v[100:103], v[28:31]
    s_waitcnt lgkmcnt(2)
    v_mfma_f32_16x16x32_bf16 v[32:35], v[88:91], v[96:99], v[32:35]
    ds_read_b128 v[84:87], v1 offset:33792
    v_mfma_f32_16x16x32_bf16 v[36:39], v[88:91], v[100:103], v[36:39]
    s_waitcnt lgkmcnt(2)
    v_mfma_f32_16x16x32_bf16 v[40:43], v[92:95], v[96:99], v[40:43]
    ds_read_b128 v[88:91], v1 offset:34816
    v_mfma_f32_16x16x32_bf16 v[44:47], v[92:95], v[100:103], v[44:47]
    s_waitcnt lgkmcnt(2)
    v_mfma_f32_16x16x32_bf16 v[48:51], v[80:83], v[96:99], v[48:51]
    ds_read_b128 v[92:95], v1 offset:35840
    v_mfma_f32_16x16x32_bf16 v[52:55], v[80:83], v[100:103], v[52:55]
    s_waitcnt lgkmcnt(2)
    v_mfma_f32_16x16x32_bf16 v[56:59], v[84:87], v[96:99], v[56:59]
    s_waitcnt vmcnt(10)
    s_barrier
    ds_read_b128 v[80:83], v1 offset:50176
    v_mfma_f32_16x16x32_bf16 v[60:63], v[84:87], v[100:103], v[60:63]
    s_add_u32 s24, s22, 32768
    buffer_load_dwordx4 v[136:139], v1, s[8:11], s24 offen sc1
    s_add_u32 s24, s23, 32768
    buffer_load_dwordx4 v[140:143], v1, s[8:11], s24 offen sc1
    s_waitcnt lgkmcnt(2)
    v_mfma_f32_16x16x32_bf16 v[64:67], v[88:91], v[96:99], v[64:67]
    ds_read_b128 v[84:87], v1 offset:51200
    v_mfma_f32_16x16x32_bf16 v[68:71], v[88:91], v[100:103], v[68:71]
    s_add_u32 m0, s20, 114688
    s_add_u32 s17, s64, 221184
    buffer_load_dwordx4 v1, s[8:11], s17 offen lds
    s_waitcnt lgkmcnt(2)
    v_mfma_f32_16x16x32_bf16 v[72:75], v[92:95], v[96:99], v[72:75]
    ds_read_b128 v[88:91], v1 offset:52224
    v_mfma_f32_16x16x32_bf16 v[76:79], v[92:95], v[100:103], v[76:79]
    s_waitcnt lgkmcnt(2)
    v_mfma_f32_16x16x32_bf16 v[8:11], v[80:83], v[104:107], v[8:11]
    ds_read_b128 v[92:95], v1 offset:53248
    v_mfma_f32_16x16x32_bf16 v[12:15], v[80:83], v[108:111], v[12:15]
    s_add_u32 m0, s20, 122880
    s_add_u32 s17, s64, 229376
    buffer_load_dwordx4 v1, s[8:11], s17 offen lds
    s_waitcnt lgkmcnt(2)
    v_mfma_f32_16x16x32_bf16 v[16:19], v[84:87], v[104:107], v[16:19]
    ds_read_b128 v[80:83], v1 offset:54272
    v_mfma_f32_16x16x32_bf16 v[20:23], v[84:87], v[108:111], v[20:23]
    s_waitcnt lgkmcnt(2)
    v_mfma_f32_16x16x32_bf16 v[24:27], v[88:91], v[104:107], v[24:27]
    ds_read_b128 v[84:87], v1 offset:55296
    v_mfma_f32_16x16x32_bf16 v[28:31], v[88:91], v[108:111], v[28:31]
    s_add_u32 m0, s20, 131072
    s_add_u32 s17, s64, 237568
    buffer_load_dwordx4 v1, s[8:11], s17 offen lds
    s_waitcnt lgkmcnt(2)
    v_mfma_f32_16x16x32_bf16 v[32:35], v[92:95], v[104:107], v[32:35]
    ds_read_b128 v[88:91], v1 offset:56320
    v_mfma_f32_16x16x32_bf16 v[36:39], v[92:95], v[108:111], v[36:39]
    s_waitcnt lgkmcnt(2)
    v_mfma_f32_16x16x32_bf16 v[40:43], v[80:83], v[104:107], v[40:43]
    ds_read_b128 v[92:95], v3 offset:0
    v_mfma_f32_16x16x32_bf16 v[44:47], v[80:83], v[108:111], v[44:47]
    s_add_u32 m0, s20, 139264
    s_add_u32 s17, s64, 245760
    buffer_load_dwordx4 v1, s[8:11], s17 offen lds
    s_waitcnt lgkmcnt(2)
    v_mfma_f32_16x16x32_bf16 v[48:51], v[84:87], v[104:107], v[48:51]
    ds_read_b128 v[80:83], v3 offset:1024
    v_mfma_f32_16x16x32_bf16 v[52:55], v[84:87], v[108:111], v[52:55]
    s_waitcnt lgkmcnt(2)
    v_mfma_f32_16x16x32_bf16 v[56:59], v[88:91], v[104:107], v[56:59]
    ds_read_b128 v[84:87], v3 offset:11264
    v_mfma_f32_16x16x32_bf16 v[60:63], v[88:91], v[108:111], v[60:63]
    s_add_u32 s24, s22, 35840
    buffer_load_dwordx2 v[144:145], v5, s[8:11], s24 offen offset:0 sc1
    buffer_load_dwordx2 v[146:147], v5, s[8:11], s24 offen offset:512 sc1
    s_add_u32 s24, s23, 35840
    buffer_load_dwordx2 v[148:149], v5, s[8:11], s24 offen offset:0 sc1
    buffer_load_dwordx2 v[150:151], v5, s[8:11], s24 offen offset:512 sc1
    s_waitcnt lgkmcnt(2)
    v_mfma_f32_16x16x32_bf16 v[64:67], v[92:95], v[104:107], v[64:67]
    ds_read_b128 v[88:91], v3 offset:12288
    v_mfma_f32_16x16x32_bf16 v[68:71], v[92:95], v[108:111], v[68:71]
    s_waitcnt lgkmcnt(2)
    v_mfma_f32_16x16x32_bf16 v[72:75], v[80:83], v[104:107], v[72:75]
    ds_read_b128 v[92:95], v3 offset:13312
    v_mfma_f32_16x16x32_bf16 v[76:79], v[80:83], v[108:111], v[76:79]
    s_waitcnt vmcnt(18) lgkmcnt(2)
    v_mfma_f32_16x16x32_bf16 v[8:11], v[84:87], v[112:115], v[8:11]
    ds_read_b128 v[80:83], v3 offset:14336
    v_mfma_f32_16x16x32_bf16 v[12:15], v[84:87], v[116:119], v[12:15]
    s_waitcnt lgkmcnt(2)
    v_mfma_f32_16x16x32_bf16 v[16:19], v[88:91], v[112:115], v[16:19]
    ds_read_b128 v[84:87], v3 offset:15360
    v_mfma_f32_16x16x32_bf16 v[20:23], v[88:91], v[116:119], v[20:23]
    s_waitcnt lgkmcnt(2)
    v_mfma_f32_16x16x32_bf16 v[24:27], v[92:95], v[112:115], v[24:27]
    ds_read_b128 v[88:91], v3 offset:16384
    v_mfma_f32_16x16x32_bf16 v[28:31], v[92:95], v[116:119], v[28:31]
    s_waitcnt lgkmcnt(2)
    v_mfma_f32_16x16x32_bf16 v[32:35], v[80:83], v[112:115], v[32:35]
    ds_read_b128 v[92:95], v3 offset:17408
    v_mfma_f32_16x16x32_bf16 v[36:39], v[80:83], v[116:119], v[36:39]
    s_waitcnt lgkmcnt(2)
    v_mfma_f32_16x16x32_bf16 v[40:43], v[84:87], v[112:115], v[40:43]
    ds_read_b128 v[80:83], v3 offset:18432
    v_mfma_f32_16x16x32_bf16 v[44:47], v[84:87], v[116:119], v[44:47]
    s_waitcnt lgkmcnt(2)
    v_mfma_f32_16x16x32_bf16 v[48:51], v[88:91], v[112:115], v[48:51]
    ds_read_b128 v[84:87], v3 offset:19456
    v_mfma_f32_16x16x32_bf16 v[52:55], v[88:91], v[116:119], v[52:55]
    s_waitcnt lgkmcnt(2)
    v_mfma_f32_16x16x32_bf16 v[56:59], v[92:95], v[112:115], v[56:59]
    s_waitcnt vmcnt(12)
    s_barrier
    ds_read_b128 v[88:91], v3 offset:29696
    v_mfma_f32_16x16x32_bf16 v[60:63], v[92:95], v[116:119], v[60:63]
    s_waitcnt lgkmcnt(2)
    v_mfma_f32_16x16x32_bf16 v[64:67], v[80:83], v[112:115], v[64:67]
    ds_read_b128 v[92:95], v3 offset:30720
    v_mfma_f32_16x16x32_bf16 v[68:71], v[80:83], v[116:119], v[68:71]
    s_add_u32 m0, s20, 0
    s_add_u32 s17, s64, 258048
    buffer_load_dwordx4 v1, s[8:11], s17 offen lds
    s_waitcnt lgkmcnt(2)
    v_mfma_f32_16x16x32_bf16 v[72:75], v[84:87], v[112:115], v[72:75]
    ds_read_b128 v[80:83], v3 offset:31744
    v_mfma_f32_16x16x32_bf16 v[76:79], v[84:87], v[116:119], v[76:79]
    s_waitcnt lgkmcnt(2)
    v_mfma_f32_16x16x32_bf16 v[8:11], v[88:91], v[120:123], v[8:11]
    ds_read_b128 v[84:87], v3 offset:32768
    v_mfma_f32_16x16x32_bf16 v[12:15], v[88:91], v[124:127], v[12:15]
    s_add_u32 m0, s20, 8192
    s_add_u32 s17, s64, 266240
    buffer_load_dwordx4 v1, s[8:11], s17 offen lds
    s_waitcnt lgkmcnt(2)
    v_mfma_f32_16x16x32_bf16 v[16:19], v[92:95], v[120:123], v[16:19]
    ds_read_b128 v[88:91], v3 offset:33792
    v_mfma_f32_16x16x32_bf16 v[20:23], v[92:95], v[124:127], v[20:23]
    s_waitcnt lgkmcnt(2)
    v_mfma_f32_16x16x32_bf16 v[24:27], v[80:83], v[120:123], v[24:27]
    ds_read_b128 v[92:95], v3 offset:34816
    v_mfma_f32_16x16x32_bf16 v[28:31], v[80:83], v[124:127], v[28:31]
    s_add_u32 m0, s20, 16384
    s_add_u32 s17, s64, 274432
    buffer_load_dwordx4 v1, s[8:11], s17 offen lds
    s_add_u32 s24, s22, 7168
    buffer_load_dwordx4 v[96:99], v1, s[8:11], s24 offen sc1
    s_add_u32 s24, s23, 7168
    buffer_load_dwordx4 v[100:103], v1, s[8:11], s24 offen sc1
    s_waitcnt lgkmcnt(2)
    v_mfma_f32_16x16x32_bf16 v[32:35], v[84:87], v[120:123], v[32:35]
    ds_read_b128 v[80:83], v3 offset:35840
    v_mfma_f32_16x16x32_bf16 v[36:39], v[84:87], v[124:127], v[36:39]
    s_waitcnt lgkmcnt(2)
    v_mfma_f32_16x16x32_bf16 v[40:43], v[88:91], v[120:123], v[40:43]
    ds_read_b128 v[84:87], v3 offset:36864
    v_mfma_f32_16x16x32_bf16 v[44:47], v[88:91], v[124:127], v[44:47]
    s_add_u32 m0, s20, 24576
    s_add_u32 s17, s64, 282624
    buffer_load_dwordx4 v1, s[8:11], s17 offen lds
    s_waitcnt lgkmcnt(2)
    v_mfma_f32_16x16x32_bf16 v[48:51], v[92:95], v[120:123], v[48:51]
    ds_read_b128 v[88:91], v3 offset:37888
    v_mfma_f32_16x16x32_bf16 v[52:55], v[92:95], v[124:127], v[52:55]
    s_waitcnt lgkmcnt(2)
    v_mfma_f32_16x16x32_bf16 v[56:59], v[80:83], v[120:123], v[56:59]
    ds_read_b128 v[92:95], v3 offset:48128
    v_mfma_f32_16x16x32_bf16 v[60:63], v[80:83], v[124:127], v[60:63]
    s_waitcnt lgkmcnt(2)
    v_mfma_f32_16x16x32_bf16 v[64:67], v[84:87], v[120:123], v[64:67]
    ds_read_b128 v[80:83], v3 offset:49152
    v_mfma_f32_16x16x32_bf16 v[68:71], v[84:87], v[124:127], v[68:71]
    s_waitcnt lgkmcnt(2)
    v_mfma_f32_16x16x32_bf16 v[72:75], v[88:91], v[120:123], v[72:75]
    ds_read_b128 v[84:87], v3 offset:50176
    v_mfma_f32_16x16x32_bf16 v[76:79], v[88:91], v[124:127], v[76:79]
    s_waitcnt vmcnt(16) lgkmcnt(2)
    v_mfma_f32_16x16x32_bf16 v[8:11], v[92:95], v[128:131], v[8:11]
    ds_read_b128 v[88:91], v3 offset:51200
    v_mfma_f32_16x16x32_bf16 v[12:15], v[92:95], v[132:135], v[12:15]
    s_waitcnt lgkmcnt(2)
    v_mfma_f32_16x16x32_bf16 v[16:19], v[80:83], v[128:131], v[16:19]
    ds_read_b128 v[92:95], v3 offset:52224
    v_mfma_f32_16x16x32_bf16 v[20:23], v[80:83], v[132:135], v[20:23]
    s_waitcnt lgkmcnt(2)
    v_mfma_f32_16x16x32_bf16 v[24:27], v[84:87], v[128:131], v[24:27]
    ds_read_b128 v[80:83], v3 offset:53248
    v_mfma_f32_16x16x32_bf16 v[28:31], v[84:87], v[132:135], v[28:31]
    s_add_u32 s24, s22, 16384
    buffer_load_dwordx4 v[104:107], v1, s[8:11], s24 offen sc1
    s_add_u32 s24, s23, 16384
    buffer_load_dwordx4 v[108:111], v1, s[8:11], s24 offen sc1
    s_waitcnt lgkmcnt(2)
    v_mfma_f32_16x16x32_bf16 v[32:35], v[88:91], v[128:131], v[32:35]
    ds_read_b128 v[84:87], v3 offset:54272
    v_mfma_f32_16x16x32_bf16 v[36:39], v[88:91], v[132:135], v[36:39]
    s_waitcnt lgkmcnt(2)
    v_mfma_f32_16x16x32_bf16 v[40:43], v[92:95], v[128:131], v[40:43]
    ds_read_b128 v[88:91], v3 offset:55296
    v_mfma_f32_16x16x32_bf16 v[44:47], v[92:95], v[132:135], v[44:47]
    s_waitcnt lgkmcnt(2)
    v_mfma_f32_16x16x32_bf16 v[48:51], v[80:83], v[128:131], v[48:51]
    ds_read_b128 v[92:95], v3 offset:56320
    v_mfma_f32_16x16x32_bf16 v[52:55], v[80:83], v[132:135], v[52:55]
    s_waitcnt lgkmcnt(2)
    v_mfma_f32_16x16x32_bf16 v[56:59], v[84:87], v[128:131], v[56:59]
    s_waitcnt vmcnt(12)
    s_barrier
    ds_read_b128 v[80:83], v4 offset:9216
    v_mfma_f32_16x16x32_bf16 v[60:63], v[84:87], v[132:135], v[60:63]
    s_waitcnt lgkmcnt(2)
    v_mfma_f32_16x16x32_bf16 v[64:67], v[88:91], v[128:131], v[64:67]
    ds_read_b128 v[84:87], v4 offset:10240
    v_mfma_f32_16x16x32_bf16 v[68:71], v[88:91], v[132:135], v[68:71]
    s_add_u32 m0, s20, 40960
    s_add_u32 s17, s64, 294912
    buffer_load_dwordx4 v1, s[8:11], s17 offen lds
    s_waitcnt lgkmcnt(2)
    v_mfma_f32_16x16x32_bf16 v[72:75], v[92:95], v[128:131], v[72:75]
    ds_read_b128 v[88:91], v4 offset:11264
    v_mfma_f32_16x16x32_bf16 v[76:79], v[92:95], v[132:135], v[76:79]
    s_waitcnt lgkmcnt(2)
    v_mfma_f32_16x16x32_bf16 v[8:11], v[80:83], v[136:139], v[8:11]
    ds_read_b128 v[92:95], v4 offset:12288
    v_mfma_f32_16x16x32_bf16 v[12:15], v[80:83], v[140:143], v[12:15]
    s_add_u32 m0, s20, 49152
    s_add_u32 s17, s64, 303104
    buffer_load_dwordx4 v1, s[8:11], s17 offen lds
    s_waitcnt lgkmcnt(2)
    v_mfma_f32_16x16x32_bf16 v[16:19], v[84:87], v[136:139], v[16:19]
    ds_read_b128 v[80:83], v4 offset:13312
    v_mfma_f32_16x16x32_bf16 v[20:23], v[84:87], v[140:143], v[20:23]
    s_waitcnt lgkmcnt(2)
    v_mfma_f32_16x16x32_bf16 v[24:27], v[88:91], v[136:139], v[24:27]
    ds_read_b128 v[84:87], v4 offset:14336
    v_mfma_f32_16x16x32_bf16 v[28:31], v[88:91], v[140:143], v[28:31]
    s_add_u32 m0, s20, 57344
    s_add_u32 s17, s64, 311296
    buffer_load_dwordx4 v1, s[8:11], s17 offen lds
    s_add_u32 s24, s22, 25600
    buffer_load_dwordx4 v[112:115], v1, s[8:11], s24 offen sc1
    s_add_u32 s24, s23, 25600
    buffer_load_dwordx4 v[116:119], v1, s[8:11], s24 offen sc1
    s_waitcnt lgkmcnt(2)
    v_mfma_f32_16x16x32_bf16 v[32:35], v[92:95], v[136:139], v[32:35]
    ds_read_b128 v[88:91], v4 offset:15360
    v_mfma_f32_16x16x32_bf16 v[36:39], v[92:95], v[140:143], v[36:39]
    s_waitcnt lgkmcnt(2)
    v_mfma_f32_16x16x32_bf16 v[40:43], v[80:83], v[136:139], v[40:43]
    ds_read_b128 v[92:95], v4 offset:16384
    v_mfma_f32_16x16x32_bf16 v[44:47], v[80:83], v[140:143], v[44:47]
    s_add_u32 m0, s20, 65536
    s_add_u32 s17, s64, 319488
    buffer_load_dwordx4 v1, s[8:11], s17 offen lds
    s_waitcnt lgkmcnt(2)
    v_mfma_f32_16x16x32_bf16 v[48:51], v[84:87], v[136:139], v[48:51]
    ds_read_b128 v[80:83], v4 offset:17408
    v_mfma_f32_16x16x32_bf16 v[52:55], v[84:87], v[140:143], v[52:55]
    s_waitcnt lgkmcnt(2)
    v_mfma_f32_16x16x32_bf16 v[56:59], v[88:91], v[136:139], v[56:59]
    ds_read_b128 v[84:87], v4 offset:27648
    v_mfma_f32_16x16x32_bf16 v[60:63], v[88:91], v[140:143], v[60:63]
    s_waitcnt lgkmcnt(2)
    v_mfma_f32_16x16x32_bf16 v[64:67], v[92:95], v[136:139], v[64:67]
    ds_read_b128 v[88:91], v4 offset:28672
    v_mfma_f32_16x16x32_bf16 v[68:71], v[92:95], v[140:143], v[68:71]
    s_waitcnt lgkmcnt(2)
    v_mfma_f32_16x16x32_bf16 v[72:75], v[80:83], v[136:139], v[72:75]
    ds_read_b128 v[92:95], v4 offset:29696
    v_mfma_f32_16x16x32_bf16 v[76:79], v[80:83], v[140:143], v[76:79]
    s_add_u32 s44, s13, s18
    s_mul_i32 s45, s44, 18
    s_lshr_b32 s46, s14, 1
    s_mul_i32 s46, s46, 9
    s_add_u32 s45, s45, s46
    s_lshl_b32 s45, s45, 10
    s_and_b32 s46, s14, 1
    s_lshl_b32 s47, s46, 2
    s_add_u32 s47, s47, s15
    s_lshl_b32 s47, s47, 10
    s_add_u32 s47, s47, s45
    s_lshl_b32 s46, s46, 9
    s_add_u32 s46, s46, s45
    s_add_u32 s46, s46, 8192
    s_mul_i32 s48, s14, 9
    s_lshl_b32 s49, s15, 1
    s_add_u32 s49, s49, s48
    s_add_u32 s48, s48, 8
    s_mul_i32 s50, s44, 18432
    s_lshl_b32 s51, s49, 5
    s_add_u32 s51, s51, s50
    s_lshl_b32 s52, s48, 5
    s_add_u32 s52, s52, s50
    s_and_b32 s53, s12, 3
    s_cmp_lg_u32 s53, s15
    s_cselect_b32 s46, 1073741824, s46
    s_cselect_b32 s52, 1073741824, s52
    v_lshrrev_b32 v6, 4, v0
    v_lshlrev_b32 v184, 4, v6
    v_and_b32 v2, 15, v0
    v_mul_u32_u24 v185, 1152, v2
    v_lshl_add_u32 v186, v6, 3, v185
    v_lshrrev_b32 v2, 1, v6
    v_lshl_add_u32 v185, v2, 4, v185
    v_and_b32 v2, 1, v6
    v_lshl_add_u32 v185, v2, 5, v185
    s_add_u32 s53, s47, 13631488
    buffer_load_dwordx4 v[156:159], v1, s[8:11], s53 offen sc1
    s_add_u32 s53, s46, 13631488
    buffer_load_dwordx2 v[160:161], v5, s[8:11], s53 offen sc1
    s_lshl_b32 s53, s49, 6
    s_add_u32 s53, s53, 11520
    buffer_load_dwordx4 v[164:167], v184, s[8:11], s53 offen
    buffer_load_dwordx4 v[168:171], v184, s[8:11], s53 offen offset:64
    s_lshl_b32 s53, s48, 6
    s_add_u32 s53, s53, 11520
    buffer_load_dwordx4 v[172:175], v184, s[8:11], s53 offen
    s_lshl_b32 s53, s44, 10
    s_add_u32 s53, s53, 19922944
    v_and_b32 v182, 0x300, v1
    v_and_b32 v183, 0x78, v5
    v_add_u32 v182, v182, v183
    buffer_load_dwordx2 v[176:177], v182, s[8:11], s53 offen offset:0 sc1
    buffer_load_dwordx2 v[178:179], v182, s[8:11], s53 offen offset:128 sc1
    s_lshr_b32 s54, s13, 3
    s_lshl_b32 s54, s54, 2
    s_add_u32 s54, s54, s14
    s_lshl_b32 s54, s54, 7
    s_add_u32 s54, s54, 20709376
    s_waitcnt vmcnt(21) lgkmcnt(2)
    v_mfma_f32_16x16x32_bf16 v[8:11], v[84:87], v[144:147], v[8:11]
    ds_read_b128 v[80:83], v4 offset:30720
    v_mfma_f32_16x16x32_bf16 v[12:15], v[84:87], v[148:151], v[12:15]
    s_waitcnt lgkmcnt(2)
    v_mfma_f32_16x16x32_bf16 v[16:19], v[88:91], v[144:147], v[16:19]
    ds_read_b128 v[84:87], v4 offset:31744
    v_mfma_f32_16x16x32_bf16 v[20:23], v[88:91], v[148:151], v[20:23]
    s_waitcnt lgkmcnt(2)
    v_mfma_f32_16x16x32_bf16 v[24:27], v[92:95], v[144:147], v[24:27]
    ds_read_b128 v[88:91], v4 offset:32768
    v_mfma_f32_16x16x32_bf16 v[28:31], v[92:95], v[148:151], v[28:31]
    s_add_u32 s24, s22, 34816
    buffer_load_dwordx4 v[120:123], v1, s[8:11], s24 offen sc1
    s_add_u32 s24, s23, 34816
    buffer_load_dwordx4 v[124:127], v1, s[8:11], s24 offen sc1
    s_waitcnt lgkmcnt(2)
    v_mfma_f32_16x16x32_bf16 v[32:35], v[80:83], v[144:147], v[32:35]
    ds_read_b128 v[92:95], v4 offset:33792
    v_mfma_f32_16x16x32_bf16 v[36:39], v[80:83], v[148:151], v[36:39]
    s_waitcnt lgkmcnt(2)
    v_mfma_f32_16x16x32_bf16 v[40:43], v[84:87], v[144:147], v[40:43]
    ds_read_b128 v[80:83], v4 offset:34816
    v_mfma_f32_16x16x32_bf16 v[44:47], v[84:87], v[148:151], v[44:47]
    s_waitcnt lgkmcnt(2)
    v_mfma_f32_16x16x32_bf16 v[48:51], v[88:91], v[144:147], v[48:51]
    ds_read_b128 v[84:87], v4 offset:35840
    v_mfma_f32_16x16x32_bf16 v[52:55], v[88:91], v[148:151], v[52:55]
    s_waitcnt lgkmcnt(2)
    v_mfma_f32_16x16x32_bf16 v[56:59], v[92:95], v[144:147], v[56:59]
    s_waitcnt vmcnt(17)
    s_barrier
    ds_read_b128 v[88:91], v1 offset:9216
    v_mfma_f32_16x16x32_bf16 v[60:63], v[92:95], v[148:151], v[60:63]
    s_waitcnt lgkmcnt(2)
    v_mfma_f32_16x16x32_bf16 v[64:67], v[80:83], v[144:147], v[64:67]
    ds_read_b128 v[92:95], v1 offset:10240
    v_mfma_f32_16x16x32_bf16 v[68:71], v[80:83], v[148:151], v[68:71]
    s_waitcnt lgkmcnt(2)
    v_mfma_f32_16x16x32_bf16 v[72:75], v[84:87], v[144:147], v[72:75]
    ds_read_b128 v[80:83], v1 offset:11264
    v_mfma_f32_16x16x32_bf16 v[76:79], v[84:87], v[148:151], v[76:79]
    s_waitcnt lgkmcnt(2)
    v_mfma_f32_16x16x32_bf16 v[8:11], v[88:91], v[96:99], v[8:11]
    ds_read_b128 v[84:87], v1 offset:12288
    v_mfma_f32_16x16x32_bf16 v[12:15], v[88:91], v[100:103], v[12:15]
    s_waitcnt lgkmcnt(2)
    v_mfma_f32_16x16x32_bf16 v[16:19], v[92:95], v[96:99], v[16:19]
    ds_read_b128 v[88:91], v1 offset:13312
    v_mfma_f32_16x16x32_bf16 v[20:23], v[92:95], v[100:103], v[20:23]
    s_waitcnt lgkmcnt(2)
    v_mfma_f32_16x16x32_bf16 v[24:27], v[80:83], v[96:99], v[24:27]
    ds_read_b128 v[92:95], v1 offset:14336
    v_mfma_f32_16x16x32_bf16 v[28:31], v[80:83], v[100:103], v[28:31]
    s_waitcnt lgkmcnt(2)
    v_mfma_f32_16x16x32_bf16 v[32:35], v[84:87], v[96:99], v[32:35]
    ds_read_b128 v[80:83], v1 offset:15360
    v_mfma_f32_16x16x32_bf16 v[36:39], v[84:87], v[100:103], v[36:39]
    s_waitcnt lgkmcnt(2)
    v_mfma_f32_16x16x32_bf16 v[40:43], v[88:91], v[96:99], v[40:43]
    ds_read_b128 v[84:87], v1 offset:27648
    v_mfma_f32_16x16x32_bf16 v[44:47], v[88:91], v[100:103], v[44:47]
    s_waitcnt lgkmcnt(2)
    v_mfma_f32_16x16x32_bf16 v[48:51], v[92:95], v[96:99], v[48:51]
    ds_read_b128 v[88:91], v1 offset:28672
    v_mfma_f32_16x16x32_bf16 v[52:55], v[92:95], v[100:103], v[52:55]
    s_waitcnt lgkmcnt(2)
    v_mfma_f32_16x16x32_bf16 v[56:59], v[80:83], v[96:99], v[56:59]
    ds_read_b128 v[92:95], v1 offset:29696
    v_mfma_f32_16x16x32_bf16 v[60:63], v[80:83], v[100:103], v[60:63]
    s_waitcnt vmcnt(15) lgkmcnt(2)
    v_mfma_f32_16x16x32_bf16 v[8:11], v[84:87], v[104:107], v[8:11]
    ds_read_b128 v[80:83], v1 offset:30720
    v_mfma_f32_16x16x32_bf16 v[12:15], v[84:87], v[108:111], v[12:15]
    s_waitcnt lgkmcnt(2)
    v_mfma_f32_16x16x32_bf16 v[16:19], v[88:91], v[104:107], v[16:19]
    ds_read_b128 v[84:87], v1 offset:31744
    v_mfma_f32_16x16x32_bf16 v[20:23], v[88:91], v[108:111], v[20:23]
    s_waitcnt lgkmcnt(2)
    v_mfma_f32_16x16x32_bf16 v[24:27], v[92:95], v[104:107], v[24:27]
    ds_read_b128 v[88:91], v1 offset:32768
    v_mfma_f32_16x16x32_bf16 v[28:31], v[92:95], v[108:111], v[28:31]
    s_waitcnt lgkmcnt(2)
    v_mfma_f32_16x16x32_bf16 v[32:35], v[80:83], v[104:107], v[32:35]
    ds_read_b128 v[92:95], v1 offset:33792
    v_mfma_f32_16x16x32_bf16 v[36:39], v[80:83], v[108:111], v[36:39]
    s_waitcnt lgkmcnt(2)
    v_mfma_f32_16x16x32_bf16 v[40:43], v[84:87], v[104:107], v[40:43]
    s_waitcnt vmcnt(9)
    s_barrier
    ds_read_b128 v[80:83], v1 offset:50176
    v_mfma_f32_16x16x32_bf16 v[44:47], v[84:87], v[108:111], v[44:47]
    s_waitcnt lgkmcnt(2)
    v_mfma_f32_16x16x32_bf16 v[48:51], v[88:91], v[104:107], v[48:51]
    ds_read_b128 v[84:87], v3 offset:11264
    v_mfma_f32_16x16x32_bf16 v[52:55], v[88:91], v[108:111], v[52:55]
    s_waitcnt lgkmcnt(2)
    v_mfma_f32_16x16x32_bf16 v[56:59], v[92:95], v[104:107], v[56:59]
    ds_read_b128 v[88:91], v1 offset:51200
    v_mfma_f32_16x16x32_bf16 v[60:63], v[92:95], v[108:111], v[60:63]
    s_waitcnt lgkmcnt(2)
    v_mfma_f32_16x16x32_bf16 v[8:11], v[80:83], v[112:115], v[8:11]
    ds_read_b128 v[92:95], v3 offset:12288
    v_mfma_f32_16x16x32_bf16 v[12:15], v[80:83], v[116:119], v[12:15]
    s_waitcnt vmcnt(0) lgkmcnt(2)
    v_mfma_f32_16x16x32_bf16 v[8:11], v[84:87], v[120:123], v[8:11]
    ds_read_b128 v[80:83], v1 offset:52224
    v_mfma_f32_16x16x32_bf16 v[12:15], v[84:87], v[124:127], v[12:15]
    s_waitcnt lgkmcnt(2)
    v_mfma_f32_16x16x32_bf16 v[16:19], v[88:91], v[112:115], v[16:19]
    ds_read_b128 v[84:87], v3 offset:13312
    v_mfma_f32_16x16x32_bf16 v[20:23], v[88:91], v[116:119], v[20:23]
    s_waitcnt lgkmcnt(2)
    v_mfma_f32_16x16x32_bf16 v[16:19], v[92:95], v[120:123], v[16:19]
    ds_read_b128 v[88:91], v1 offset:53248
    v_mfma_f32_16x16x32_bf16 v[20:23], v[92:95], v[124:127], v[20:23]
    s_waitcnt lgkmcnt(2)
    v_mfma_f32_16x16x32_bf16 v[24:27], v[80:83], v[112:115], v[24:27]
    ds_read_b128 v[92:95], v3 offset:14336
    v_mfma_f32_16x16x32_bf16 v[28:31], v[80:83], v[116:119], v[28:31]
    s_waitcnt lgkmcnt(2)
    v_mfma_f32_16x16x32_bf16 v[24:27], v[84:87], v[120:123], v[24:27]
    ds_read_b128 v[80:83], v1 offset:54272
    v_mfma_f32_16x16x32_bf16 v[28:31], v[84:87], v[124:127], v[28:31]
    ds_write_b128 v152, v[8:11] offset:0
    s_waitcnt lgkmcnt(3)
    v_mfma_f32_16x16x32_bf16 v[32:35], v[88:91], v[112:115], v[32:35]
    ds_read_b128 v[84:87], v3 offset:15360
    v_mfma_f32_16x16x32_bf16 v[36:39], v[88:91], v[116:119], v[36:39]
    s_waitcnt lgkmcnt(3)
    v_mfma_f32_16x16x32_bf16 v[32:35], v[92:95], v[120:123], v[32:35]
    ds_read_b128 v[88:91], v1 offset:55296
    v_mfma_f32_16x16x32_bf16 v[36:39], v[92:95], v[124:127], v[36:39]
    ds_write_b128 v152, v[16:19] offset:1024
    s_waitcnt lgkmcnt(4)
    v_mfma_f32_16x16x32_bf16 v[40:43], v[80:83], v[112:115], v[40:43]
    ds_read_b128 v[92:95], v3 offset:16384
    v_mfma_f32_16x16x32_bf16 v[44:47], v[80:83], v[116:119], v[44:47]
    s_waitcnt lgkmcnt(3)
    v_mfma_f32_16x16x32_bf16 v[40:43], v[84:87], v[120:123], v[40:43]
    ds_read_b128 v[80:83], v1 offset:56320
    v_mfma_f32_16x16x32_bf16 v[44:47], v[84:87], v[124:127], v[44:47]
    ds_write_b128 v152, v[24:27] offset:2048
    s_waitcnt lgkmcnt(4)
    v_mfma_f32_16x16x32_bf16 v[48:51], v[88:91], v[112:115], v[48:51]
    ds_read_b128 v[84:87], v3 offset:17408
    v_mfma_f32_16x16x32_bf16 v[52:55], v[88:91], v[116:119], v[52:55]
    s_waitcnt lgkmcnt(3)
    v_mfma_f32_16x16x32_bf16 v[48:51], v[92:95], v[120:123], v[48:51]
    ds_read_b128 v[88:91], v1 offset:16384
    v_mfma_f32_16x16x32_bf16 v[52:55], v[92:95], v[124:127], v[52:55]
    ds_write_b128 v152, v[32:35] offset:3072
    s_waitcnt lgkmcnt(4)
    v_mfma_f32_16x16x32_bf16 v[56:59], v[80:83], v[112:115], v[56:59]
    ds_read_b128 v[92:95], v1 offset:17408
    v_mfma_f32_16x16x32_bf16 v[60:63], v[80:83], v[116:119], v[60:63]
    s_waitcnt lgkmcnt(3)
    v_mfma_f32_16x16x32_bf16 v[56:59], v[84:87], v[120:123], v[56:59]
    ds_read_b128 v[80:83], v1 offset:34816
    v_mfma_f32_16x16x32_bf16 v[60:63], v[84:87], v[124:127], v[60:63]
    ds_write_b128 v152, v[40:43] offset:4096
    ds_write_b128 v152, v[48:51] offset:5120
    s_nop 3
    ds_write_b128 v152, v[56:59] offset:6144
    s_waitcnt lgkmcnt(0)
    s_barrier
    ds_read_b128 v[200:203], v153 offset:0
    ds_read_b128 v[204:207], v153 offset:1024
    ds_read_b128 v[208:211], v153 offset:2048
    ds_read_b128 v[212:215], v153 offset:3072
    ds_read_b128 v[216:219], v153 offset:4096
    ds_read_b128 v[220:223], v153 offset:5120
    ds_read_b128 v[224:227], v153 offset:6144
    s_waitcnt lgkmcnt(6)
    v_pk_add_f32 v[12:13], v[12:13], v[200:201]
    v_pk_add_f32 v[14:15], v[14:15], v[202:203]
    v_cvt_pk_bf16_f32 v8, v12, v13
    v_cvt_pk_bf16_f32 v9, v14, v15
    s_waitcnt lgkmcnt(5)
    v_pk_add_f32 v[20:21], v[20:21], v[204:205]
    v_pk_add_f32 v[22:23], v[22:23], v[206:207]
    v_cvt_pk_bf16_f32 v10, v20, v21
    v_cvt_pk_bf16_f32 v11, v22, v23
    buffer_store_dwordx4 v[8:11], v1, s[8:11], s30 offen sc1
    s_waitcnt lgkmcnt(4)
    v_pk_add_f32 v[28:29], v[28:29], v[208:209]
    v_pk_add_f32 v[30:31], v[30:31], v[210:211]
    v_cvt_pk_bf16_f32 v24, v28, v29
    v_cvt_pk_bf16_f32 v25, v30, v31
    s_waitcnt lgkmcnt(3)
    v_pk_add_f32 v[36:37], v[36:37], v[212:213]
    v_pk_add_f32 v[38:39], v[38:39], v[214:215]
    v_cvt_pk_bf16_f32 v26, v36, v37
    v_cvt_pk_bf16_f32 v27, v38, v39
    buffer_store_dwordx4 v[24:27], v1, s[8:11], s31 offen sc1
    s_waitcnt lgkmcnt(2)
    v_pk_add_f32 v[44:45], v[44:45], v[216:217]
    v_pk_add_f32 v[46:47], v[46:47], v[218:219]
    v_cvt_pk_bf16_f32 v40, v44, v45
    v_cvt_pk_bf16_f32 v41, v46, v47
    s_waitcnt lgkmcnt(1)
    v_pk_add_f32 v[52:53], v[52:53], v[220:221]
    v_pk_add_f32 v[54:55], v[54:55], v[222:223]
    v_cvt_pk_bf16_f32 v42, v52, v53
    v_cvt_pk_bf16_f32 v43, v54, v55
    buffer_store_dwordx4 v[40:43], v1, s[8:11], s32 offen sc1
    s_waitcnt lgkmcnt(0)
    v_pk_add_f32 v[60:61], v[60:61], v[224:225]
    v_pk_add_f32 v[62:63], v[62:63], v[226:227]
    v_cvt_pk_bf16_f32 v56, v60, v61
    v_cvt_pk_bf16_f32 v57, v62, v63
    buffer_store_dwordx2 v[56:57], v5, s[8:11], s36 offen sc1
    v_mfma_f32_16x16x32_bf16 v[64:67], v[88:91], v[96:99], v[64:67]
    ds_read_b128 v[84:87], v1 offset:35840
    v_mfma_f32_16x16x32_bf16 v[68:71], v[88:91], v[100:103], v[68:71]
    v_mfma_f32_16x16x32_bf16 v[72:75], v[92:95], v[96:99], v[72:75]
    ds_read_b128 v[88:91], v3 offset:0
    v_mfma_f32_16x16x32_bf16 v[76:79], v[92:95], v[100:103], v[76:79]
    v_mfma_f32_16x16x32_bf16 v[64:67], v[80:83], v[104:107], v[64:67]
    ds_read_b128 v[92:95], v3 offset:1024
    v_mfma_f32_16x16x32_bf16 v[68:71], v[80:83], v[108:111], v[68:71]
    s_waitcnt lgkmcnt(2)
    v_mfma_f32_16x16x32_bf16 v[72:75], v[84:87], v[104:107], v[72:75]
    ds_read_b128 v[80:83], v3 offset:18432
    v_mfma_f32_16x16x32_bf16 v[76:79], v[84:87], v[108:111], v[76:79]
    s_waitcnt lgkmcnt(2)
    v_mfma_f32_16x16x32_bf16 v[64:67], v[88:91], v[112:115], v[64:67]
    ds_read_b128 v[84:87], v3 offset:19456
    v_mfma_f32_16x16x32_bf16 v[68:71], v[88:91], v[116:119], v[68:71]
    s_waitcnt lgkmcnt(2)
    v_mfma_f32_16x16x32_bf16 v[72:75], v[92:95], v[112:115], v[72:75]
    v_mfma_f32_16x16x32_bf16 v[76:79], v[92:95], v[116:119], v[76:79]
    s_waitcnt lgkmcnt(1)
    v_mfma_f32_16x16x32_bf16 v[64:67], v[80:83], v[120:123], v[64:67]
    v_mfma_f32_16x16x32_bf16 v[68:71], v[80:83], v[124:127], v[68:71]
    s_waitcnt lgkmcnt(0)
    v_mfma_f32_16x16x32_bf16 v[72:75], v[84:87], v[120:123], v[72:75]
    v_mfma_f32_16x16x32_bf16 v[76:79], v[84:87], v[124:127], v[76:79]
    s_nop 3
    ds_write_b128 v152, v[64:67] offset:7168
    s_nop 1
    ds_write_b128 v152, v[72:75] offset:8192
    v_mov_b32 v188, v68
    v_mov_b32 v189, v69
    v_mov_b32 v190, v70
    v_mov_b32 v191, v71
    v_mov_b32 v192, v76
    v_mov_b32 v193, v77
    v_mov_b32 v194, v78
    v_mov_b32 v195, v79
K6_TAIL:
    s_waitcnt vmcnt(4)
    v_add_f32 v176, v176, v178
    v_add_f32 v177, v177, v179
    v_mov_b32 v178, v176
    v_mov_b32 v179, v177
    s_nop 0
    v_permlane32_swap_b32 v176, v178
    v_permlane32_swap_b32 v177, v179
    v_add_f32 v176, v176, v178
    v_add_f32 v177, v177, v179
    v_mov_b32 v178, v176
    v_mov_b32 v179, v177
    s_nop 0
    v_permlane16_swap_b32 v176, v178
    v_permlane16_swap_b32 v177, v179
    v_add_f32 v176, v176, v178
    v_add_f32 v177, v177, v179
    v_mul_f32 v176, 0x3ae38e39, v176
    v_mul_f32 v177, 0x3ae38e39, v177
    v_fma_f32 v177, -v176, v176, v177
    v_max_f32 v177, 0, v177
    v_cvt_pk_bf16_f32 v178, v177, v177
    v_lshlrev_b32 v177, 16, v178
    v_add_f32 v177, 0x3727c5ac, v177
    v_cvt_pk_bf16_f32 v178, v177, v177
    v_lshlrev_b32 v177, 16, v178
    v_sqrt_f32 v177, v177
    s_nop 0
    v_cvt_pk_bf16_f32 v178, v177, v177
    v_lshlrev_b32 v177, 16, v178
    v_rcp_f32 v177, v177
    v_mov_b32 v196, 0
    v_mov_b32 v197, 0
    v_mov_b32 v198, 0
    v_mov_b32 v199, 0
    v_mul_f32 v176, v177, v177
    v_mul_f32 v164, v164, v176
    v_mul_f32 v165, v165, v176
    v_mul_f32 v166, v166, v176
    v_mul_f32 v167, v167, v176
    v_mul_f32 v168, v168, v176
    v_mul_f32 v169, v169, v176
    v_mul_f32 v170, v170, v176
    v_mul_f32 v171, v171, v176
    v_mul_f32 v172, v172, v176
    v_mul_f32 v173, v173, v176
    v_mul_f32 v174, v174, v176
    v_mul_f32 v175, v175, v176
    s_add_u32 s47, s47, 67108864
    s_add_u32 s46, s46, 67108864
    s_waitcnt vmcnt(0) lgkmcnt(0)
    s_barrier
    ds_read_b128 v[200:203], v153 offset:7168
    ds_read_b128 v[204:207], v153 offset:8192
    s_cmp_lg_u32 s12, 0
    s_cbranch_scc1 K6_WAITED
    s_lshl_b32 s55, s15, 2
    s_add_u32 s55, s55, s54
    v_mov_b32 v2, 0
    v_mov_b32 v6, 1
    s_mov_b64 exec, 1
    buffer_store_dword v6, v2, s[8:11], s55 offen sc1
    s_mov_b64 exec, -1
    s_mov_b32 exec_lo, 0xf
    s_mov_b32 exec_hi, 0
    v_lshlrev_b32 v2, 2, v0
    s_mov_b32 s56, 0
K6_POLL:
    buffer_load_dword v6, v2, s[8:11], s54 offen sc1
    s_add_u32 s56, s56, 1
    s_waitcnt vmcnt(0)
    v_cmp_ne_u32 vcc, 1, v6
    s_nop 4
    s_cbranch_vccz K6_POLLED
    s_cmp_lt_u32 s56, 0x40000
    s_cbranch_scc1 K6_POLL
K6_POLLED:
    s_mov_b64 exec, -1
K6_WAITED:
    s_barrier
    s_add_u32 s53, s47, s38
    buffer_load_dwordx4 v[96:99], v1, s[8:11], s53 offen sc1
    s_add_u32 s53, s47, s39
    buffer_load_dwordx4 v[100:103], v1, s[8:11], s53 offen sc1
    s_add_u32 s53, s47, s40
    buffer_load_dwordx4 v[104:107], v1, s[8:11], s53 offen sc1
    s_add_u32 s53, s46, 0
    buffer_load_dwordx2 v[108:109], v5, s[8:11], s53 offen sc1
    s_add_u32 s53, s46, 2359296
    buffer_load_dwordx2 v[110:111], v5, s[8:11], s53 offen sc1
    s_add_u32 s53, s46, 4718592
    buffer_load_dwordx2 v[112:113], v5, s[8:11], s53 offen sc1
    s_add_u32 s53, s46, 7077888
    buffer_load_dwordx2 v[114:115], v5, s[8:11], s53 offen sc1
    s_waitcnt lgkmcnt(0)
    v_pk_add_f32 v[188:189], v[188:189], v[200:201]
    v_pk_add_f32 v[190:191], v[190:191], v[202:203]
    v_pk_add_f32 v[192:193], v[192:193], v[204:205]
    v_pk_add_f32 v[194:195], v[194:195], v[206:207]
    s_waitcnt vmcnt(4)
    v_lshlrev_b32 v116, 16, v96
    v_and_b32 v117, 0xffff0000, v96
    v_pk_add_f32 v[188:189], v[188:189], v[116:117]
    v_lshlrev_b32 v118, 16, v97
    v_and_b32 v119, 0xffff0000, v97
    v_pk_add_f32 v[190:191], v[190:191], v[118:119]
    v_lshlrev_b32 v116, 16, v98
    v_and_b32 v117, 0xffff0000, v98
    v_pk_add_f32 v[192:193], v[192:193], v[116:117]
    v_lshlrev_b32 v118, 16, v99
    v_and_b32 v119, 0xffff0000, v99
    v_pk_add_f32 v[194:195], v[194:195], v[118:119]
    v_lshlrev_b32 v116, 16, v100
    v_and_b32 v117, 0xffff0000, v100
    v_pk_add_f32 v[188:189], v[188:189], v[116:117]
    v_lshlrev_b32 v118, 16, v101
    v_and_b32 v119, 0xffff0000, v101
    v_pk_add_f32 v[190:191], v[190:191], v[118:119]
    v_lshlrev_b32 v116, 16, v102
    v_and_b32 v117, 0xffff0000, v102
    v_pk_add_f32 v[192:193], v[192:193], v[116:117]
    v_lshlrev_b32 v118, 16, v103
    v_and_b32 v119, 0xffff0000, v103
    v_pk_add_f32 v[194:195], v[194:195], v[118:119]
    v_lshlrev_b32 v116, 16, v104
    v_and_b32 v117, 0xffff0000, v104
    v_pk_add_f32 v[188:189], v[188:189], v[116:117]
    v_lshlrev_b32 v118, 16, v105
    v_and_b32 v119, 0xffff0000, v105
    v_pk_add_f32 v[190:191], v[190:191], v[118:119]
    v_lshlrev_b32 v116, 16, v106
    v_and_b32 v117, 0xffff0000, v106
    v_pk_add_f32 v[192:193], v[192:193], v[116:117]
    v_lshlrev_b32 v118, 16, v107
    v_and_b32 v119, 0xffff0000, v107
    v_pk_add_f32 v[194:195], v[194:195], v[118:119]
    v_lshlrev_b32 v116, 16, v156
    v_and_b32 v117, 0xffff0000, v156
    v_pk_fma_f32 v[188:189], v[188:189], v[164:165], v[116:117]
    v_cvt_pk_bf16_f32 v120, v188, v189
    v_lshlrev_b32 v116, 16, v157
    v_and_b32 v117, 0xffff0000, v157
    v_pk_fma_f32 v[190:191], v[190:191], v[166:167], v[116:117]
    v_cvt_pk_bf16_f32 v121, v190, v191
    v_lshlrev_b32 v116, 16, v158
    v_and_b32 v117, 0xffff0000, v158
    v_pk_fma_f32 v[192:193], v[192:193], v[168:169], v[116:117]
    v_cvt_pk_bf16_f32 v122, v192, v193
    v_lshlrev_b32 v116, 16, v159
    v_and_b32 v117, 0xffff0000, v159
    v_pk_fma_f32 v[194:195], v[194:195], v[170:171], v[116:117]
    v_cvt_pk_bf16_f32 v123, v194, v195
    v_permlane16_swap_b32 v120, v122
    s_nop 0
    v_permlane16_swap_b32 v121, v123
    buffer_store_dwordx4 v[120:123], v185, s[60:63], s51 offen
    s_cmp_ge_u32 s52, 0x10000000
    s_cbranch_scc1 K6_DONE
    s_waitcnt vmcnt(1)
    v_lshlrev_b32 v116, 16, v108
    v_and_b32 v117, 0xffff0000, v108
    v_pk_add_f32 v[196:197], v[196:197], v[116:117]
    v_lshlrev_b32 v118, 16, v109
    v_and_b32 v119, 0xffff0000, v109
    v_pk_add_f32 v[198:199], v[198:199], v[118:119]
    v_lshlrev_b32 v116, 16, v110
    v_and_b32 v117, 0xffff0000, v110
    v_pk_add_f32 v[196:197], v[196:197], v[116:117]
    v_lshlrev_b32 v118, 16, v111
    v_and_b32 v119, 0xffff0000, v111
    v_pk_add_f32 v[198:199], v[198:199], v[118:119]
    v_lshlrev_b32 v116, 16, v112
    v_and_b32 v117, 0xffff0000, v112
    v_pk_add_f32 v[196:197], v[196:197], v[116:117]
    v_lshlrev_b32 v118, 16, v113
    v_and_b32 v119, 0xffff0000, v113
    v_pk_add_f32 v[198:199], v[198:199], v[118:119]
    v_lshlrev_b32 v116, 16, v114
    v_and_b32 v117, 0xffff0000, v114
    v_pk_add_f32 v[196:197], v[196:197], v[116:117]
    v_lshlrev_b32 v118, 16, v115
    v_and_b32 v119, 0xffff0000, v115
    v_pk_add_f32 v[198:199], v[198:199], v[118:119]
    v_lshlrev_b32 v116, 16, v160
    v_and_b32 v117, 0xffff0000, v160
    v_pk_fma_f32 v[196:197], v[196:197], v[172:173], v[116:117]
    v_cvt_pk_bf16_f32 v124, v196, v197
    v_lshlrev_b32 v116, 16, v161
    v_and_b32 v117, 0xffff0000, v161
    v_pk_fma_f32 v[198:199], v[198:199], v[174:175], v[116:117]
    v_cvt_pk_bf16_f32 v125, v198, v199
    buffer_store_dwordx2 v[124:125], v186, s[60:63], s52 offen
K6_DONE:
K5_END:
    s_endpgm
TEXT_END:
    s_endpgm
.section .rodata,"a"
.p2align 6
.amdhsa_kernel k1_prep_kernel
  .amdhsa_next_free_vgpr 88
  .amdhsa_next_free_sgpr 64
  .amdhsa_accum_offset 88
  .amdhsa_group_segment_fixed_size 0
  .amdhsa_kernarg_size 112
  .amdhsa_user_sgpr_count 2
  .amdhsa_user_sgpr_kernarg_segment_ptr 1
  .amdhsa_system_sgpr_workgroup_id_x 1
.end_amdhsa_kernel
.p2align 6
.amdhsa_kernel k2_qkv_kernel
  .amdhsa_next_free_vgpr 332
  .amdhsa_next_free_sgpr 40
  .amdhsa_accum_offset 224
  .amdhsa_group_segment_fixed_size 0
  .amdhsa_kernarg_size 112
  .amdhsa_user_sgpr_count 2
  .amdhsa_user_sgpr_kernarg_segment_ptr 1
  .amdhsa_system_sgpr_workgroup_id_x 1
.end_amdhsa_kernel
.p2align 6
.amdhsa_kernel k3_attn_kernel
  .amdhsa_next_free_vgpr 152
  .amdhsa_next_free_sgpr 102
  .amdhsa_accum_offset 152
  .amdhsa_group_segment_fixed_size 0
  .amdhsa_kernarg_size 112
  .amdhsa_user_sgpr_count 2
  .amdhsa_user_sgpr_kernarg_segment_ptr 1
  .amdhsa_system_sgpr_workgroup_id_x 1
.end_amdhsa_kernel
.p2align 6
.amdhsa_kernel k4_tail_kernel
  .amdhsa_next_free_vgpr 256
  .amdhsa_next_free_sgpr 80
  .amdhsa_accum_offset 256
  .amdhsa_group_segment_fixed_size 0
  .amdhsa_kernarg_size 112
  .amdhsa_user_sgpr_count 2
  .amdhsa_user_sgpr_kernarg_segment_ptr 1
  .amdhsa_system_sgpr_workgroup_id_x 1
.end_amdhsa_kernel
```
